```python
import torch

def _softmax(x, axis=-1):
    return torch.softmax(x, dim=axis)

def _gelu(x):
    return torch.nn.functional.gelu(x, approximate='tanh')

def _silu(x):
    return torch.nn.functional.silu(x)

def _sigmoid(x):
    return torch.sigmoid(x)

def _layernorm(x, axis=-1, eps=1e-05):
    m = x.mean(dim=axis, keepdim=True)
    v = x.var(dim=axis, keepdim=True, unbiased=False)
    return (x - m) / torch.sqrt(v + eps)

def _scatter_add(tgt, idx, src, axis=0):
    return tgt.clone().index_add_(axis, idx, src)

def _segment_sum(src, seg, n):
    out = torch.zeros((n,) + src.shape[1:], dtype=src.dtype)
    return out.index_add_(0, seg, src)

def _pad(x, pw):
    flat = tuple((v for pair in reversed(pw) for v in pair))
    return torch.nn.functional.pad(x, flat)
kernel_name = 'adaLN_cond__ssm_conv_h3__glu_gated_glu__prompt'

def setup_inputs():

    _w = lambda a: (lambda t: t.to(torch.bfloat16) if t.is_floating_point() else t)(torch.as_tensor(a))

    def _A_setup():
        B, S, D = (1, 2048, 576)
        ks = 4
        return {'q': _w((lambda *s: torch.randn(*s, dtype=torch.bfloat16) * 0.05)(B, S, D)), 'k': _w((lambda *s: torch.randn(*s, dtype=torch.bfloat16) * 0.8)(B, S, D)), 'v': _w((lambda *s: torch.randn(*s, dtype=torch.bfloat16) * 0.8)(B, S, D)), 'shift_k': _w((lambda *s: torch.randn(*s, dtype=torch.bfloat16) * 0.8)(D, ks) * 0.5), 'ssm_k': _w((lambda *s: torch.randn(*s, dtype=torch.bfloat16) * 0.8)(D, S) * (1.0 / S ** 0.5)), 'ssm_D': _w((lambda *s: torch.randn(*s, dtype=torch.bfloat16) * 0.8)(D))}
    _A_in = _A_setup()

    def _B_setup():
        B, S, D, F = (1, 2048, 576, 4608)
        return {'x': _w((lambda *s: torch.randn(*s, dtype=torch.bfloat16) * 0.05)(B, S, D)), 'w_gate': _w((lambda *s: torch.randn(*s, dtype=torch.bfloat16) * 0.05)(D, F)), 'w_up': _w((lambda *s: torch.randn(*s, dtype=torch.bfloat16) * 0.05)(D, F)), 'w_down': _w((lambda *s: torch.randn(*s, dtype=torch.bfloat16) * 0.05)(F, D))}
    _B_in = _B_setup()
    return {'A_q': _A_in['q'], 'A_k': _A_in['k'], 'A_v': _A_in['v'], 'A_shift_k': _A_in['shift_k'], 'A_ssm_k': _A_in['ssm_k'], 'A_ssm_D': _A_in['ssm_D'], 'B_x': _B_in['x'], 'B_w_gate': _B_in['w_gate'], 'B_w_up': _B_in['w_up'], 'B_w_down': _B_in['w_down'], 'c': _w((lambda *s: torch.randn(*s, dtype=torch.bfloat16) * 0.1)(1, 576) * 8.0), 'w_mod': _w((lambda *s: torch.randn(*s, dtype=torch.bfloat16) * 0.1)(576, 6 * 576) * 576 ** (-0.5) * 8.0)}

def reference(A_q, A_k, A_v, A_shift_k, A_ssm_k, A_ssm_D, B_x, B_w_gate, B_w_up, B_w_down, c, w_mod):

    def _A_ref(q, k, v, shift_k, ssm_k, ssm_D):
        B, S, D = q.shape
        ks = shift_k.shape[-1]
        k_pad = _pad(k, ((0, 0), (ks - 1, 0), (0, 0)))
        k_shift = torch.zeros_like(k)
        for t in range(ks):
            k_shift = k_shift + k_pad[:, t:t + S, :] * shift_k[:, ks - 1 - t][None, None, :]
        kv = k_shift * v
        L = 2 * S
        kv_pad = _pad(kv, ((0, 0), (0, S), (0, 0)))
        kf_pad = _pad(ssm_k, ((0, 0), (0, S)))
        kv_f = (lambda x, axes=(-2, -1): torch.fft.rfft2(x.float(), dim=axes))(kv_pad[:, None, :, :], axes=(1, 2))
        kf_f = (lambda x, axes=(-2, -1): torch.fft.rfft2(x.float(), dim=axes))(kf_pad[:, None, :], axes=(1, 2))
        kf_f = (lambda x, *d: x.permute(*d))(kf_f, 1, 2, 0)
        y_f = kv_f * kf_f[None, :, :, :]
        y = (lambda x, s, axes=(-2, -1): torch.fft.irfft2(x, s=s, dim=axes).to(torch.bfloat16))(y_f, (1, L), axes=(1, 2))[:, 0, :S, :]
        y = y + kv * ssm_D[None, None, :]
        return q * y

    def _B_ref(x, w_gate, w_up, w_down):
        g = torch.einsum('bsd,df->bsf', x, w_gate)
        u = torch.einsum('bsd,df->bsf', x, w_up)
        h = _sigmoid(g) * u
        return torch.einsum('bsf,fd->bsd', h, w_down)
    x = A_q
    mod = (_silu(c) @ w_mod).reshape(c.shape[0], 6, 1, -1)
    sa, ca, ga, sb, cb, gb = (mod[:, 0].clone(), mod[:, 1].clone(), mod[:, 2].clone(), mod[:, 3].clone(), mod[:, 4].clone(), mod[:, 5].clone())
    h = _layernorm(x, axis=-1) * (1 + ca) + sa
    x = x + ga * _A_ref(h, A_k, A_v, A_shift_k, A_ssm_k, A_ssm_D)
    h = _layernorm(x, axis=-1) * (1 + cb) + sb
    x = x + gb * _B_ref(h, B_w_gate, B_w_up, B_w_down)
    return x
```

```asm
; @launch grid=(256,1,1) block=(256,1,1) lds=159744
.amdgcn_target "amdgcn-amd-amdhsa--gfx950"
.text
.globl adaLN_cond__ssm_conv_h3__glu_gated_glu__prompt_kernel
.p2align 8
.type adaLN_cond__ssm_conv_h3__glu_gated_glu__prompt_kernel,@function
adaLN_cond__ssm_conv_h3__glu_gated_glu__prompt_kernel:
    s_cmp_ge_u32 s2, 256
    s_cbranch_scc1 KB_END
    s_load_dwordx4 s[4:7], s[0:1], 8
    s_load_dwordx4 s[36:39], s[0:1], 24
    s_load_dwordx4 s[8:11], s[0:1], 104
    s_load_dwordx2 s[52:53], s[0:1], 0
    s_memrealtime s[60:61]
    s_lshr_b32 s13, s2, 3
    s_and_b32 s100, s2, 31
    s_lshr_b32 s101, s2, 5
    s_and_b32 s14, s2, 7
    v_lshrrev_b32 v4, 6, v0
    v_mul_u32_u24 v2, 7282, v0
    v_readfirstlane_b32 s3, v4
    v_lshrrev_b32 v2, 16, v2
    v_mul_u32_u24 v1, 9, v2
    v_sub_u32 v1, v0, v1
    s_mul_i32 s15, s100, 64*1152
    s_mul_i32 s16, s101, 144
    s_add_u32 s15, s15, s16
    s_sub_u32 s15, s15, 4*1152
    v_mul_u32_u24 v3, 1152, v2
    v_lshl_add_u32 v3, v1, 4, v3
    v_add_u32 v3, s15, v3
    v_add_u32 v6, 256, v0
    v_mul_u32_u24 v7, 7282, v6
    v_lshrrev_b32 v7, 16, v7
    v_mul_u32_u24 v7, 1008, v7
    v_lshl_add_u32 v7, v6, 4, v7
    v_add_u32 v4, s15, v7
    v_add_u32 v6, 512, v0
    v_mul_u32_u24 v7, 7282, v6
    v_lshrrev_b32 v7, 16, v7
    v_mul_u32_u24 v7, 1008, v7
    v_lshl_add_u32 v7, v6, 4, v7
    v_add_u32 v5, s15, v7
    v_cmp_gt_u32 vcc, 100, v0
    v_mul_u32_u24 v6, 3456, v2
    v_lshl_add_u32 v6, v1, 4, v6
    v_cndmask_b32 v5, 2.0, v5, vcc
    s_add_u32 s15, s15, 3*1152
    v_add_u32 v6, s15, v6
    v_cmp_gt_u32 vcc, 198, v0
    v_add_u32 v7, 1152, v6
    s_mul_i32 s17, s101, 576
    v_cndmask_b32 v6, 2.0, v6, vcc
    v_cndmask_b32 v7, 2.0, v7, vcc
    v_lshlrev_b32 v60, 6, v1
    s_lshl_b32 s49, s3, 10
    s_add_u32 m0, s49, 121952
    s_waitcnt lgkmcnt(0)
    s_mov_b32 s44, s8
    s_mov_b32 s45, s9
    s_mov_b32 s46, 256
    s_mov_b32 s47, 0x00020000
    s_or_b32 s48, s60, 1
    v_mov_b32 v148, s48
    v_lshlrev_b32 v149, 8, v0
    s_lshl_b32 s48, s2, 8
    buffer_store_dword v148, v149, s[44:47], s48 offen sc1
    s_mov_b32 s20, s4
    s_mov_b32 s21, s5
    s_mov_b32 s22, 2359296
    s_mov_b32 s23, 0x00020000
    buffer_load_dwordx4 v3, s[20:23], 0 offen lds
    s_add_u32 m0, s49, 126048
    s_mov_b32 s24, s6
    s_mov_b32 s25, s7
    s_mov_b32 s26, 2359296
    s_mov_b32 s27, 0x00020000
    buffer_load_dwordx4 v4, s[20:23], 0 offen lds
    s_add_u32 m0, s49, 130144
    buffer_load_dwordx4 v[32:35], v6, s[24:27], 0 offen
    buffer_load_dwordx4 v5, s[20:23], 0 offen lds
    buffer_load_dwordx4 v[36:39], v7, s[24:27], 0 offen
    buffer_load_dwordx4 v[40:43], v7, s[24:27], 0 offen offset:1152
    s_mov_b32 s28, s36
    s_mov_b32 s29, s37
    s_mov_b32 s30, 4608
    s_mov_b32 s31, 0x00020000
    buffer_load_dwordx4 v[44:47], v60, s[28:31], s17 offen offset:0
    buffer_load_dwordx4 v[48:51], v60, s[28:31], s17 offen offset:16
    buffer_load_dwordx4 v[52:55], v60, s[28:31], s17 offen offset:32
    buffer_load_dwordx4 v[56:59], v60, s[28:31], s17 offen offset:48
    v_mul_u32_u24 v3, 432, v2
    v_lshl_add_u32 v3, v1, 4, v3
    v_add_u32 v3, 121952, v3
    v_mul_u32_u24 v6, 480, v2
    v_lshl_add_u32 v6, v1, 4, v6
    v_add_u32 v6, 108032, v6
    v_and_b32 v1, 63, v0
    v_lshrrev_b32 v4, 4, v1
    v_bfe_u32 v5, v1, 2, 2
    v_lshl_add_u32 v5, v4, 4, v5
    v_bfe_u32 v7, v1, 1, 1
    v_lshl_add_u32 v5, v7, 3, v5
    v_sub_u32 v5, 59, v5
    v_mul_u32_u24 v5, 160, v5
    v_and_b32 v7, 1, v1
    v_lshl_add_u32 v5, v7, 3, v5
    v_add_u32 v2, 108160, v5
    s_lshl_b32 s49, s3, 4
    s_add_u32 s49, s49, 108032
    v_add_u32 v5, s49, v5
    s_and_b32 s48, s13, 15
    s_lshr_b32 s49, s13, 4
    s_add_u32 s12, s48, 1
    s_lshr_b32 s12, s12, 1
    s_mul_i32 s62, s49, 9
    s_add_u32 s12, s12, s62
    s_mul_i32 s62, s14, 18
    s_add_u32 s12, s12, s62
    s_lshr_b32 s62, s48, 1
    s_mul_i32 s63, s49, 7
    s_add_u32 s62, s62, s63
    s_lshl_b32 s62, s62, 3
    s_add_u32 s62, s62, s14
    s_and_b32 s63, s48, 1
    s_cmp_eq_u32 s48, 15
    s_cselect_b32 s63, 0, s63
    s_cmp_eq_u32 s63, 1
    s_cselect_b32 s12, s62, s12
    s_cselect_b32 s42, 0, 4096
    s_lshl_b32 s15, s12, 2
    s_add_u32 s15, s15, s3
    s_lshl_b32 s49, s15, 12
    s_add_u32 s40, s38, s49
    s_addc_u32 s41, s39, 0
    s_mov_b32 s43, 0x00020000
    s_cmp_lg_u32 s63, 1
    s_cbranch_scc1 K1_HSRD
    s_getpc_b64 s[40:41]
K1_PC:
    s_lshr_b32 s49, s12, 3
    s_lshl_b32 s49, s49, 2
    s_add_u32 s49, s49, s3
    s_lshl_b32 s49, s49, 12
    s_add_u32 s40, s40, s49
    s_addc_u32 s41, s41, 0
    s_sub_i32 s42, TEXT_END-K1_PC, s49
    s_max_i32 s42, s42, 0
K1_HSRD:
    s_mul_i32 s62, s3, 27008
    v_lshlrev_b32 v149, 4, v1
    s_add_u32 m0, s62, 9280
    s_nop 0
    buffer_load_dwordx4 v149, s[40:43], 4 offen offset:0 lds
    buffer_load_dwordx4 v149, s[40:43], 4 offen offset:1024 lds
    buffer_load_dwordx4 v149, s[40:43], 4 offen offset:2048 lds
    buffer_load_dwordx4 v149, s[40:43], 4 offen offset:3072 lds
    s_mov_b32 s54, 2359296
    s_mov_b32 s55, 0x00020000
    v_and_b32 v150, 7, v1
    v_mul_u32_u24 v150, 1152, v150
    v_lshrrev_b32 v151, 3, v1
    v_lshl_add_u32 v150, v151, 4, v150
    s_and_b32 s48, s2, 0xf0
    s_lshl_b32 s61, s14, 1
    s_add_u32 s48, s48, s61
    s_and_b32 s61, s13, 1
    s_add_u32 s48, s48, s61
    s_mul_i32 s48, s48, 8*1152
    s_lshl_b32 s49, s3, 7
    s_add_u32 s49, s49, s48
    buffer_load_dwordx4 v[192:195], v150, s[52:55], s49 offen
    buffer_load_dwordx4 v[196:199], v150, s[52:55], s49 offen offset:512
    buffer_load_dwordx4 v[200:203], v150, s[52:55], s48 offen offset:1024
    s_mov_b32 s50, 0
K1_PASS:
    ds_read_b128 v[8:11], v3 offset:0
    ds_read_b128 v[12:15], v3 offset:144
    ds_read_b128 v[16:19], v3 offset:288
    ds_read_b128 v[20:23], v3 offset:432
    ds_read_b128 v[24:27], v3 offset:576
    ds_read_b128 v[28:31], v3 offset:720
    v_lshlrev_b32 v60, 16, v44
    v_and_b32 v68, 0xffff0000, v44
    v_lshlrev_b32 v76, 16, v45
    v_and_b32 v84, 0xffff0000, v45
    v_lshlrev_b32 v61, 16, v46
    v_and_b32 v69, 0xffff0000, v46
    v_lshlrev_b32 v77, 16, v47
    v_and_b32 v85, 0xffff0000, v47
    v_lshlrev_b32 v62, 16, v48
    v_and_b32 v70, 0xffff0000, v48
    v_lshlrev_b32 v78, 16, v49
    v_and_b32 v86, 0xffff0000, v49
    v_lshlrev_b32 v63, 16, v50
    v_and_b32 v71, 0xffff0000, v50
    v_lshlrev_b32 v79, 16, v51
    v_and_b32 v87, 0xffff0000, v51
    v_lshlrev_b32 v64, 16, v52
    v_and_b32 v72, 0xffff0000, v52
    v_lshlrev_b32 v80, 16, v53
    v_and_b32 v88, 0xffff0000, v53
    v_lshlrev_b32 v65, 16, v54
    v_and_b32 v73, 0xffff0000, v54
    v_lshlrev_b32 v81, 16, v55
    v_and_b32 v89, 0xffff0000, v55
    v_lshlrev_b32 v66, 16, v56
    v_and_b32 v74, 0xffff0000, v56
    v_lshlrev_b32 v82, 16, v57
    v_and_b32 v90, 0xffff0000, v57
    v_lshlrev_b32 v67, 16, v58
    v_and_b32 v75, 0xffff0000, v58
    v_lshlrev_b32 v83, 16, v59
    v_and_b32 v91, 0xffff0000, v59
    s_waitcnt lgkmcnt(0)
    v_lshlrev_b32 v92, 16, v8
    v_and_b32 v93, 0xffff0000, v8
    v_lshlrev_b32 v94, 16, v9
    v_and_b32 v95, 0xffff0000, v9
    v_lshlrev_b32 v96, 16, v10
    v_and_b32 v97, 0xffff0000, v10
    v_lshlrev_b32 v98, 16, v11
    v_and_b32 v99, 0xffff0000, v11
    v_pk_mul_f32 v[108:109], v[92:93], v[84:85]
    v_pk_mul_f32 v[110:111], v[94:95], v[86:87]
    v_pk_mul_f32 v[112:113], v[96:97], v[88:89]
    v_pk_mul_f32 v[114:115], v[98:99], v[90:91]
    v_lshlrev_b32 v100, 16, v12
    v_and_b32 v101, 0xffff0000, v12
    v_lshlrev_b32 v102, 16, v13
    v_and_b32 v103, 0xffff0000, v13
    v_lshlrev_b32 v104, 16, v14
    v_and_b32 v105, 0xffff0000, v14
    v_lshlrev_b32 v106, 16, v15
    v_and_b32 v107, 0xffff0000, v15
    v_pk_fma_f32 v[108:109], v[100:101], v[76:77], v[108:109]
    v_pk_fma_f32 v[110:111], v[102:103], v[78:79], v[110:111]
    v_pk_fma_f32 v[112:113], v[104:105], v[80:81], v[112:113]
    v_pk_fma_f32 v[114:115], v[106:107], v[82:83], v[114:115]
    v_pk_mul_f32 v[116:117], v[100:101], v[84:85]
    v_pk_mul_f32 v[118:119], v[102:103], v[86:87]
    v_pk_mul_f32 v[120:121], v[104:105], v[88:89]
    v_pk_mul_f32 v[122:123], v[106:107], v[90:91]
    v_lshlrev_b32 v92, 16, v16
    v_and_b32 v93, 0xffff0000, v16
    v_lshlrev_b32 v94, 16, v17
    v_and_b32 v95, 0xffff0000, v17
    v_lshlrev_b32 v96, 16, v18
    v_and_b32 v97, 0xffff0000, v18
    v_lshlrev_b32 v98, 16, v19
    v_and_b32 v99, 0xffff0000, v19
    v_pk_fma_f32 v[108:109], v[92:93], v[68:69], v[108:109]
    v_pk_fma_f32 v[110:111], v[94:95], v[70:71], v[110:111]
    v_pk_fma_f32 v[112:113], v[96:97], v[72:73], v[112:113]
    v_pk_fma_f32 v[114:115], v[98:99], v[74:75], v[114:115]
    v_pk_fma_f32 v[116:117], v[92:93], v[76:77], v[116:117]
    v_pk_fma_f32 v[118:119], v[94:95], v[78:79], v[118:119]
    v_pk_fma_f32 v[120:121], v[96:97], v[80:81], v[120:121]
    v_pk_fma_f32 v[122:123], v[98:99], v[82:83], v[122:123]
    v_pk_mul_f32 v[124:125], v[92:93], v[84:85]
    v_pk_mul_f32 v[126:127], v[94:95], v[86:87]
    v_pk_mul_f32 v[128:129], v[96:97], v[88:89]
    v_pk_mul_f32 v[130:131], v[98:99], v[90:91]
    v_lshlrev_b32 v100, 16, v20
    v_and_b32 v101, 0xffff0000, v20
    v_lshlrev_b32 v102, 16, v21
    v_and_b32 v103, 0xffff0000, v21
    v_lshlrev_b32 v104, 16, v22
    v_and_b32 v105, 0xffff0000, v22
    v_lshlrev_b32 v106, 16, v23
    v_and_b32 v107, 0xffff0000, v23
    v_pk_fma_f32 v[108:109], v[100:101], v[60:61], v[108:109]
    v_pk_fma_f32 v[110:111], v[102:103], v[62:63], v[110:111]
    v_pk_fma_f32 v[112:113], v[104:105], v[64:65], v[112:113]
    v_pk_fma_f32 v[114:115], v[106:107], v[66:67], v[114:115]
    v_pk_fma_f32 v[116:117], v[100:101], v[68:69], v[116:117]
    v_pk_fma_f32 v[118:119], v[102:103], v[70:71], v[118:119]
    v_pk_fma_f32 v[120:121], v[104:105], v[72:73], v[120:121]
    v_pk_fma_f32 v[122:123], v[106:107], v[74:75], v[122:123]
    v_pk_fma_f32 v[124:125], v[100:101], v[76:77], v[124:125]
    v_pk_fma_f32 v[126:127], v[102:103], v[78:79], v[126:127]
    v_pk_fma_f32 v[128:129], v[104:105], v[80:81], v[128:129]
    v_pk_fma_f32 v[130:131], v[106:107], v[82:83], v[130:131]
    v_lshlrev_b32 v92, 16, v24
    v_and_b32 v93, 0xffff0000, v24
    v_lshlrev_b32 v94, 16, v25
    v_and_b32 v95, 0xffff0000, v25
    v_lshlrev_b32 v96, 16, v26
    v_and_b32 v97, 0xffff0000, v26
    v_lshlrev_b32 v98, 16, v27
    v_and_b32 v99, 0xffff0000, v27
    v_pk_fma_f32 v[116:117], v[92:93], v[60:61], v[116:117]
    v_pk_fma_f32 v[118:119], v[94:95], v[62:63], v[118:119]
    v_pk_fma_f32 v[120:121], v[96:97], v[64:65], v[120:121]
    v_pk_fma_f32 v[122:123], v[98:99], v[66:67], v[122:123]
    v_pk_fma_f32 v[124:125], v[92:93], v[68:69], v[124:125]
    v_pk_fma_f32 v[126:127], v[94:95], v[70:71], v[126:127]
    v_pk_fma_f32 v[128:129], v[96:97], v[72:73], v[128:129]
    v_pk_fma_f32 v[130:131], v[98:99], v[74:75], v[130:131]
    v_lshlrev_b32 v100, 16, v28
    v_and_b32 v101, 0xffff0000, v28
    v_lshlrev_b32 v102, 16, v29
    v_and_b32 v103, 0xffff0000, v29
    v_lshlrev_b32 v104, 16, v30
    v_and_b32 v105, 0xffff0000, v30
    v_lshlrev_b32 v106, 16, v31
    v_and_b32 v107, 0xffff0000, v31
    v_pk_fma_f32 v[124:125], v[100:101], v[60:61], v[124:125]
    v_pk_fma_f32 v[126:127], v[102:103], v[62:63], v[126:127]
    v_pk_fma_f32 v[128:129], v[104:105], v[64:65], v[128:129]
    v_pk_fma_f32 v[130:131], v[106:107], v[66:67], v[130:131]
    v_lshlrev_b32 v92, 16, v32
    v_and_b32 v93, 0xffff0000, v32
    v_lshlrev_b32 v94, 16, v33
    v_and_b32 v95, 0xffff0000, v33
    v_lshlrev_b32 v96, 16, v34
    v_and_b32 v97, 0xffff0000, v34
    v_lshlrev_b32 v98, 16, v35
    v_and_b32 v99, 0xffff0000, v35
    v_pk_mul_f32 v[108:109], v[108:109], v[92:93]
    v_pk_mul_f32 v[110:111], v[110:111], v[94:95]
    v_pk_mul_f32 v[112:113], v[112:113], v[96:97]
    v_pk_mul_f32 v[114:115], v[114:115], v[98:99]
    v_cvt_pk_bf16_f32 v132, v108, v109
    v_cvt_pk_bf16_f32 v133, v110, v111
    v_cvt_pk_bf16_f32 v134, v112, v113
    v_cvt_pk_bf16_f32 v135, v114, v115
    ds_write_b128 v6, v[132:135] offset:0
    v_lshlrev_b32 v100, 16, v36
    v_and_b32 v101, 0xffff0000, v36
    v_lshlrev_b32 v102, 16, v37
    v_and_b32 v103, 0xffff0000, v37
    v_lshlrev_b32 v104, 16, v38
    v_and_b32 v105, 0xffff0000, v38
    v_lshlrev_b32 v106, 16, v39
    v_and_b32 v107, 0xffff0000, v39
    v_pk_mul_f32 v[116:117], v[116:117], v[100:101]
    v_pk_mul_f32 v[118:119], v[118:119], v[102:103]
    v_pk_mul_f32 v[120:121], v[120:121], v[104:105]
    v_pk_mul_f32 v[122:123], v[122:123], v[106:107]
    v_cvt_pk_bf16_f32 v136, v116, v117
    v_cvt_pk_bf16_f32 v137, v118, v119
    v_cvt_pk_bf16_f32 v138, v120, v121
    v_cvt_pk_bf16_f32 v139, v122, v123
    ds_write_b128 v6, v[136:139] offset:160
    v_lshlrev_b32 v92, 16, v40
    v_and_b32 v93, 0xffff0000, v40
    v_lshlrev_b32 v94, 16, v41
    v_and_b32 v95, 0xffff0000, v41
    v_lshlrev_b32 v96, 16, v42
    v_and_b32 v97, 0xffff0000, v42
    v_lshlrev_b32 v98, 16, v43
    v_and_b32 v99, 0xffff0000, v43
    v_pk_mul_f32 v[124:125], v[124:125], v[92:93]
    v_pk_mul_f32 v[126:127], v[126:127], v[94:95]
    v_pk_mul_f32 v[128:129], v[128:129], v[96:97]
    v_pk_mul_f32 v[130:131], v[130:131], v[98:99]
    v_cvt_pk_bf16_f32 v140, v124, v125
    v_cvt_pk_bf16_f32 v141, v126, v127
    v_cvt_pk_bf16_f32 v142, v128, v129
    v_cvt_pk_bf16_f32 v143, v130, v131
    ds_write_b128 v6, v[140:143] offset:320
    s_waitcnt lgkmcnt(0)
    s_barrier
    ds_read_b64_tr_b16 v[8:9], v5 offset:800
    ds_read_b64_tr_b16 v[10:11], v5 offset:160
    ds_read_b64_tr_b16 v[12:13], v5 offset:640
    ds_read_b64_tr_b16 v[14:15], v5 offset:0
    ds_read_b64_tr_b16 v[16:17], v5 offset:864
    ds_read_b64_tr_b16 v[18:19], v5 offset:224
    ds_read_b64_tr_b16 v[20:21], v5 offset:704
    ds_read_b64_tr_b16 v[22:23], v5 offset:64
    ds_read_b64_tr_b16 v[24:25], v2 offset:800
    ds_read_b64_tr_b16 v[26:27], v2 offset:160
    ds_read_b64_tr_b16 v[28:29], v2 offset:640
    ds_read_b64_tr_b16 v[30:31], v2 offset:0
    s_cmp_lg_u32 s50, 0
    s_cbranch_scc1 K1_DONE
    s_mov_b32 s50, 1
    v_and_b32 v7, 7, v1
    v_mul_u32_u24 v7, 8448, v7
    v_lshrrev_b32 v4, 3, v1
    v_lshl_add_u32 v7, v4, 4, v7
    s_mul_i32 s18, s101, 608256
    s_lshl_b32 s19, s100, 7
    s_sub_u32 s19, 3968, s19
    s_add_u32 s18, s19, s18
    s_mul_i32 s49, s3, 67584
    s_add_u32 s16, s18, s49
    s_add_u32 s17, s16, 270336
    s_add_u32 s18, s18, 540672
    s_cmp_lg_u32 s3, 0
    s_cselect_b32 s18, 2.0, s18
    v_add_u32 v4, 4224, v7
    s_add_u32 s32, s10, 0x0
    s_addc_u32 s33, s11, 0
    s_mov_b32 s34, 0x4a4000
    s_mov_b32 s35, 0x00020000
    s_add_u32 s56, s10, 0xba0000
    s_addc_u32 s57, s11, 0
    s_mov_b32 s58, 0xb0000
    s_mov_b32 s59, 0x00020000
    v_mov_b32 v150, 0
    s_waitcnt vmcnt(7)
    s_waitcnt lgkmcnt(0)
    s_barrier
    buffer_load_dword v148, v150, s[44:47], 0 offen sc1
    s_branch K1_PASS
K1_DONE:
    s_waitcnt lgkmcnt(10)
    buffer_store_dwordx4 v[8:11], v7, s[32:35], s16 offen sc1
    s_waitcnt lgkmcnt(8)
    buffer_store_dwordx4 v[12:15], v4, s[32:35], s16 offen sc1
    s_waitcnt lgkmcnt(6)
    buffer_store_dwordx4 v[16:19], v7, s[32:35], s17 offen sc1
    s_waitcnt lgkmcnt(4)
    buffer_store_dwordx4 v[20:23], v4, s[32:35], s17 offen sc1
    s_waitcnt lgkmcnt(2)
    buffer_store_dwordx4 v[24:27], v7, s[32:35], s18 offen sc1
    s_waitcnt lgkmcnt(0)
    buffer_store_dwordx4 v[28:31], v4, s[32:35], s18 offen sc1
    s_lshl_b32 s50, s2, 7
    v_lshrrev_b32 v221, 3, v1
    v_lshlrev_b32 v221, 15, v221
    v_and_b32 v220, 7, v1
    v_cmp_gt_u32 vcc, 8, v1
    v_lshl_add_u32 v221, v220, 4, v221
    s_nop 0
    v_cndmask_b32 v220, 2.0, v221, vcc
    s_waitcnt vmcnt(0)
    s_barrier
    v_readfirstlane_b32 s51, v148
    s_mov_b32 s49, 0
KA_N:
    s_cmp_lg_u32 s51, 0
    s_cbranch_scc1 KA_G
    buffer_load_dword v148, v150, s[44:47], 0 offen sc1
    s_add_u32 s49, s49, 1
    s_waitcnt vmcnt(0)
    v_readfirstlane_b32 s51, v148
    s_cmp_lt_u32 s49, 0x40000
    s_cbranch_scc1 KA_N
KA_G:
    s_nop 1
    v_mov_b32 v216, s51
    v_mov_b32 v217, s51
    v_mov_b32 v218, s51
    v_mov_b32 v219, s51
    s_cmp_lg_u32 s3, 0
    s_cselect_b32 s50, 720896, s50
    buffer_store_dwordx4 v[216:219], v220, s[56:59], s50 offen sc1
    v_mul_u32_u24 v206, 6554, v1
    v_lshrrev_b32 v206, 16, v206
    v_mul_u32_u24 v206, 7936, v206
    v_cmp_gt_u32 vcc, 60, v1
    v_lshl_add_u32 v206, v1, 7, v206
    s_mul_i32 s60, s14, 9
    v_cndmask_b32 v206, 2.0, v206, vcc
    s_add_u32 s60, s60, 1
    s_lshr_b32 s60, s60, 1
    s_lshl_b32 s60, s60, 8
    s_cmp_eq_u32 s63, 1
    s_cbranch_scc1 K2_L1
    v_lshlrev_b32 v3, 4, v1
    s_load_dwordx2 s[6:7], s[0:1], 40
    s_load_dwordx4 s[44:47], s[0:1], 56
    v_and_b32 v4, 15, v1
    v_lshrrev_b32 v5, 4, v1
    v_lshlrev_b32 v6, 2, v4
    v_lshl_add_u32 v6, v5, 4, v6
    v_add_u32 v7, 4294967236, v6
    buffer_load_dword v8, v7, s[40:43], 0 offen
    v_add_u32 v7, 4294967240, v6
    buffer_load_dword v9, v7, s[40:43], 0 offen
    v_add_u32 v7, 4294967244, v6
    buffer_load_dword v10, v7, s[40:43], 0 offen
    v_add_u32 v7, 4294967248, v6
    buffer_load_dword v11, v7, s[40:43], 0 offen
    s_waitcnt lgkmcnt(0)
    s_cmp_ge_u32 s3, 2
    s_cselect_b32 s44, s46, s44
    s_cselect_b32 s45, s47, s45
    s_mov_b32 s46, 5308416
    s_mov_b32 s47, 0x00020000
    s_mov_b32 s28, s6
    s_mov_b32 s29, s7
    s_mov_b32 s30, 1152
    s_mov_b32 s31, 0x00020000
    s_lshl_b32 s16, s15, 1
    v_mov_b32 v7, s16
    buffer_load_ushort v16, v7, s[28:31], 0 offen
    s_add_u32 m0, s62, 13440
    s_nop 0
    buffer_load_dwordx4 v3, s[40:43], 8 offen offset:0 lds
    buffer_load_dwordx4 v3, s[40:43], 8 offen offset:1024 lds
    buffer_load_dwordx4 v3, s[40:43], 8 offen offset:2048 lds
    buffer_load_dwordx4 v3, s[40:43], 8 offen offset:3072 lds
    s_branch K2_LX
K2_L1:
    s_load_dwordx4 s[44:47], s[0:1], 56
    s_load_dwordx2 s[6:7], s[0:1], 88
    s_and_b32 s9, s3, 1
    s_waitcnt lgkmcnt(0)
    s_cmp_ge_u32 s3, 2
    s_cselect_b32 s44, s46, s44
    s_cselect_b32 s45, s47, s45
    s_mov_b32 s46, 5308416
    s_mov_b32 s47, 0x00020000
    s_cmp_ge_u32 s12, 54
    s_cbranch_scc1 K2_L2
    s_load_dwordx4 s[4:7], s[0:1], 80
    v_and_b32 v24, 7, v0
    v_lshrrev_b32 v25, 3, v0
    v_mul_u32_u24 v3, 124416, v25
    v_lshl_add_u32 v3, v24, 4, v3
    s_lshl_b32 s13, s12, 7
    v_add_u32 v3, s13, v3
    v_mul_u32_u24 v4, 36, v25
    s_waitcnt lgkmcnt(0)
    s_mov_b32 s20, s4
    s_mov_b32 s21, s5
    s_mov_b32 s22, 1152
    s_mov_b32 s23, 0x00020000
    s_mov_b32 s24, s6
    s_mov_b32 s25, s7
    s_mov_b32 s26, 3981312
    s_mov_b32 s27, 0x00020000
    buffer_load_dwordx4 v[170:173], v4, s[20:23], 0 offen
    buffer_load_dwordx4 v[174:177], v4, s[20:23], 0 offen offset:16
    buffer_load_dword v178, v4, s[20:23], 0 offen offset:32
    s_mov_b32 s14, 0
    buffer_load_dwordx4 v[28:31], v3, s[24:27], s14 offen
    s_mov_b32 s14, 6912
    buffer_load_dwordx4 v[32:35], v3, s[24:27], s14 offen
    s_mov_b32 s14, 13824
    buffer_load_dwordx4 v[36:39], v3, s[24:27], s14 offen
    s_mov_b32 s14, 20736
    buffer_load_dwordx4 v[40:43], v3, s[24:27], s14 offen
    s_mov_b32 s14, 27648
    buffer_load_dwordx4 v[44:47], v3, s[24:27], s14 offen
    s_mov_b32 s14, 34560
    buffer_load_dwordx4 v[48:51], v3, s[24:27], s14 offen
    s_mov_b32 s14, 41472
    buffer_load_dwordx4 v[52:55], v3, s[24:27], s14 offen
    s_mov_b32 s14, 48384
    buffer_load_dwordx4 v[56:59], v3, s[24:27], s14 offen
    s_mov_b32 s14, 55296
    buffer_load_dwordx4 v[60:63], v3, s[24:27], s14 offen
    s_mov_b32 s14, 62208
    buffer_load_dwordx4 v[64:67], v3, s[24:27], s14 offen
    s_branch K2_LX
K2_L2:
    s_cmp_lt_u32 s12, 56
    s_cbranch_scc1 K2_LX
    v_lshrrev_b32 v2, 3, v0
    v_mul_u32_u24 v2, 18, v2
    v_and_b32 v3, 7, v0
    v_add3_u32 v2, v2, v3, 10
    v_mul_u32_u24 v2, 6912, v2
    s_sub_u32 s13, s12, 56
    s_lshl_b32 s14, s13, 7
    s_mov_b32 s24, s6
    s_mov_b32 s25, s7
    s_mov_b32 s26, 3981312
    s_mov_b32 s27, 0x00020000
    buffer_load_dword v213, v2, s[24:27], s14 offen
    s_lshr_b32 s13, s13, 3
    s_lshl_b32 s13, s13, 1
    s_add_u32 s13, s13, s9
    s_mul_i32 s13, s13, 55296
    s_add_u32 s13, s13, s60
    buffer_load_dword v214, v206, s[44:47], s13 offen
    s_add_u32 s13, s13, 774144
    buffer_load_dword v214, v206, s[44:47], s13 offen
    s_add_u32 s13, s13, 774144
    buffer_load_dword v214, v206, s[44:47], s13 offen
K2_LX:
    v_and_b32 v26, 7, v1
    v_lshlrev_b32 v26, 3, v26
    v_add_u32 v26, 147456, v26
    s_lshl_b32 s49, s3, 6
    v_add_u32 v27, s49, v26
    v_lshlrev_b32 v100, 16, v192
    v_and_b32 v101, 0xffff0000, v192
    v_lshlrev_b32 v102, 16, v193
    v_and_b32 v103, 0xffff0000, v193
    v_lshlrev_b32 v104, 16, v194
    v_and_b32 v105, 0xffff0000, v194
    v_lshlrev_b32 v106, 16, v195
    v_and_b32 v107, 0xffff0000, v195
    v_lshlrev_b32 v108, 16, v196
    v_and_b32 v109, 0xffff0000, v196
    v_lshlrev_b32 v110, 16, v197
    v_and_b32 v111, 0xffff0000, v197
    v_lshlrev_b32 v112, 16, v198
    v_and_b32 v113, 0xffff0000, v198
    v_lshlrev_b32 v114, 16, v199
    v_and_b32 v115, 0xffff0000, v199
    v_lshlrev_b32 v116, 16, v200
    v_and_b32 v117, 0xffff0000, v200
    v_lshlrev_b32 v118, 16, v201
    v_and_b32 v119, 0xffff0000, v201
    v_lshlrev_b32 v120, 16, v202
    v_and_b32 v121, 0xffff0000, v202
    v_lshlrev_b32 v122, 16, v203
    v_and_b32 v123, 0xffff0000, v203
    v_pk_add_f32 v[124:125], v[100:101], v[102:103]
    v_pk_add_f32 v[126:127], v[104:105], v[106:107]
    v_pk_add_f32 v[124:125], v[124:125], v[126:127]
    v_add_f32 v152, v124, v125
    v_pk_add_f32 v[124:125], v[108:109], v[110:111]
    v_pk_add_f32 v[126:127], v[112:113], v[114:115]
    v_pk_add_f32 v[124:125], v[124:125], v[126:127]
    v_add_f32 v154, v124, v125
    v_pk_add_f32 v[124:125], v[116:117], v[118:119]
    v_pk_add_f32 v[126:127], v[120:121], v[122:123]
    v_pk_add_f32 v[124:125], v[124:125], v[126:127]
    v_add_f32 v156, v124, v125
    v_add_f32_dpp v152, v152, v152 row_ror:8 row_mask:0xf bank_mask:0xf
    v_add_f32_dpp v154, v154, v154 row_ror:8 row_mask:0xf bank_mask:0xf
    v_add_f32_dpp v156, v156, v156 row_ror:8 row_mask:0xf bank_mask:0xf
    v_mov_b32 v140, v152
    v_mov_b32 v141, v154
    v_mov_b32 v142, v156
    v_permlane16_swap_b32 v152, v140
    v_permlane16_swap_b32 v154, v141
    v_permlane16_swap_b32 v156, v142
    v_add_f32 v152, v152, v140
    v_add_f32 v154, v154, v141
    v_add_f32 v156, v156, v142
    v_mov_b32 v140, v152
    v_mov_b32 v141, v154
    v_mov_b32 v142, v156
    v_permlane32_swap_b32 v152, v140
    v_permlane32_swap_b32 v154, v141
    v_permlane32_swap_b32 v156, v142
    v_add_f32 v152, v152, v140
    v_add_f32 v154, v154, v141
    v_add_f32 v156, v156, v142
    v_mul_f32 v152, 0xbc800000, v152
    v_mul_f32 v154, 0xbc800000, v154
    v_mul_f32 v156, 0xbc800000, v156
    v_pk_add_f32 v[124:125], v[100:101], v[152:153] op_sel_hi:[1,0]
    v_pk_add_f32 v[126:127], v[102:103], v[152:153] op_sel_hi:[1,0]
    v_pk_add_f32 v[128:129], v[104:105], v[152:153] op_sel_hi:[1,0]
    v_pk_add_f32 v[130:131], v[106:107], v[152:153] op_sel_hi:[1,0]
    v_pk_mul_f32 v[124:125], v[124:125], v[124:125]
    v_pk_fma_f32 v[124:125], v[126:127], v[126:127], v[124:125]
    v_pk_fma_f32 v[124:125], v[128:129], v[128:129], v[124:125]
    v_pk_fma_f32 v[124:125], v[130:131], v[130:131], v[124:125]
    v_add_f32 v153, v124, v125
    v_pk_add_f32 v[124:125], v[108:109], v[154:155] op_sel_hi:[1,0]
    v_pk_add_f32 v[126:127], v[110:111], v[154:155] op_sel_hi:[1,0]
    v_pk_add_f32 v[128:129], v[112:113], v[154:155] op_sel_hi:[1,0]
    v_pk_add_f32 v[130:131], v[114:115], v[154:155] op_sel_hi:[1,0]
    v_pk_mul_f32 v[124:125], v[124:125], v[124:125]
    v_pk_fma_f32 v[124:125], v[126:127], v[126:127], v[124:125]
    v_pk_fma_f32 v[124:125], v[128:129], v[128:129], v[124:125]
    v_pk_fma_f32 v[124:125], v[130:131], v[130:131], v[124:125]
    v_add_f32 v155, v124, v125
    v_pk_add_f32 v[124:125], v[116:117], v[156:157] op_sel_hi:[1,0]
    v_pk_add_f32 v[126:127], v[118:119], v[156:157] op_sel_hi:[1,0]
    v_pk_add_f32 v[128:129], v[120:121], v[156:157] op_sel_hi:[1,0]
    v_pk_add_f32 v[130:131], v[122:123], v[156:157] op_sel_hi:[1,0]
    v_pk_mul_f32 v[124:125], v[124:125], v[124:125]
    v_pk_fma_f32 v[124:125], v[126:127], v[126:127], v[124:125]
    v_pk_fma_f32 v[124:125], v[128:129], v[128:129], v[124:125]
    v_pk_fma_f32 v[124:125], v[130:131], v[130:131], v[124:125]
    v_add_f32 v157, v124, v125
    v_add_f32_dpp v153, v153, v153 row_ror:8 row_mask:0xf bank_mask:0xf
    v_add_f32_dpp v155, v155, v155 row_ror:8 row_mask:0xf bank_mask:0xf
    v_add_f32_dpp v157, v157, v157 row_ror:8 row_mask:0xf bank_mask:0xf
    v_mov_b32 v140, v153
    v_mov_b32 v141, v155
    v_mov_b32 v142, v157
    v_permlane16_swap_b32 v153, v140
    v_permlane16_swap_b32 v155, v141
    v_permlane16_swap_b32 v157, v142
    v_add_f32 v153, v153, v140
    v_add_f32 v155, v155, v141
    v_add_f32 v157, v157, v142
    v_mov_b32 v140, v153
    v_mov_b32 v141, v155
    v_mov_b32 v142, v157
    v_permlane32_swap_b32 v153, v140
    v_permlane32_swap_b32 v155, v141
    v_permlane32_swap_b32 v157, v142
    v_add_f32 v153, v153, v140
    v_add_f32 v155, v155, v141
    v_add_f32 v157, v157, v142
    ds_write_b64 v27, v[152:153]
    ds_write_b64 v27, v[154:155] offset:256
    ds_write_b64 v27, v[156:157] offset:512
    s_waitcnt lgkmcnt(0)
    s_barrier
    ds_read_b64 v[152:153], v26 offset:0
    ds_read_b64 v[154:155], v26 offset:64
    ds_read_b64 v[156:157], v26 offset:128
    ds_read_b64 v[158:159], v26 offset:192
    ds_read_b64 v[160:161], v26 offset:256
    ds_read_b64 v[162:163], v26 offset:320
    ds_read_b64 v[164:165], v26 offset:384
    ds_read_b64 v[166:167], v26 offset:448
    ds_read_b64 v[168:169], v26 offset:512
    s_waitcnt lgkmcnt(0)
    v_pk_add_f32 v[204:205], v[152:153], v[154:155]
    v_pk_add_f32 v[124:125], v[156:157], v[158:159]
    v_pk_add_f32 v[126:127], v[160:161], v[162:163]
    v_pk_add_f32 v[128:129], v[164:165], v[166:167]
    v_pk_add_f32 v[204:205], v[204:205], v[168:169]
    v_pk_add_f32 v[124:125], v[124:125], v[126:127]
    v_pk_add_f32 v[204:205], v[204:205], v[128:129]
    v_pk_add_f32 v[204:205], v[204:205], v[124:125]
    v_mul_f32 v204, 0x3de38e39, v204
    v_sub_f32 v152, v152, v204
    v_sub_f32 v154, v154, v204
    v_sub_f32 v156, v156, v204
    v_sub_f32 v158, v158, v204
    v_sub_f32 v160, v160, v204
    v_sub_f32 v162, v162, v204
    v_sub_f32 v164, v164, v204
    v_sub_f32 v166, v166, v204
    v_sub_f32 v168, v168, v204
    v_mul_f32 v150, v152, v152
    v_mul_f32 v124, v154, v154
    v_fmac_f32 v150, v156, v156
    v_fmac_f32 v124, v158, v158
    v_fmac_f32 v150, v160, v160
    v_fmac_f32 v124, v162, v162
    v_fmac_f32 v150, v164, v164
    v_fmac_f32 v124, v166, v166
    v_fmac_f32 v150, v168, v168
    v_add_f32 v150, v150, v124
    v_fmac_f32 v205, 0x42800000, v150
    v_mov_b32 v150, 0x3727c5ac
    v_fmac_f32 v150, 0x3ae38e39, v205
    v_rsq_f32 v205, v150
    s_cmp_eq_u32 s63, 1
    s_cbranch_scc1 K2_SPARE
    s_add_u32 m0, s62, 17600
    s_nop 0
    buffer_load_dwordx4 v3, s[40:43], 12 offen offset:0 lds
    buffer_load_dwordx4 v3, s[40:43], 12 offen offset:1024 lds
    buffer_load_dwordx4 v3, s[40:43], 12 offen offset:2048 lds
    buffer_load_dwordx4 v3, s[40:43], 12 offen offset:3072 lds
    s_add_u32 m0, s62, 21760
    s_nop 0
    buffer_load_dwordx4 v3, s[40:43], 16 offen offset:0 lds
    buffer_load_dwordx4 v3, s[40:43], 16 offen offset:1024 lds
    buffer_load_dwordx4 v3, s[40:43], 16 offen offset:2048 lds
    buffer_load_dwordx4 v3, s[40:43], 16 offen offset:3072 lds
    s_mov_b32 s13, s62
    s_mul_i32 s48, s15, 8448
    s_add_u32 s20, s10, s48
    s_addc_u32 s21, s11, 0
    s_mov_b32 s22, 4096
    s_mov_b32 s23, 0x00020000
    s_add_u32 s24, s20, 4224
    s_addc_u32 s25, s21, 0
    s_mov_b32 s26, 4096
    s_mov_b32 s27, 0x00020000
    s_add_u32 s32, s10, 0x4d0000
    s_addc_u32 s33, s11, 0
    s_mov_b32 s34, 0x240000
    s_mov_b32 s35, 0x00020000
    s_lshl_b32 s50, s14, 12
    s_lshl_b32 s49, s3, 10
    s_add_u32 s50, s50, s49
    v_lshlrev_b32 v7, 7, v1
    v_cmp_gt_u32 vcc, 8, v1
    s_nop 1
    v_cndmask_b32 v7, 2.0, v7, vcc
    s_mov_b32 s19, 0
KA_POLL:
    buffer_load_dword v25, v7, s[56:59], s50 offen sc1
    s_add_u32 s19, s19, 1
    s_waitcnt vmcnt(0)
    v_cmp_eq_u32 vcc, s51, v25
    s_cmp_gt_u32 s19, 0x40000
    s_cbranch_scc1 KA_POLL_X
    s_bcnt1_i32_b64 s61, vcc
    s_cmp_lt_u32 s61, 8
    s_cbranch_scc1 KA_POLL
KA_POLL_X:
    s_barrier
    s_add_u32 m0, s13, 4640
    s_nop 0
    buffer_load_dwordx4 v3, s[20:23], 0 offen offset:0 lds
    buffer_load_dwordx4 v3, s[20:23], 0 offen offset:1024 lds
    buffer_load_dwordx4 v3, s[20:23], 0 offen offset:2048 lds
    buffer_load_dwordx4 v3, s[20:23], 0 offen offset:3072 lds
    s_add_u32 m0, s13, 0
    s_nop 0
    buffer_load_dwordx4 v3, s[24:27], 0 offen offset:0 lds
    buffer_load_dwordx4 v3, s[24:27], 0 offen offset:1024 lds
    buffer_load_dwordx4 v3, s[24:27], 0 offen offset:2048 lds
    buffer_load_dwordx4 v3, s[24:27], 0 offen offset:3072 lds
    v_mov_b32 v20, 0
    v_mov_b32 v21, 0
    v_mov_b32 v22, 0
    v_mov_b32 v23, 0
    v_add_u32 v7, s13, v3
    s_mov_b64 exec, 0xfffffff
    ds_write_b128 v7, v[20:23] offset:4096
    ds_write_b128 v7, v[20:23] offset:8736
    s_mov_b64 exec, -1
    v_and_b32 v7, 1, v4
    v_mul_u32_u24 v17, 4640, v7
    v_lshrrev_b32 v7, 1, v4
    v_lshlrev_b32 v7, 6, v7
    v_sub_u32 v17, v17, v7
    v_lshl_add_u32 v17, v5, 4, v17
    s_add_u32 s16, s13, 448
    v_add_u32 v17, s16, v17
    v_and_b32 v7, 3, v4
    v_mul_u32_u24 v18, 4160, v7
    v_lshrrev_b32 v7, 2, v4
    v_add_u32 v7, v7, v5
    v_lshl_add_u32 v18, v7, 4, v18
    s_add_u32 s16, s13, 9280
    v_add_u32 v18, s16, v18
    v_lshlrev_b32 v7, 7, v5
    v_lshl_add_u32 v7, v4, 2, v7
    s_add_u32 s16, s13, 5084
    v_sub_u32 v19, s16, v7
    v_lshlrev_b32 v24, 9, v5
    v_bfe_u32 v7, v4, 3, 1
    v_lshl_add_u32 v24, v7, 7, v24
    v_and_b32 v7, 7, v4
    v_lshl_add_u32 v24, v7, 2, v24
    s_lshl_b32 s16, s3, 5
    s_add_u32 s16, s16, 108032
    v_add_u32 v24, s16, v24
    v_lshlrev_b32 v16, 16, v16
    s_mul_i32 s16, s14, 18
    s_sub_u32 s16, s12, s16
    s_lshl_b32 s16, s16, 1
    s_and_b32 s9, s3, 1
    s_add_u32 s16, s16, s9
    s_mul_i32 s16, s16, 55296
    s_add_u32 s16, s16, 2322432
    s_add_u32 s16, s16, s60
    s_waitcnt vmcnt(0) lgkmcnt(0)
    ds_read_b128 v[64:67], v17 offset:3584
    ds_read_b128 v[68:71], v17 offset:3072
    ds_read_b128 v[100:103], v18 offset:448
    ds_read_b128 v[72:75], v17 offset:2560
    ds_read_b128 v[104:107], v18 offset:960
    ds_read_b128 v[76:79], v17 offset:2048
    ds_read_b128 v[108:111], v18 offset:1472
    ds_read_b128 v[80:83], v17 offset:1536
    ds_read_b128 v[112:115], v18 offset:1984
    ds_read_b128 v[84:87], v17 offset:1024
    ds_read_b128 v[116:119], v18 offset:2496
    ds_read_b128 v[88:91], v17 offset:512
    ds_read_b128 v[120:123], v18 offset:3008
    ds_read_b128 v[92:95], v17 offset:0
    ds_read_b128 v[124:127], v18 offset:3520
    s_waitcnt lgkmcnt(14)
    v_mfma_f32_16x16x32_bf16 v[32:35], v[64:67], v[8:11], 0
    s_waitcnt lgkmcnt(12)
    v_mfma_f32_16x16x32_bf16 v[36:39], v[64:67], v[100:103], 0
    v_mfma_f32_16x16x32_bf16 v[36:39], v[68:71], v[8:11], v[36:39]
    ds_read_b128 v[128:131], v17 offset:3648
    v_mfma_f32_16x16x32_bf16 v[40:43], v[68:71], v[100:103], 0
    s_waitcnt lgkmcnt(11)
    v_mfma_f32_16x16x32_bf16 v[40:43], v[64:67], v[104:107], v[40:43]
    ds_read_b128 v[160:163], v18 offset:0
    v_mfma_f32_16x16x32_bf16 v[40:43], v[72:75], v[8:11], v[40:43]
    v_mfma_f32_16x16x32_bf16 v[44:47], v[68:71], v[104:107], 0
    ds_read_b128 v[132:135], v17 offset:3136
    v_mfma_f32_16x16x32_bf16 v[44:47], v[72:75], v[100:103], v[44:47]
    v_mfma_f32_16x16x32_bf16 v[48:51], v[72:75], v[104:107], 0
    ds_read_b128 v[164:167], v18 offset:512
    s_waitcnt lgkmcnt(12)
    v_mfma_f32_16x16x32_bf16 v[44:47], v[64:67], v[108:111], v[44:47]
    v_mfma_f32_16x16x32_bf16 v[44:47], v[76:79], v[8:11], v[44:47]
    ds_read_b128 v[136:139], v17 offset:2624
    v_mfma_f32_16x16x32_bf16 v[48:51], v[68:71], v[108:111], v[48:51]
    v_mfma_f32_16x16x32_bf16 v[48:51], v[76:79], v[100:103], v[48:51]
    ds_read_b128 v[168:171], v18 offset:1024
    v_mfma_f32_16x16x32_bf16 v[52:55], v[72:75], v[108:111], 0
    v_mfma_f32_16x16x32_bf16 v[52:55], v[76:79], v[104:107], v[52:55]
    ds_read_b128 v[140:143], v17 offset:2112
    v_mfma_f32_16x16x32_bf16 v[56:59], v[76:79], v[108:111], 0
    s_waitcnt lgkmcnt(13)
    v_mfma_f32_16x16x32_bf16 v[48:51], v[64:67], v[112:115], v[48:51]
    ds_read_b128 v[172:175], v18 offset:1536
    v_mfma_f32_16x16x32_bf16 v[48:51], v[80:83], v[8:11], v[48:51]
    v_mfma_f32_16x16x32_bf16 v[52:55], v[68:71], v[112:115], v[52:55]
    ds_read_b128 v[144:147], v17 offset:1600
    v_mfma_f32_16x16x32_bf16 v[52:55], v[80:83], v[100:103], v[52:55]
    v_mfma_f32_16x16x32_bf16 v[56:59], v[72:75], v[112:115], v[56:59]
    ds_read_b128 v[176:179], v18 offset:2048
    v_mfma_f32_16x16x32_bf16 v[56:59], v[80:83], v[104:107], v[56:59]
    v_mfma_f32_16x16x32_bf16 v[60:63], v[76:79], v[112:115], 0
    ds_read_b128 v[148:151], v17 offset:1088
    v_mfma_f32_16x16x32_bf16 v[60:63], v[80:83], v[108:111], v[60:63]
    s_waitcnt lgkmcnt(15)
    v_mfma_f32_16x16x32_bf16 v[52:55], v[64:67], v[116:119], v[52:55]
    ds_read_b128 v[180:183], v18 offset:2560
    v_mfma_f32_16x16x32_bf16 v[52:55], v[84:87], v[8:11], v[52:55]
    v_mfma_f32_16x16x32_bf16 v[56:59], v[68:71], v[116:119], v[56:59]
    ds_read_b128 v[152:155], v17 offset:576
    v_mfma_f32_16x16x32_bf16 v[56:59], v[84:87], v[100:103], v[56:59]
    v_mfma_f32_16x16x32_bf16 v[60:63], v[72:75], v[116:119], v[60:63]
    ds_read_b128 v[184:187], v18 offset:3072
    v_mfma_f32_16x16x32_bf16 v[60:63], v[84:87], v[104:107], v[60:63]
    s_waitcnt lgkmcnt(15)
    v_mfma_f32_16x16x32_bf16 v[56:59], v[64:67], v[120:123], v[56:59]
    ds_read_b128 v[156:159], v17 offset:64
    v_mfma_f32_16x16x32_bf16 v[56:59], v[88:91], v[8:11], v[56:59]
    v_mfma_f32_16x16x32_bf16 v[60:63], v[68:71], v[120:123], v[60:63]
    ds_read_b128 v[188:191], v18 offset:3584
    v_mfma_f32_16x16x32_bf16 v[60:63], v[88:91], v[100:103], v[60:63]
    s_waitcnt lgkmcnt(15)
    v_mfma_f32_16x16x32_bf16 v[60:63], v[64:67], v[124:127], v[60:63]
    v_mfma_f32_16x16x32_bf16 v[60:63], v[92:95], v[8:11], v[60:63]
    s_waitcnt lgkmcnt(14)
    v_mfma_f32_16x16x32_bf16 v[32:35], v[128:131], v[160:163], v[32:35]
    s_waitcnt lgkmcnt(12)
    v_mfma_f32_16x16x32_bf16 v[36:39], v[128:131], v[164:167], v[36:39]
    v_mfma_f32_16x16x32_bf16 v[36:39], v[132:135], v[160:163], v[36:39]
    ds_read_b128 v[64:67], v17 offset:3712
    v_mfma_f32_16x16x32_bf16 v[40:43], v[132:135], v[164:167], v[40:43]
    s_waitcnt lgkmcnt(11)
    v_mfma_f32_16x16x32_bf16 v[40:43], v[128:131], v[168:171], v[40:43]
    ds_read_b128 v[96:99], v18 offset:64
    v_mfma_f32_16x16x32_bf16 v[40:43], v[136:139], v[160:163], v[40:43]
    v_mfma_f32_16x16x32_bf16 v[44:47], v[132:135], v[168:171], v[44:47]
    ds_read_b128 v[68:71], v17 offset:3200
    v_mfma_f32_16x16x32_bf16 v[44:47], v[136:139], v[164:167], v[44:47]
    v_mfma_f32_16x16x32_bf16 v[48:51], v[136:139], v[168:171], v[48:51]
    ds_read_b128 v[100:103], v18 offset:576
    s_waitcnt lgkmcnt(12)
    v_mfma_f32_16x16x32_bf16 v[44:47], v[128:131], v[172:175], v[44:47]
    v_mfma_f32_16x16x32_bf16 v[44:47], v[140:143], v[160:163], v[44:47]
    ds_read_b128 v[72:75], v17 offset:2688
    v_mfma_f32_16x16x32_bf16 v[48:51], v[132:135], v[172:175], v[48:51]
    v_mfma_f32_16x16x32_bf16 v[48:51], v[140:143], v[164:167], v[48:51]
    ds_read_b128 v[104:107], v18 offset:1088
    v_mfma_f32_16x16x32_bf16 v[52:55], v[136:139], v[172:175], v[52:55]
    v_mfma_f32_16x16x32_bf16 v[52:55], v[140:143], v[168:171], v[52:55]
    ds_read_b128 v[76:79], v17 offset:2176
    v_mfma_f32_16x16x32_bf16 v[56:59], v[140:143], v[172:175], v[56:59]
    s_waitcnt lgkmcnt(13)
    v_mfma_f32_16x16x32_bf16 v[48:51], v[128:131], v[176:179], v[48:51]
    ds_read_b128 v[108:111], v18 offset:1600
    v_mfma_f32_16x16x32_bf16 v[48:51], v[144:147], v[160:163], v[48:51]
    v_mfma_f32_16x16x32_bf16 v[52:55], v[132:135], v[176:179], v[52:55]
    ds_read_b128 v[80:83], v17 offset:1664
    v_mfma_f32_16x16x32_bf16 v[52:55], v[144:147], v[164:167], v[52:55]
    v_mfma_f32_16x16x32_bf16 v[56:59], v[136:139], v[176:179], v[56:59]
    ds_read_b128 v[112:115], v18 offset:2112
    v_mfma_f32_16x16x32_bf16 v[56:59], v[144:147], v[168:171], v[56:59]
    v_mfma_f32_16x16x32_bf16 v[60:63], v[140:143], v[176:179], v[60:63]
    ds_read_b128 v[84:87], v17 offset:1152
    v_mfma_f32_16x16x32_bf16 v[60:63], v[144:147], v[172:175], v[60:63]
    s_waitcnt lgkmcnt(15)
    v_mfma_f32_16x16x32_bf16 v[52:55], v[128:131], v[180:183], v[52:55]
    ds_read_b128 v[116:119], v18 offset:2624
    v_mfma_f32_16x16x32_bf16 v[52:55], v[148:151], v[160:163], v[52:55]
    v_mfma_f32_16x16x32_bf16 v[56:59], v[132:135], v[180:183], v[56:59]
    ds_read_b128 v[88:91], v17 offset:640
    v_mfma_f32_16x16x32_bf16 v[56:59], v[148:151], v[164:167], v[56:59]
    v_mfma_f32_16x16x32_bf16 v[60:63], v[136:139], v[180:183], v[60:63]
    ds_read_b128 v[120:123], v18 offset:3136
    v_mfma_f32_16x16x32_bf16 v[60:63], v[148:151], v[168:171], v[60:63]
    s_waitcnt lgkmcnt(15)
    v_mfma_f32_16x16x32_bf16 v[56:59], v[128:131], v[184:187], v[56:59]
    ds_read_b128 v[92:95], v17 offset:128
    v_mfma_f32_16x16x32_bf16 v[56:59], v[152:155], v[160:163], v[56:59]
    v_mfma_f32_16x16x32_bf16 v[60:63], v[132:135], v[184:187], v[60:63]
    ds_read_b128 v[124:127], v18 offset:3648
    v_mfma_f32_16x16x32_bf16 v[60:63], v[152:155], v[164:167], v[60:63]
    s_waitcnt lgkmcnt(15)
    v_mfma_f32_16x16x32_bf16 v[60:63], v[128:131], v[188:191], v[60:63]
    v_mfma_f32_16x16x32_bf16 v[60:63], v[156:159], v[160:163], v[60:63]
    buffer_load_dword v207, v206, s[44:47], s16 offen
    s_waitcnt lgkmcnt(14)
    v_mfma_f32_16x16x32_bf16 v[32:35], v[64:67], v[96:99], v[32:35]
    s_waitcnt lgkmcnt(12)
    v_mfma_f32_16x16x32_bf16 v[36:39], v[64:67], v[100:103], v[36:39]
    ds_read_b32 v224, v19 offset:3648
    v_mfma_f32_16x16x32_bf16 v[36:39], v[68:71], v[96:99], v[36:39]
    ds_read_b128 v[128:131], v17 offset:3776
    v_mfma_f32_16x16x32_bf16 v[40:43], v[68:71], v[100:103], v[40:43]
    ds_read_b32 v226, v19 offset:3584
    s_waitcnt lgkmcnt(13)
    v_mfma_f32_16x16x32_bf16 v[40:43], v[64:67], v[104:107], v[40:43]
    ds_read_b128 v[160:163], v18 offset:128
    v_mfma_f32_16x16x32_bf16 v[40:43], v[72:75], v[96:99], v[40:43]
    ds_read_b32 v228, v19 offset:3136
    v_mfma_f32_16x16x32_bf16 v[44:47], v[68:71], v[104:107], v[44:47]
    ds_read_b128 v[132:135], v17 offset:3264
    v_mfma_f32_16x16x32_bf16 v[44:47], v[72:75], v[100:103], v[44:47]
    ds_read_b32 v230, v19 offset:3072
    v_mfma_f32_16x16x32_bf16 v[48:51], v[72:75], v[104:107], v[48:51]
    ds_read_b128 v[164:167], v18 offset:640
    s_waitcnt lgkmcnt(15)
    v_mfma_f32_16x16x32_bf16 v[44:47], v[64:67], v[108:111], v[44:47]
    ds_read_b32 v232, v19 offset:2624
    v_mfma_f32_16x16x32_bf16 v[44:47], v[76:79], v[96:99], v[44:47]
    ds_read_b128 v[136:139], v17 offset:2752
    v_mfma_f32_16x16x32_bf16 v[48:51], v[68:71], v[108:111], v[48:51]
    ds_read_b32 v234, v19 offset:2560
    v_mfma_f32_16x16x32_bf16 v[48:51], v[76:79], v[100:103], v[48:51]
    ds_read_b128 v[168:171], v18 offset:1152
    v_mfma_f32_16x16x32_bf16 v[52:55], v[72:75], v[108:111], v[52:55]
    ds_read_b32 v236, v19 offset:2112
    v_mfma_f32_16x16x32_bf16 v[52:55], v[76:79], v[104:107], v[52:55]
    ds_read_b128 v[140:143], v17 offset:2240
    v_mfma_f32_16x16x32_bf16 v[56:59], v[76:79], v[108:111], v[56:59]
    ds_read_b32 v238, v19 offset:2048
    s_waitcnt lgkmcnt(15)
    v_mfma_f32_16x16x32_bf16 v[48:51], v[64:67], v[112:115], v[48:51]
    ds_read_b128 v[172:175], v18 offset:1664
    v_mfma_f32_16x16x32_bf16 v[48:51], v[80:83], v[96:99], v[48:51]
    ds_read_b32 v240, v19 offset:1600
    v_mfma_f32_16x16x32_bf16 v[52:55], v[68:71], v[112:115], v[52:55]
    ds_read_b128 v[144:147], v17 offset:1728
    v_mfma_f32_16x16x32_bf16 v[52:55], v[80:83], v[100:103], v[52:55]
    ds_read_b32 v242, v19 offset:1536
    v_mfma_f32_16x16x32_bf16 v[56:59], v[72:75], v[112:115], v[56:59]
    ds_read_b128 v[176:179], v18 offset:2176
    v_mfma_f32_16x16x32_bf16 v[56:59], v[80:83], v[104:107], v[56:59]
    ds_read_b32 v244, v19 offset:1088
    v_mfma_f32_16x16x32_bf16 v[60:63], v[76:79], v[112:115], v[60:63]
    ds_read_b128 v[148:151], v17 offset:1216
    v_mfma_f32_16x16x32_bf16 v[60:63], v[80:83], v[108:111], v[60:63]
    ds_read_b32 v246, v19 offset:1024
    v_mfma_f32_16x16x32_bf16 v[52:55], v[64:67], v[116:119], v[52:55]
    ds_read_b128 v[180:183], v18 offset:2688
    v_mfma_f32_16x16x32_bf16 v[52:55], v[84:87], v[96:99], v[52:55]
    ds_read_b32 v248, v19 offset:576
    v_mfma_f32_16x16x32_bf16 v[56:59], v[68:71], v[116:119], v[56:59]
    ds_read_b128 v[152:155], v17 offset:704
    v_mfma_f32_16x16x32_bf16 v[56:59], v[84:87], v[100:103], v[56:59]
    ds_read_b32 v250, v19 offset:512
    v_mfma_f32_16x16x32_bf16 v[60:63], v[72:75], v[116:119], v[60:63]
    ds_read_b128 v[184:187], v18 offset:3200
    v_mfma_f32_16x16x32_bf16 v[60:63], v[84:87], v[104:107], v[60:63]
    ds_read_b32 v252, v19 offset:64
    v_mfma_f32_16x16x32_bf16 v[56:59], v[64:67], v[120:123], v[56:59]
    ds_read_b128 v[156:159], v17 offset:192
    v_mfma_f32_16x16x32_bf16 v[56:59], v[88:91], v[96:99], v[56:59]
    ds_read_b32 v254, v19 offset:0
    v_mfma_f32_16x16x32_bf16 v[60:63], v[68:71], v[120:123], v[60:63]
    ds_read_b128 v[188:191], v18 offset:3712
    v_mfma_f32_16x16x32_bf16 v[60:63], v[88:91], v[100:103], v[60:63]
    v_mfma_f32_16x16x32_bf16 v[60:63], v[64:67], v[124:127], v[60:63]
    v_mfma_f32_16x16x32_bf16 v[60:63], v[92:95], v[96:99], v[60:63]
    s_waitcnt lgkmcnt(15)
    v_mfma_f32_16x16x32_bf16 v[32:35], v[128:131], v[160:163], v[32:35]
    v_mfma_f32_16x16x32_bf16 v[36:39], v[128:131], v[164:167], v[36:39]
    v_mfma_f32_16x16x32_bf16 v[36:39], v[132:135], v[160:163], v[36:39]
    ds_read_b128 v[64:67], v17 offset:3840
    v_mfma_f32_16x16x32_bf16 v[40:43], v[132:135], v[164:167], v[40:43]
    v_mfma_f32_16x16x32_bf16 v[40:43], v[128:131], v[168:171], v[40:43]
    ds_read_b128 v[96:99], v18 offset:192
    v_mfma_f32_16x16x32_bf16 v[40:43], v[136:139], v[160:163], v[40:43]
    v_mfma_f32_16x16x32_bf16 v[44:47], v[132:135], v[168:171], v[44:47]
    ds_read_b128 v[68:71], v17 offset:3328
    v_mfma_f32_16x16x32_bf16 v[44:47], v[136:139], v[164:167], v[44:47]
    v_mfma_f32_16x16x32_bf16 v[48:51], v[136:139], v[168:171], v[48:51]
    ds_read_b128 v[100:103], v18 offset:704
    v_mfma_f32_16x16x32_bf16 v[44:47], v[128:131], v[172:175], v[44:47]
    v_mfma_f32_16x16x32_bf16 v[44:47], v[140:143], v[160:163], v[44:47]
    ds_read_b128 v[72:75], v17 offset:2816
    v_mfma_f32_16x16x32_bf16 v[48:51], v[132:135], v[172:175], v[48:51]
    v_mfma_f32_16x16x32_bf16 v[48:51], v[140:143], v[164:167], v[48:51]
    ds_read_b128 v[104:107], v18 offset:1216
    v_mfma_f32_16x16x32_bf16 v[52:55], v[136:139], v[172:175], v[52:55]
    v_mfma_f32_16x16x32_bf16 v[52:55], v[140:143], v[168:171], v[52:55]
    ds_read_b128 v[76:79], v17 offset:2304
    v_mfma_f32_16x16x32_bf16 v[56:59], v[140:143], v[172:175], v[56:59]
    s_waitcnt lgkmcnt(15)
    v_mfma_f32_16x16x32_bf16 v[48:51], v[128:131], v[176:179], v[48:51]
    ds_read_b128 v[108:111], v18 offset:1728
    v_mfma_f32_16x16x32_bf16 v[48:51], v[144:147], v[160:163], v[48:51]
    v_mfma_f32_16x16x32_bf16 v[52:55], v[132:135], v[176:179], v[52:55]
    ds_read_b128 v[80:83], v17 offset:1792
    v_mfma_f32_16x16x32_bf16 v[52:55], v[144:147], v[164:167], v[52:55]
    v_mfma_f32_16x16x32_bf16 v[56:59], v[136:139], v[176:179], v[56:59]
    ds_read_b128 v[112:115], v18 offset:2240
    v_mfma_f32_16x16x32_bf16 v[56:59], v[144:147], v[168:171], v[56:59]
    v_mfma_f32_16x16x32_bf16 v[60:63], v[140:143], v[176:179], v[60:63]
    ds_read_b128 v[84:87], v17 offset:1280
    v_mfma_f32_16x16x32_bf16 v[60:63], v[144:147], v[172:175], v[60:63]
    v_mfma_f32_16x16x32_bf16 v[52:55], v[128:131], v[180:183], v[52:55]
    ds_read_b128 v[116:119], v18 offset:2752
    v_mfma_f32_16x16x32_bf16 v[52:55], v[148:151], v[160:163], v[52:55]
    v_mfma_f32_16x16x32_bf16 v[56:59], v[132:135], v[180:183], v[56:59]
    ds_read_b128 v[88:91], v17 offset:768
    v_mfma_f32_16x16x32_bf16 v[56:59], v[148:151], v[164:167], v[56:59]
    v_mfma_f32_16x16x32_bf16 v[60:63], v[136:139], v[180:183], v[60:63]
    ds_read_b128 v[120:123], v18 offset:3264
    v_mfma_f32_16x16x32_bf16 v[60:63], v[148:151], v[168:171], v[60:63]
    s_waitcnt lgkmcnt(15)
    v_mfma_f32_16x16x32_bf16 v[56:59], v[128:131], v[184:187], v[56:59]
    ds_read_b128 v[92:95], v17 offset:256
    v_mfma_f32_16x16x32_bf16 v[56:59], v[152:155], v[160:163], v[56:59]
    v_mfma_f32_16x16x32_bf16 v[60:63], v[132:135], v[184:187], v[60:63]
    ds_read_b128 v[124:127], v18 offset:3776
    v_mfma_f32_16x16x32_bf16 v[60:63], v[152:155], v[164:167], v[60:63]
    s_waitcnt lgkmcnt(15)
    v_mfma_f32_16x16x32_bf16 v[60:63], v[128:131], v[188:191], v[60:63]
    v_mfma_f32_16x16x32_bf16 v[60:63], v[156:159], v[160:163], v[60:63]
    s_waitcnt lgkmcnt(14)
    v_mfma_f32_16x16x32_bf16 v[32:35], v[64:67], v[96:99], v[32:35]
    s_waitcnt lgkmcnt(12)
    v_mfma_f32_16x16x32_bf16 v[36:39], v[64:67], v[100:103], v[36:39]
    v_lshlrev_b32 v227, 16, v226
    v_mfma_f32_16x16x32_bf16 v[36:39], v[68:71], v[96:99], v[36:39]
    ds_read_b128 v[128:131], v17 offset:3904
    v_mfma_f32_16x16x32_bf16 v[40:43], v[68:71], v[100:103], v[40:43]
    v_and_b32 v226, 0xffff0000, v226
    s_waitcnt lgkmcnt(11)
    v_mfma_f32_16x16x32_bf16 v[40:43], v[64:67], v[104:107], v[40:43]
    ds_read_b128 v[160:163], v18 offset:256
    v_mfma_f32_16x16x32_bf16 v[40:43], v[72:75], v[96:99], v[40:43]
    v_lshlrev_b32 v225, 16, v224
    v_mfma_f32_16x16x32_bf16 v[44:47], v[68:71], v[104:107], v[44:47]
    ds_read_b128 v[132:135], v17 offset:3392
    v_mfma_f32_16x16x32_bf16 v[44:47], v[72:75], v[100:103], v[44:47]
    v_and_b32 v224, 0xffff0000, v224
    v_mfma_f32_16x16x32_bf16 v[48:51], v[72:75], v[104:107], v[48:51]
    ds_read_b128 v[164:167], v18 offset:768
    s_waitcnt lgkmcnt(12)
    v_mfma_f32_16x16x32_bf16 v[44:47], v[64:67], v[108:111], v[44:47]
    v_lshlrev_b32 v231, 16, v230
    v_mfma_f32_16x16x32_bf16 v[44:47], v[76:79], v[96:99], v[44:47]
    ds_read_b128 v[136:139], v17 offset:2880
    v_mfma_f32_16x16x32_bf16 v[48:51], v[68:71], v[108:111], v[48:51]
    v_and_b32 v230, 0xffff0000, v230
    v_mfma_f32_16x16x32_bf16 v[48:51], v[76:79], v[100:103], v[48:51]
    ds_read_b128 v[168:171], v18 offset:1280
    v_mfma_f32_16x16x32_bf16 v[52:55], v[72:75], v[108:111], v[52:55]
    v_lshlrev_b32 v229, 16, v228
    v_mfma_f32_16x16x32_bf16 v[52:55], v[76:79], v[104:107], v[52:55]
    ds_read_b128 v[140:143], v17 offset:2368
    v_mfma_f32_16x16x32_bf16 v[56:59], v[76:79], v[108:111], v[56:59]
    v_and_b32 v228, 0xffff0000, v228
    s_waitcnt lgkmcnt(13)
    v_mfma_f32_16x16x32_bf16 v[48:51], v[64:67], v[112:115], v[48:51]
    ds_read_b128 v[172:175], v18 offset:1792
    v_mfma_f32_16x16x32_bf16 v[48:51], v[80:83], v[96:99], v[48:51]
    v_lshlrev_b32 v235, 16, v234
    v_mfma_f32_16x16x32_bf16 v[52:55], v[68:71], v[112:115], v[52:55]
    ds_read_b128 v[144:147], v17 offset:1856
    v_mfma_f32_16x16x32_bf16 v[52:55], v[80:83], v[100:103], v[52:55]
    v_and_b32 v234, 0xffff0000, v234
    v_mfma_f32_16x16x32_bf16 v[56:59], v[72:75], v[112:115], v[56:59]
    ds_read_b128 v[176:179], v18 offset:2304
    v_mfma_f32_16x16x32_bf16 v[56:59], v[80:83], v[104:107], v[56:59]
    v_lshlrev_b32 v233, 16, v232
    v_mfma_f32_16x16x32_bf16 v[60:63], v[76:79], v[112:115], v[60:63]
    ds_read_b128 v[148:151], v17 offset:1344
    v_mfma_f32_16x16x32_bf16 v[60:63], v[80:83], v[108:111], v[60:63]
    v_and_b32 v232, 0xffff0000, v232
    s_waitcnt lgkmcnt(15)
    v_mfma_f32_16x16x32_bf16 v[52:55], v[64:67], v[116:119], v[52:55]
    ds_read_b128 v[180:183], v18 offset:2816
    v_mfma_f32_16x16x32_bf16 v[52:55], v[84:87], v[96:99], v[52:55]
    v_lshlrev_b32 v239, 16, v238
    v_mfma_f32_16x16x32_bf16 v[56:59], v[68:71], v[116:119], v[56:59]
    ds_read_b128 v[152:155], v17 offset:832
    v_mfma_f32_16x16x32_bf16 v[56:59], v[84:87], v[100:103], v[56:59]
    v_and_b32 v238, 0xffff0000, v238
    v_mfma_f32_16x16x32_bf16 v[60:63], v[72:75], v[116:119], v[60:63]
    ds_read_b128 v[184:187], v18 offset:3328
    v_mfma_f32_16x16x32_bf16 v[60:63], v[84:87], v[104:107], v[60:63]
    v_lshlrev_b32 v237, 16, v236
    s_waitcnt lgkmcnt(15)
    v_mfma_f32_16x16x32_bf16 v[56:59], v[64:67], v[120:123], v[56:59]
    ds_read_b128 v[156:159], v17 offset:320
    v_mfma_f32_16x16x32_bf16 v[56:59], v[88:91], v[96:99], v[56:59]
    v_and_b32 v236, 0xffff0000, v236
    v_mfma_f32_16x16x32_bf16 v[60:63], v[68:71], v[120:123], v[60:63]
    ds_read_b128 v[188:191], v18 offset:3840
    v_mfma_f32_16x16x32_bf16 v[60:63], v[88:91], v[100:103], v[60:63]
    v_lshlrev_b32 v243, 16, v242
    s_waitcnt lgkmcnt(15)
    v_mfma_f32_16x16x32_bf16 v[60:63], v[64:67], v[124:127], v[60:63]
    v_mfma_f32_16x16x32_bf16 v[60:63], v[92:95], v[96:99], v[60:63]
    v_and_b32 v242, 0xffff0000, v242
    s_waitcnt lgkmcnt(14)
    v_mfma_f32_16x16x32_bf16 v[32:35], v[128:131], v[160:163], v[32:35]
    s_waitcnt lgkmcnt(12)
    v_mfma_f32_16x16x32_bf16 v[36:39], v[128:131], v[164:167], v[36:39]
    v_lshlrev_b32 v241, 16, v240
    v_mfma_f32_16x16x32_bf16 v[36:39], v[132:135], v[160:163], v[36:39]
    ds_read_b128 v[64:67], v17 offset:3968
    v_mfma_f32_16x16x32_bf16 v[40:43], v[132:135], v[164:167], v[40:43]
    v_and_b32 v240, 0xffff0000, v240
    s_waitcnt lgkmcnt(11)
    v_mfma_f32_16x16x32_bf16 v[40:43], v[128:131], v[168:171], v[40:43]
    ds_read_b128 v[96:99], v18 offset:320
    v_mfma_f32_16x16x32_bf16 v[40:43], v[136:139], v[160:163], v[40:43]
    v_lshlrev_b32 v247, 16, v246
    v_mfma_f32_16x16x32_bf16 v[44:47], v[132:135], v[168:171], v[44:47]
    ds_read_b128 v[68:71], v17 offset:3456
    v_mfma_f32_16x16x32_bf16 v[44:47], v[136:139], v[164:167], v[44:47]
    v_and_b32 v246, 0xffff0000, v246
    v_mfma_f32_16x16x32_bf16 v[48:51], v[136:139], v[168:171], v[48:51]
    ds_read_b128 v[100:103], v18 offset:832
    s_waitcnt lgkmcnt(12)
    v_mfma_f32_16x16x32_bf16 v[44:47], v[128:131], v[172:175], v[44:47]
    v_lshlrev_b32 v245, 16, v244
    v_mfma_f32_16x16x32_bf16 v[44:47], v[140:143], v[160:163], v[44:47]
    ds_read_b128 v[72:75], v17 offset:2944
    v_mfma_f32_16x16x32_bf16 v[48:51], v[132:135], v[172:175], v[48:51]
    v_and_b32 v244, 0xffff0000, v244
    v_mfma_f32_16x16x32_bf16 v[48:51], v[140:143], v[164:167], v[48:51]
    ds_read_b128 v[104:107], v18 offset:1344
    v_mfma_f32_16x16x32_bf16 v[52:55], v[136:139], v[172:175], v[52:55]
    v_lshlrev_b32 v251, 16, v250
    v_mfma_f32_16x16x32_bf16 v[52:55], v[140:143], v[168:171], v[52:55]
    ds_read_b128 v[76:79], v17 offset:2432
    v_mfma_f32_16x16x32_bf16 v[56:59], v[140:143], v[172:175], v[56:59]
    v_and_b32 v250, 0xffff0000, v250
    s_waitcnt lgkmcnt(13)
    v_mfma_f32_16x16x32_bf16 v[48:51], v[128:131], v[176:179], v[48:51]
    ds_read_b128 v[108:111], v18 offset:1856
    v_mfma_f32_16x16x32_bf16 v[48:51], v[144:147], v[160:163], v[48:51]
    v_lshlrev_b32 v249, 16, v248
    v_mfma_f32_16x16x32_bf16 v[52:55], v[132:135], v[176:179], v[52:55]
    ds_read_b128 v[80:83], v17 offset:1920
    v_mfma_f32_16x16x32_bf16 v[52:55], v[144:147], v[164:167], v[52:55]
    v_and_b32 v248, 0xffff0000, v248
    v_mfma_f32_16x16x32_bf16 v[56:59], v[136:139], v[176:179], v[56:59]
    ds_read_b128 v[112:115], v18 offset:2368
    v_mfma_f32_16x16x32_bf16 v[56:59], v[144:147], v[168:171], v[56:59]
    v_lshlrev_b32 v255, 16, v254
    v_mfma_f32_16x16x32_bf16 v[60:63], v[140:143], v[176:179], v[60:63]
    ds_read_b128 v[84:87], v17 offset:1408
    v_mfma_f32_16x16x32_bf16 v[60:63], v[144:147], v[172:175], v[60:63]
    v_and_b32 v254, 0xffff0000, v254
    s_waitcnt lgkmcnt(15)
    v_mfma_f32_16x16x32_bf16 v[52:55], v[128:131], v[180:183], v[52:55]
    ds_read_b128 v[116:119], v18 offset:2880
    v_mfma_f32_16x16x32_bf16 v[52:55], v[148:151], v[160:163], v[52:55]
    v_lshlrev_b32 v253, 16, v252
    v_mfma_f32_16x16x32_bf16 v[56:59], v[132:135], v[180:183], v[56:59]
    ds_read_b128 v[88:91], v17 offset:896
    v_mfma_f32_16x16x32_bf16 v[56:59], v[148:151], v[164:167], v[56:59]
    v_and_b32 v252, 0xffff0000, v252
    v_mfma_f32_16x16x32_bf16 v[60:63], v[136:139], v[180:183], v[60:63]
    ds_read_b128 v[120:123], v18 offset:3392
    v_mfma_f32_16x16x32_bf16 v[60:63], v[148:151], v[168:171], v[60:63]
    s_waitcnt lgkmcnt(15)
    v_mfma_f32_16x16x32_bf16 v[56:59], v[128:131], v[184:187], v[56:59]
    ds_read_b128 v[92:95], v17 offset:384
    v_mfma_f32_16x16x32_bf16 v[56:59], v[152:155], v[160:163], v[56:59]
    v_mfma_f32_16x16x32_bf16 v[60:63], v[132:135], v[184:187], v[60:63]
    ds_read_b128 v[124:127], v18 offset:3904
    v_mfma_f32_16x16x32_bf16 v[60:63], v[152:155], v[164:167], v[60:63]
    s_waitcnt lgkmcnt(15)
    v_mfma_f32_16x16x32_bf16 v[60:63], v[128:131], v[188:191], v[60:63]
    v_mfma_f32_16x16x32_bf16 v[60:63], v[156:159], v[160:163], v[60:63]
    s_waitcnt lgkmcnt(14)
    v_mfma_f32_16x16x32_bf16 v[32:35], v[64:67], v[96:99], v[32:35]
    s_waitcnt lgkmcnt(12)
    v_mfma_f32_16x16x32_bf16 v[36:39], v[64:67], v[100:103], v[36:39]
    v_mfma_f32_16x16x32_bf16 v[36:39], v[68:71], v[96:99], v[36:39]
    ds_read_b128 v[128:131], v17 offset:4032
    v_mfma_f32_16x16x32_bf16 v[40:43], v[68:71], v[100:103], v[40:43]
    s_waitcnt lgkmcnt(11)
    v_mfma_f32_16x16x32_bf16 v[40:43], v[64:67], v[104:107], v[40:43]
    ds_read_b128 v[160:163], v18 offset:384
    v_mfma_f32_16x16x32_bf16 v[40:43], v[72:75], v[96:99], v[40:43]
    v_mfma_f32_16x16x32_bf16 v[44:47], v[68:71], v[104:107], v[44:47]
    ds_read_b128 v[132:135], v17 offset:3520
    v_mfma_f32_16x16x32_bf16 v[44:47], v[72:75], v[100:103], v[44:47]
    v_mfma_f32_16x16x32_bf16 v[48:51], v[72:75], v[104:107], v[48:51]
    ds_read_b128 v[164:167], v18 offset:896
    s_waitcnt lgkmcnt(12)
    v_mfma_f32_16x16x32_bf16 v[44:47], v[64:67], v[108:111], v[44:47]
    v_mfma_f32_16x16x32_bf16 v[44:47], v[76:79], v[96:99], v[44:47]
    ds_read_b128 v[136:139], v17 offset:3008
    v_mfma_f32_16x16x32_bf16 v[48:51], v[68:71], v[108:111], v[48:51]
    v_mfma_f32_16x16x32_bf16 v[48:51], v[76:79], v[100:103], v[48:51]
    ds_read_b128 v[168:171], v18 offset:1408
    v_mfma_f32_16x16x32_bf16 v[52:55], v[72:75], v[108:111], v[52:55]
    v_mfma_f32_16x16x32_bf16 v[52:55], v[76:79], v[104:107], v[52:55]
    ds_read_b128 v[140:143], v17 offset:2496
    v_mfma_f32_16x16x32_bf16 v[56:59], v[76:79], v[108:111], v[56:59]
    s_waitcnt lgkmcnt(13)
    v_mfma_f32_16x16x32_bf16 v[48:51], v[64:67], v[112:115], v[48:51]
    ds_read_b128 v[172:175], v18 offset:1920
    v_mfma_f32_16x16x32_bf16 v[48:51], v[80:83], v[96:99], v[48:51]
    v_mfma_f32_16x16x32_bf16 v[52:55], v[68:71], v[112:115], v[52:55]
    ds_read_b128 v[144:147], v17 offset:1984
    v_mfma_f32_16x16x32_bf16 v[52:55], v[80:83], v[100:103], v[52:55]
    v_mfma_f32_16x16x32_bf16 v[56:59], v[72:75], v[112:115], v[56:59]
    ds_read_b128 v[176:179], v18 offset:2432
    v_mfma_f32_16x16x32_bf16 v[56:59], v[80:83], v[104:107], v[56:59]
    v_mfma_f32_16x16x32_bf16 v[60:63], v[76:79], v[112:115], v[60:63]
    ds_read_b128 v[148:151], v17 offset:1472
    v_mfma_f32_16x16x32_bf16 v[60:63], v[80:83], v[108:111], v[60:63]
    s_waitcnt lgkmcnt(15)
    v_mfma_f32_16x16x32_bf16 v[52:55], v[64:67], v[116:119], v[52:55]
    ds_read_b128 v[180:183], v18 offset:2944
    v_mfma_f32_16x16x32_bf16 v[52:55], v[84:87], v[96:99], v[52:55]
    v_mfma_f32_16x16x32_bf16 v[56:59], v[68:71], v[116:119], v[56:59]
    ds_read_b128 v[152:155], v17 offset:960
    v_mfma_f32_16x16x32_bf16 v[56:59], v[84:87], v[100:103], v[56:59]
    v_mfma_f32_16x16x32_bf16 v[60:63], v[72:75], v[116:119], v[60:63]
    ds_read_b128 v[184:187], v18 offset:3456
    v_mfma_f32_16x16x32_bf16 v[60:63], v[84:87], v[104:107], v[60:63]
    s_waitcnt lgkmcnt(15)
    v_mfma_f32_16x16x32_bf16 v[56:59], v[64:67], v[120:123], v[56:59]
    ds_read_b128 v[156:159], v17 offset:448
    v_mfma_f32_16x16x32_bf16 v[56:59], v[88:91], v[96:99], v[56:59]
    v_mfma_f32_16x16x32_bf16 v[60:63], v[68:71], v[120:123], v[60:63]
    ds_read_b128 v[188:191], v18 offset:3968
    v_mfma_f32_16x16x32_bf16 v[60:63], v[88:91], v[100:103], v[60:63]
    s_waitcnt lgkmcnt(15)
    v_mfma_f32_16x16x32_bf16 v[60:63], v[64:67], v[124:127], v[60:63]
    v_mfma_f32_16x16x32_bf16 v[60:63], v[92:95], v[96:99], v[60:63]
    s_waitcnt lgkmcnt(14)
    v_mfma_f32_16x16x32_bf16 v[32:35], v[128:131], v[160:163], v[32:35]
    s_waitcnt lgkmcnt(12)
    v_mfma_f32_16x16x32_bf16 v[36:39], v[128:131], v[164:167], v[36:39]
    v_mfma_f32_16x16x32_bf16 v[36:39], v[132:135], v[160:163], v[36:39]
    s_waitcnt lgkmcnt(10)
    v_mfma_f32_16x16x32_bf16 v[40:43], v[128:131], v[168:171], v[40:43]
    v_mfma_f32_16x16x32_bf16 v[40:43], v[132:135], v[164:167], v[40:43]
    v_mfma_f32_16x16x32_bf16 v[40:43], v[136:139], v[160:163], v[40:43]
    s_waitcnt lgkmcnt(8)
    v_mfma_f32_16x16x32_bf16 v[44:47], v[128:131], v[172:175], v[44:47]
    v_fmac_f32 v32, v16, v224
    v_fmac_f32 v33, v16, v225
    v_fmac_f32 v34, v16, v226
    v_fmac_f32 v35, v16, v227
    v_cvt_pk_bf16_f32 v32, v32, v33
    v_cvt_pk_bf16_f32 v33, v34, v35
    ds_write2st64_b32 v24, v32, v33 offset0:0 offset1:1
    v_mfma_f32_16x16x32_bf16 v[44:47], v[132:135], v[168:171], v[44:47]
    v_mfma_f32_16x16x32_bf16 v[44:47], v[136:139], v[164:167], v[44:47]
    v_fmac_f32 v36, v16, v228
    v_fmac_f32 v37, v16, v229
    v_fmac_f32 v38, v16, v230
    v_fmac_f32 v39, v16, v231
    v_cvt_pk_bf16_f32 v36, v36, v37
    v_cvt_pk_bf16_f32 v37, v38, v39
    ds_write2st64_b32 v24, v36, v37 offset0:8 offset1:9
    v_mfma_f32_16x16x32_bf16 v[44:47], v[140:143], v[160:163], v[44:47]
    s_waitcnt lgkmcnt(8)
    v_mfma_f32_16x16x32_bf16 v[48:51], v[128:131], v[176:179], v[48:51]
    v_mfma_f32_16x16x32_bf16 v[48:51], v[132:135], v[172:175], v[48:51]
    v_fmac_f32 v40, v16, v232
    v_fmac_f32 v41, v16, v233
    v_fmac_f32 v42, v16, v234
    v_fmac_f32 v43, v16, v235
    v_cvt_pk_bf16_f32 v40, v40, v41
    v_cvt_pk_bf16_f32 v41, v42, v43
    ds_write2st64_b32 v24, v40, v41 offset0:16 offset1:17
    v_mfma_f32_16x16x32_bf16 v[48:51], v[136:139], v[168:171], v[48:51]
    v_mfma_f32_16x16x32_bf16 v[48:51], v[140:143], v[164:167], v[48:51]
    v_mfma_f32_16x16x32_bf16 v[48:51], v[144:147], v[160:163], v[48:51]
    s_waitcnt lgkmcnt(7)
    v_mfma_f32_16x16x32_bf16 v[52:55], v[128:131], v[180:183], v[52:55]
    v_fmac_f32 v44, v16, v236
    v_fmac_f32 v45, v16, v237
    v_fmac_f32 v46, v16, v238
    v_fmac_f32 v47, v16, v239
    v_cvt_pk_bf16_f32 v44, v44, v45
    v_cvt_pk_bf16_f32 v45, v46, v47
    ds_write2st64_b32 v24, v44, v45 offset0:24 offset1:25
    v_mfma_f32_16x16x32_bf16 v[52:55], v[132:135], v[176:179], v[52:55]
    v_mfma_f32_16x16x32_bf16 v[52:55], v[136:139], v[172:175], v[52:55]
    v_mfma_f32_16x16x32_bf16 v[52:55], v[140:143], v[168:171], v[52:55]
    v_mfma_f32_16x16x32_bf16 v[52:55], v[144:147], v[164:167], v[52:55]
    v_mfma_f32_16x16x32_bf16 v[52:55], v[148:151], v[160:163], v[52:55]
    v_fmac_f32 v48, v16, v240
    v_fmac_f32 v49, v16, v241
    v_fmac_f32 v50, v16, v242
    v_fmac_f32 v51, v16, v243
    v_cvt_pk_bf16_f32 v48, v48, v49
    v_cvt_pk_bf16_f32 v49, v50, v51
    ds_write2st64_b32 v24, v48, v49 offset0:32 offset1:33
    s_waitcnt lgkmcnt(7)
    v_mfma_f32_16x16x32_bf16 v[56:59], v[128:131], v[184:187], v[56:59]
    v_mfma_f32_16x16x32_bf16 v[56:59], v[132:135], v[180:183], v[56:59]
    v_mfma_f32_16x16x32_bf16 v[56:59], v[136:139], v[176:179], v[56:59]
    v_mfma_f32_16x16x32_bf16 v[56:59], v[140:143], v[172:175], v[56:59]
    v_mfma_f32_16x16x32_bf16 v[56:59], v[144:147], v[168:171], v[56:59]
    v_mfma_f32_16x16x32_bf16 v[56:59], v[148:151], v[164:167], v[56:59]
    v_fmac_f32 v52, v16, v244
    v_fmac_f32 v53, v16, v245
    v_fmac_f32 v54, v16, v246
    v_fmac_f32 v55, v16, v247
    v_cvt_pk_bf16_f32 v52, v52, v53
    v_cvt_pk_bf16_f32 v53, v54, v55
    ds_write2st64_b32 v24, v52, v53 offset0:40 offset1:41
    v_mfma_f32_16x16x32_bf16 v[56:59], v[152:155], v[160:163], v[56:59]
    s_waitcnt lgkmcnt(6)
    v_mfma_f32_16x16x32_bf16 v[60:63], v[128:131], v[188:191], v[60:63]
    v_mfma_f32_16x16x32_bf16 v[60:63], v[132:135], v[184:187], v[60:63]
    v_mfma_f32_16x16x32_bf16 v[60:63], v[136:139], v[180:183], v[60:63]
    v_mfma_f32_16x16x32_bf16 v[60:63], v[140:143], v[176:179], v[60:63]
    v_mfma_f32_16x16x32_bf16 v[60:63], v[144:147], v[172:175], v[60:63]
    v_mfma_f32_16x16x32_bf16 v[60:63], v[148:151], v[168:171], v[60:63]
    s_nop 0
    v_fmac_f32 v56, v16, v248
    v_fmac_f32 v57, v16, v249
    v_fmac_f32 v58, v16, v250
    v_fmac_f32 v59, v16, v251
    v_cvt_pk_bf16_f32 v56, v56, v57
    v_cvt_pk_bf16_f32 v57, v58, v59
    ds_write2st64_b32 v24, v56, v57 offset0:48 offset1:49
    v_mfma_f32_16x16x32_bf16 v[60:63], v[152:155], v[164:167], v[60:63]
    v_mfma_f32_16x16x32_bf16 v[60:63], v[156:159], v[160:163], v[60:63]
    s_nop 7
    v_fmac_f32 v60, v16, v252
    v_fmac_f32 v61, v16, v253
    v_fmac_f32 v62, v16, v254
    v_fmac_f32 v63, v16, v255
    v_cvt_pk_bf16_f32 v60, v60, v61
    v_cvt_pk_bf16_f32 v61, v62, v63
    ds_write2st64_b32 v24, v60, v61 offset0:56 offset1:57
    v_lshlrev_b32 v4, 4, v0
    v_add_u32 v4, 108032, v4
    v_lshrrev_b32 v5, 3, v0
    v_mul_u32_u24 v5, 18432, v5
    v_and_b32 v6, 7, v0
    v_lshl_add_u32 v5, v6, 4, v5
    s_lshl_b32 s16, s12, 7
    s_waitcnt lgkmcnt(0)
    s_barrier
    ds_read_b128 v[8:11], v4 offset:0
    ds_read_b128 v[12:15], v4 offset:4096
    ds_read_b128 v[16:19], v4 offset:8192
    ds_read_b128 v[20:23], v4 offset:12288
    s_waitcnt lgkmcnt(3)
    buffer_store_dwordx4 v[8:11], v5, s[32:35], s16 offen sc1
    s_add_u32 s16, s16, 589824
    s_waitcnt lgkmcnt(2)
    buffer_store_dwordx4 v[12:15], v5, s[32:35], s16 offen sc1
    s_add_u32 s16, s16, 589824
    s_waitcnt lgkmcnt(1)
    buffer_store_dwordx4 v[16:19], v5, s[32:35], s16 offen sc1
    s_add_u32 s16, s16, 589824
    s_waitcnt lgkmcnt(0)
    buffer_store_dwordx4 v[20:23], v5, s[32:35], s16 offen sc1
    s_lshl_b32 s50, s12, 7
    s_add_u32 s50, s50, 65536
    s_branch K2_PUB
K2_SPARE:
    s_mov_b32 s50, 720896
    s_cmp_ge_u32 s12, 54
    s_cbranch_scc1 K2_PUB
    s_add_u32 s32, s10, 0x4b0000
    s_addc_u32 s33, s11, 0
    s_mov_b32 s34, 0x3600
    s_mov_b32 s35, 0x00020000
    s_mov_b32 s14, 0xbfb8aa3b
    s_waitcnt vmcnt(10)
    v_lshlrev_b32 v100, 16, v170
    v_and_b32 v101, 0xffff0000, v170
    v_lshlrev_b32 v102, 16, v171
    v_and_b32 v103, 0xffff0000, v171
    v_lshlrev_b32 v104, 16, v172
    v_and_b32 v105, 0xffff0000, v172
    v_lshlrev_b32 v106, 16, v173
    v_and_b32 v107, 0xffff0000, v173
    v_lshlrev_b32 v108, 16, v174
    v_and_b32 v109, 0xffff0000, v174
    v_lshlrev_b32 v110, 16, v175
    v_and_b32 v111, 0xffff0000, v175
    v_lshlrev_b32 v112, 16, v176
    v_and_b32 v113, 0xffff0000, v176
    v_lshlrev_b32 v114, 16, v177
    v_and_b32 v115, 0xffff0000, v177
    v_lshlrev_b32 v116, 16, v178
    v_and_b32 v117, 0xffff0000, v178
    v_mul_f32 v120, s14, v100
    v_mul_f32 v121, s14, v101
    v_mul_f32 v122, s14, v102
    v_mul_f32 v123, s14, v103
    v_mul_f32 v124, s14, v104
    v_mul_f32 v125, s14, v105
    v_mul_f32 v126, s14, v106
    v_mul_f32 v127, s14, v107
    v_mul_f32 v128, s14, v108
    v_mul_f32 v129, s14, v109
    v_mul_f32 v130, s14, v110
    v_mul_f32 v131, s14, v111
    v_mul_f32 v132, s14, v112
    v_mul_f32 v133, s14, v113
    v_mul_f32 v134, s14, v114
    v_mul_f32 v135, s14, v115
    v_mul_f32 v136, s14, v116
    v_mul_f32 v137, s14, v117
    v_exp_f32 v120, v120
    v_exp_f32 v121, v121
    v_exp_f32 v122, v122
    v_exp_f32 v123, v123
    v_exp_f32 v124, v124
    v_exp_f32 v125, v125
    v_exp_f32 v126, v126
    v_exp_f32 v127, v127
    v_exp_f32 v128, v128
    v_exp_f32 v129, v129
    v_exp_f32 v130, v130
    v_exp_f32 v131, v131
    v_exp_f32 v132, v132
    v_exp_f32 v133, v133
    v_exp_f32 v134, v134
    v_exp_f32 v135, v135
    v_exp_f32 v136, v136
    v_exp_f32 v137, v137
    v_add_f32 v120, 1.0, v120
    v_add_f32 v121, 1.0, v121
    v_add_f32 v122, 1.0, v122
    v_add_f32 v123, 1.0, v123
    v_add_f32 v124, 1.0, v124
    v_add_f32 v125, 1.0, v125
    v_add_f32 v126, 1.0, v126
    v_add_f32 v127, 1.0, v127
    v_add_f32 v128, 1.0, v128
    v_add_f32 v129, 1.0, v129
    v_add_f32 v130, 1.0, v130
    v_add_f32 v131, 1.0, v131
    v_add_f32 v132, 1.0, v132
    v_add_f32 v133, 1.0, v133
    v_add_f32 v134, 1.0, v134
    v_add_f32 v135, 1.0, v135
    v_add_f32 v136, 1.0, v136
    v_add_f32 v137, 1.0, v137
    v_rcp_f32 v120, v120
    v_rcp_f32 v121, v121
    v_rcp_f32 v122, v122
    v_rcp_f32 v123, v123
    v_rcp_f32 v124, v124
    v_rcp_f32 v125, v125
    v_rcp_f32 v126, v126
    v_rcp_f32 v127, v127
    v_rcp_f32 v128, v128
    v_rcp_f32 v129, v129
    v_rcp_f32 v130, v130
    v_rcp_f32 v131, v131
    v_rcp_f32 v132, v132
    v_rcp_f32 v133, v133
    v_rcp_f32 v134, v134
    v_rcp_f32 v135, v135
    v_rcp_f32 v136, v136
    v_rcp_f32 v137, v137
    v_mul_f32 v100, v100, v120
    v_mul_f32 v101, v101, v121
    v_mul_f32 v102, v102, v122
    v_mul_f32 v103, v103, v123
    v_mul_f32 v104, v104, v124
    v_mul_f32 v105, v105, v125
    v_mul_f32 v106, v106, v126
    v_mul_f32 v107, v107, v127
    v_mul_f32 v108, v108, v128
    v_mul_f32 v109, v109, v129
    v_mul_f32 v110, v110, v130
    v_mul_f32 v111, v111, v131
    v_mul_f32 v112, v112, v132
    v_mul_f32 v113, v113, v133
    v_mul_f32 v114, v114, v134
    v_mul_f32 v115, v115, v135
    v_mul_f32 v116, v116, v136
    v_mul_f32 v117, v117, v137
    v_cvt_pk_bf16_f32 v170, v100, v101
    v_cvt_pk_bf16_f32 v171, v102, v103
    v_cvt_pk_bf16_f32 v172, v104, v105
    v_cvt_pk_bf16_f32 v173, v106, v107
    v_cvt_pk_bf16_f32 v174, v108, v109
    v_cvt_pk_bf16_f32 v175, v110, v111
    v_cvt_pk_bf16_f32 v176, v112, v113
    v_cvt_pk_bf16_f32 v177, v114, v115
    v_cvt_pk_bf16_f32 v178, v116, v117
    v_lshlrev_b32 v100, 16, v170
    v_and_b32 v101, 0xffff0000, v170
    v_lshlrev_b32 v102, 16, v171
    v_and_b32 v103, 0xffff0000, v171
    v_lshlrev_b32 v104, 16, v172
    v_and_b32 v105, 0xffff0000, v172
    v_lshlrev_b32 v106, 16, v173
    v_and_b32 v107, 0xffff0000, v173
    v_lshlrev_b32 v108, 16, v174
    v_and_b32 v109, 0xffff0000, v174
    v_lshlrev_b32 v110, 16, v175
    v_and_b32 v111, 0xffff0000, v175
    v_lshlrev_b32 v112, 16, v176
    v_and_b32 v113, 0xffff0000, v176
    v_lshlrev_b32 v114, 16, v177
    v_and_b32 v115, 0xffff0000, v177
    v_lshlrev_b32 v116, 16, v178
    v_and_b32 v117, 0xffff0000, v178
    s_mov_b32 s14, 69120
    buffer_load_dwordx4 v[68:71], v3, s[24:27], s14 offen
    s_mov_b32 s14, 76032
    buffer_load_dwordx4 v[72:75], v3, s[24:27], s14 offen
    s_mov_b32 s14, 82944
    buffer_load_dwordx4 v[76:79], v3, s[24:27], s14 offen
    s_mov_b32 s14, 89856
    buffer_load_dwordx4 v[80:83], v3, s[24:27], s14 offen
    s_mov_b32 s14, 96768
    buffer_load_dwordx4 v[84:87], v3, s[24:27], s14 offen
    s_mov_b32 s14, 103680
    buffer_load_dwordx4 v[88:91], v3, s[24:27], s14 offen
    s_mov_b32 s14, 110592
    buffer_load_dwordx4 v[92:95], v3, s[24:27], s14 offen
    s_mov_b32 s14, 117504
    buffer_load_dwordx4 v[96:99], v3, s[24:27], s14 offen
    s_waitcnt vmcnt(17)
    v_lshlrev_b32 v120, 16, v28
    v_and_b32 v121, 0xffff0000, v28
    v_lshlrev_b32 v122, 16, v29
    v_and_b32 v123, 0xffff0000, v29
    v_lshlrev_b32 v124, 16, v30
    v_and_b32 v125, 0xffff0000, v30
    v_lshlrev_b32 v126, 16, v31
    v_and_b32 v127, 0xffff0000, v31
    v_pk_mul_f32 v[8:9], v[120:121], v[100:101] op_sel_hi:[1,0]
    v_pk_mul_f32 v[10:11], v[122:123], v[100:101] op_sel_hi:[1,0]
    v_pk_mul_f32 v[12:13], v[124:125], v[100:101] op_sel_hi:[1,0]
    v_pk_mul_f32 v[14:15], v[126:127], v[100:101] op_sel_hi:[1,0]
    s_waitcnt vmcnt(16)
    v_lshlrev_b32 v128, 16, v32
    v_and_b32 v129, 0xffff0000, v32
    v_lshlrev_b32 v130, 16, v33
    v_and_b32 v131, 0xffff0000, v33
    v_lshlrev_b32 v132, 16, v34
    v_and_b32 v133, 0xffff0000, v34
    v_lshlrev_b32 v134, 16, v35
    v_and_b32 v135, 0xffff0000, v35
    v_pk_fma_f32 v[8:9], v[128:129], v[100:101], v[8:9] op_sel:[0,1,0] op_sel_hi:[1,1,1]
    v_pk_fma_f32 v[10:11], v[130:131], v[100:101], v[10:11] op_sel:[0,1,0] op_sel_hi:[1,1,1]
    v_pk_fma_f32 v[12:13], v[132:133], v[100:101], v[12:13] op_sel:[0,1,0] op_sel_hi:[1,1,1]
    v_pk_fma_f32 v[14:15], v[134:135], v[100:101], v[14:15] op_sel:[0,1,0] op_sel_hi:[1,1,1]
    s_waitcnt vmcnt(15)
    v_lshlrev_b32 v120, 16, v36
    v_and_b32 v121, 0xffff0000, v36
    v_lshlrev_b32 v122, 16, v37
    v_and_b32 v123, 0xffff0000, v37
    v_lshlrev_b32 v124, 16, v38
    v_and_b32 v125, 0xffff0000, v38
    v_lshlrev_b32 v126, 16, v39
    v_and_b32 v127, 0xffff0000, v39
    v_pk_fma_f32 v[8:9], v[120:121], v[102:103], v[8:9] op_sel_hi:[1,0,1]
    v_pk_fma_f32 v[10:11], v[122:123], v[102:103], v[10:11] op_sel_hi:[1,0,1]
    v_pk_fma_f32 v[12:13], v[124:125], v[102:103], v[12:13] op_sel_hi:[1,0,1]
    v_pk_fma_f32 v[14:15], v[126:127], v[102:103], v[14:15] op_sel_hi:[1,0,1]
    s_waitcnt vmcnt(14)
    v_lshlrev_b32 v128, 16, v40
    v_and_b32 v129, 0xffff0000, v40
    v_lshlrev_b32 v130, 16, v41
    v_and_b32 v131, 0xffff0000, v41
    v_lshlrev_b32 v132, 16, v42
    v_and_b32 v133, 0xffff0000, v42
    v_lshlrev_b32 v134, 16, v43
    v_and_b32 v135, 0xffff0000, v43
    v_pk_fma_f32 v[8:9], v[128:129], v[102:103], v[8:9] op_sel:[0,1,0] op_sel_hi:[1,1,1]
    v_pk_fma_f32 v[10:11], v[130:131], v[102:103], v[10:11] op_sel:[0,1,0] op_sel_hi:[1,1,1]
    v_pk_fma_f32 v[12:13], v[132:133], v[102:103], v[12:13] op_sel:[0,1,0] op_sel_hi:[1,1,1]
    v_pk_fma_f32 v[14:15], v[134:135], v[102:103], v[14:15] op_sel:[0,1,0] op_sel_hi:[1,1,1]
    s_waitcnt vmcnt(13)
    v_lshlrev_b32 v120, 16, v44
    v_and_b32 v121, 0xffff0000, v44
    v_lshlrev_b32 v122, 16, v45
    v_and_b32 v123, 0xffff0000, v45
    v_lshlrev_b32 v124, 16, v46
    v_and_b32 v125, 0xffff0000, v46
    v_lshlrev_b32 v126, 16, v47
    v_and_b32 v127, 0xffff0000, v47
    v_pk_fma_f32 v[8:9], v[120:121], v[104:105], v[8:9] op_sel_hi:[1,0,1]
    v_pk_fma_f32 v[10:11], v[122:123], v[104:105], v[10:11] op_sel_hi:[1,0,1]
    v_pk_fma_f32 v[12:13], v[124:125], v[104:105], v[12:13] op_sel_hi:[1,0,1]
    v_pk_fma_f32 v[14:15], v[126:127], v[104:105], v[14:15] op_sel_hi:[1,0,1]
    s_waitcnt vmcnt(12)
    v_lshlrev_b32 v128, 16, v48
    v_and_b32 v129, 0xffff0000, v48
    v_lshlrev_b32 v130, 16, v49
    v_and_b32 v131, 0xffff0000, v49
    v_lshlrev_b32 v132, 16, v50
    v_and_b32 v133, 0xffff0000, v50
    v_lshlrev_b32 v134, 16, v51
    v_and_b32 v135, 0xffff0000, v51
    v_pk_fma_f32 v[8:9], v[128:129], v[104:105], v[8:9] op_sel:[0,1,0] op_sel_hi:[1,1,1]
    v_pk_fma_f32 v[10:11], v[130:131], v[104:105], v[10:11] op_sel:[0,1,0] op_sel_hi:[1,1,1]
    v_pk_fma_f32 v[12:13], v[132:133], v[104:105], v[12:13] op_sel:[0,1,0] op_sel_hi:[1,1,1]
    v_pk_fma_f32 v[14:15], v[134:135], v[104:105], v[14:15] op_sel:[0,1,0] op_sel_hi:[1,1,1]
    s_waitcnt vmcnt(11)
    v_lshlrev_b32 v120, 16, v52
    v_and_b32 v121, 0xffff0000, v52
    v_lshlrev_b32 v122, 16, v53
    v_and_b32 v123, 0xffff0000, v53
    v_lshlrev_b32 v124, 16, v54
    v_and_b32 v125, 0xffff0000, v54
    v_lshlrev_b32 v126, 16, v55
    v_and_b32 v127, 0xffff0000, v55
    v_pk_fma_f32 v[8:9], v[120:121], v[106:107], v[8:9] op_sel_hi:[1,0,1]
    v_pk_fma_f32 v[10:11], v[122:123], v[106:107], v[10:11] op_sel_hi:[1,0,1]
    v_pk_fma_f32 v[12:13], v[124:125], v[106:107], v[12:13] op_sel_hi:[1,0,1]
    v_pk_fma_f32 v[14:15], v[126:127], v[106:107], v[14:15] op_sel_hi:[1,0,1]
    s_waitcnt vmcnt(10)
    v_lshlrev_b32 v128, 16, v56
    v_and_b32 v129, 0xffff0000, v56
    v_lshlrev_b32 v130, 16, v57
    v_and_b32 v131, 0xffff0000, v57
    v_lshlrev_b32 v132, 16, v58
    v_and_b32 v133, 0xffff0000, v58
    v_lshlrev_b32 v134, 16, v59
    v_and_b32 v135, 0xffff0000, v59
    v_pk_fma_f32 v[8:9], v[128:129], v[106:107], v[8:9] op_sel:[0,1,0] op_sel_hi:[1,1,1]
    v_pk_fma_f32 v[10:11], v[130:131], v[106:107], v[10:11] op_sel:[0,1,0] op_sel_hi:[1,1,1]
    v_pk_fma_f32 v[12:13], v[132:133], v[106:107], v[12:13] op_sel:[0,1,0] op_sel_hi:[1,1,1]
    v_pk_fma_f32 v[14:15], v[134:135], v[106:107], v[14:15] op_sel:[0,1,0] op_sel_hi:[1,1,1]
    s_waitcnt vmcnt(9)
    v_lshlrev_b32 v120, 16, v60
    v_and_b32 v121, 0xffff0000, v60
    v_lshlrev_b32 v122, 16, v61
    v_and_b32 v123, 0xffff0000, v61
    v_lshlrev_b32 v124, 16, v62
    v_and_b32 v125, 0xffff0000, v62
    v_lshlrev_b32 v126, 16, v63
    v_and_b32 v127, 0xffff0000, v63
    v_pk_fma_f32 v[8:9], v[120:121], v[108:109], v[8:9] op_sel_hi:[1,0,1]
    v_pk_fma_f32 v[10:11], v[122:123], v[108:109], v[10:11] op_sel_hi:[1,0,1]
    v_pk_fma_f32 v[12:13], v[124:125], v[108:109], v[12:13] op_sel_hi:[1,0,1]
    v_pk_fma_f32 v[14:15], v[126:127], v[108:109], v[14:15] op_sel_hi:[1,0,1]
    s_waitcnt vmcnt(8)
    v_lshlrev_b32 v128, 16, v64
    v_and_b32 v129, 0xffff0000, v64
    v_lshlrev_b32 v130, 16, v65
    v_and_b32 v131, 0xffff0000, v65
    v_lshlrev_b32 v132, 16, v66
    v_and_b32 v133, 0xffff0000, v66
    v_lshlrev_b32 v134, 16, v67
    v_and_b32 v135, 0xffff0000, v67
    v_pk_fma_f32 v[8:9], v[128:129], v[108:109], v[8:9] op_sel:[0,1,0] op_sel_hi:[1,1,1]
    v_pk_fma_f32 v[10:11], v[130:131], v[108:109], v[10:11] op_sel:[0,1,0] op_sel_hi:[1,1,1]
    v_pk_fma_f32 v[12:13], v[132:133], v[108:109], v[12:13] op_sel:[0,1,0] op_sel_hi:[1,1,1]
    v_pk_fma_f32 v[14:15], v[134:135], v[108:109], v[14:15] op_sel:[0,1,0] op_sel_hi:[1,1,1]
    s_waitcnt vmcnt(7)
    v_lshlrev_b32 v120, 16, v68
    v_and_b32 v121, 0xffff0000, v68
    v_lshlrev_b32 v122, 16, v69
    v_and_b32 v123, 0xffff0000, v69
    v_lshlrev_b32 v124, 16, v70
    v_and_b32 v125, 0xffff0000, v70
    v_lshlrev_b32 v126, 16, v71
    v_and_b32 v127, 0xffff0000, v71
    v_pk_fma_f32 v[8:9], v[120:121], v[110:111], v[8:9] op_sel_hi:[1,0,1]
    v_pk_fma_f32 v[10:11], v[122:123], v[110:111], v[10:11] op_sel_hi:[1,0,1]
    v_pk_fma_f32 v[12:13], v[124:125], v[110:111], v[12:13] op_sel_hi:[1,0,1]
    v_pk_fma_f32 v[14:15], v[126:127], v[110:111], v[14:15] op_sel_hi:[1,0,1]
    s_waitcnt vmcnt(6)
    v_lshlrev_b32 v128, 16, v72
    v_and_b32 v129, 0xffff0000, v72
    v_lshlrev_b32 v130, 16, v73
    v_and_b32 v131, 0xffff0000, v73
    v_lshlrev_b32 v132, 16, v74
    v_and_b32 v133, 0xffff0000, v74
    v_lshlrev_b32 v134, 16, v75
    v_and_b32 v135, 0xffff0000, v75
    v_pk_fma_f32 v[8:9], v[128:129], v[110:111], v[8:9] op_sel:[0,1,0] op_sel_hi:[1,1,1]
    v_pk_fma_f32 v[10:11], v[130:131], v[110:111], v[10:11] op_sel:[0,1,0] op_sel_hi:[1,1,1]
    v_pk_fma_f32 v[12:13], v[132:133], v[110:111], v[12:13] op_sel:[0,1,0] op_sel_hi:[1,1,1]
    v_pk_fma_f32 v[14:15], v[134:135], v[110:111], v[14:15] op_sel:[0,1,0] op_sel_hi:[1,1,1]
    s_waitcnt vmcnt(5)
    v_lshlrev_b32 v120, 16, v76
    v_and_b32 v121, 0xffff0000, v76
    v_lshlrev_b32 v122, 16, v77
    v_and_b32 v123, 0xffff0000, v77
    v_lshlrev_b32 v124, 16, v78
    v_and_b32 v125, 0xffff0000, v78
    v_lshlrev_b32 v126, 16, v79
    v_and_b32 v127, 0xffff0000, v79
    v_pk_fma_f32 v[8:9], v[120:121], v[112:113], v[8:9] op_sel_hi:[1,0,1]
    v_pk_fma_f32 v[10:11], v[122:123], v[112:113], v[10:11] op_sel_hi:[1,0,1]
    v_pk_fma_f32 v[12:13], v[124:125], v[112:113], v[12:13] op_sel_hi:[1,0,1]
    v_pk_fma_f32 v[14:15], v[126:127], v[112:113], v[14:15] op_sel_hi:[1,0,1]
    s_waitcnt vmcnt(4)
    v_lshlrev_b32 v128, 16, v80
    v_and_b32 v129, 0xffff0000, v80
    v_lshlrev_b32 v130, 16, v81
    v_and_b32 v131, 0xffff0000, v81
    v_lshlrev_b32 v132, 16, v82
    v_and_b32 v133, 0xffff0000, v82
    v_lshlrev_b32 v134, 16, v83
    v_and_b32 v135, 0xffff0000, v83
    v_pk_fma_f32 v[8:9], v[128:129], v[112:113], v[8:9] op_sel:[0,1,0] op_sel_hi:[1,1,1]
    v_pk_fma_f32 v[10:11], v[130:131], v[112:113], v[10:11] op_sel:[0,1,0] op_sel_hi:[1,1,1]
    v_pk_fma_f32 v[12:13], v[132:133], v[112:113], v[12:13] op_sel:[0,1,0] op_sel_hi:[1,1,1]
    v_pk_fma_f32 v[14:15], v[134:135], v[112:113], v[14:15] op_sel:[0,1,0] op_sel_hi:[1,1,1]
    s_waitcnt vmcnt(3)
    v_lshlrev_b32 v120, 16, v84
    v_and_b32 v121, 0xffff0000, v84
    v_lshlrev_b32 v122, 16, v85
    v_and_b32 v123, 0xffff0000, v85
    v_lshlrev_b32 v124, 16, v86
    v_and_b32 v125, 0xffff0000, v86
    v_lshlrev_b32 v126, 16, v87
    v_and_b32 v127, 0xffff0000, v87
    v_pk_fma_f32 v[8:9], v[120:121], v[114:115], v[8:9] op_sel_hi:[1,0,1]
    v_pk_fma_f32 v[10:11], v[122:123], v[114:115], v[10:11] op_sel_hi:[1,0,1]
    v_pk_fma_f32 v[12:13], v[124:125], v[114:115], v[12:13] op_sel_hi:[1,0,1]
    v_pk_fma_f32 v[14:15], v[126:127], v[114:115], v[14:15] op_sel_hi:[1,0,1]
    s_waitcnt vmcnt(2)
    v_lshlrev_b32 v128, 16, v88
    v_and_b32 v129, 0xffff0000, v88
    v_lshlrev_b32 v130, 16, v89
    v_and_b32 v131, 0xffff0000, v89
    v_lshlrev_b32 v132, 16, v90
    v_and_b32 v133, 0xffff0000, v90
    v_lshlrev_b32 v134, 16, v91
    v_and_b32 v135, 0xffff0000, v91
    v_pk_fma_f32 v[8:9], v[128:129], v[114:115], v[8:9] op_sel:[0,1,0] op_sel_hi:[1,1,1]
    v_pk_fma_f32 v[10:11], v[130:131], v[114:115], v[10:11] op_sel:[0,1,0] op_sel_hi:[1,1,1]
    v_pk_fma_f32 v[12:13], v[132:133], v[114:115], v[12:13] op_sel:[0,1,0] op_sel_hi:[1,1,1]
    v_pk_fma_f32 v[14:15], v[134:135], v[114:115], v[14:15] op_sel:[0,1,0] op_sel_hi:[1,1,1]
    s_waitcnt vmcnt(1)
    v_lshlrev_b32 v120, 16, v92
    v_and_b32 v121, 0xffff0000, v92
    v_lshlrev_b32 v122, 16, v93
    v_and_b32 v123, 0xffff0000, v93
    v_lshlrev_b32 v124, 16, v94
    v_and_b32 v125, 0xffff0000, v94
    v_lshlrev_b32 v126, 16, v95
    v_and_b32 v127, 0xffff0000, v95
    v_pk_fma_f32 v[8:9], v[120:121], v[116:117], v[8:9] op_sel_hi:[1,0,1]
    v_pk_fma_f32 v[10:11], v[122:123], v[116:117], v[10:11] op_sel_hi:[1,0,1]
    v_pk_fma_f32 v[12:13], v[124:125], v[116:117], v[12:13] op_sel_hi:[1,0,1]
    v_pk_fma_f32 v[14:15], v[126:127], v[116:117], v[14:15] op_sel_hi:[1,0,1]
    s_waitcnt vmcnt(0)
    v_lshlrev_b32 v128, 16, v96
    v_and_b32 v129, 0xffff0000, v96
    v_lshlrev_b32 v130, 16, v97
    v_and_b32 v131, 0xffff0000, v97
    v_lshlrev_b32 v132, 16, v98
    v_and_b32 v133, 0xffff0000, v98
    v_lshlrev_b32 v134, 16, v99
    v_and_b32 v135, 0xffff0000, v99
    v_pk_fma_f32 v[8:9], v[128:129], v[116:117], v[8:9] op_sel:[0,1,0] op_sel_hi:[1,1,1]
    v_pk_fma_f32 v[10:11], v[130:131], v[116:117], v[10:11] op_sel:[0,1,0] op_sel_hi:[1,1,1]
    v_pk_fma_f32 v[12:13], v[132:133], v[116:117], v[12:13] op_sel:[0,1,0] op_sel_hi:[1,1,1]
    v_pk_fma_f32 v[14:15], v[134:135], v[116:117], v[14:15] op_sel:[0,1,0] op_sel_hi:[1,1,1]
    v_lshlrev_b32 v5, 8, v25
    v_lshl_add_u32 v5, v24, 5, v5
    ds_write_b128 v5, v[8:11]
    ds_write_b128 v5, v[12:15] offset:16
    s_waitcnt lgkmcnt(0)
    s_barrier
    s_cmp_ge_u32 s3, 1
    s_cbranch_scc1 K2_GEMVX
    v_lshlrev_b32 v5, 2, v0
    ds_read_b32 v28, v5 offset:0
    ds_read_b32 v29, v5 offset:256
    ds_read_b32 v30, v5 offset:512
    ds_read_b32 v31, v5 offset:768
    ds_read_b32 v32, v5 offset:1024
    ds_read_b32 v33, v5 offset:1280
    ds_read_b32 v34, v5 offset:1536
    ds_read_b32 v35, v5 offset:1792
    ds_read_b32 v36, v5 offset:2048
    ds_read_b32 v37, v5 offset:2304
    ds_read_b32 v38, v5 offset:2560
    ds_read_b32 v39, v5 offset:2816
    ds_read_b32 v40, v5 offset:3072
    ds_read_b32 v41, v5 offset:3328
    ds_read_b32 v42, v5 offset:3584
    ds_read_b32 v43, v5 offset:3840
    ds_read_b32 v44, v5 offset:4096
    ds_read_b32 v45, v5 offset:4352
    ds_read_b32 v46, v5 offset:4608
    ds_read_b32 v47, v5 offset:4864
    ds_read_b32 v48, v5 offset:5120
    ds_read_b32 v49, v5 offset:5376
    ds_read_b32 v50, v5 offset:5632
    ds_read_b32 v51, v5 offset:5888
    ds_read_b32 v52, v5 offset:6144
    ds_read_b32 v53, v5 offset:6400
    ds_read_b32 v54, v5 offset:6656
    ds_read_b32 v55, v5 offset:6912
    ds_read_b32 v56, v5 offset:7168
    ds_read_b32 v57, v5 offset:7424
    ds_read_b32 v58, v5 offset:7680
    ds_read_b32 v59, v5 offset:7936
    s_waitcnt lgkmcnt(0)
    v_add_f32 v28, v28, v44
    v_add_f32 v29, v29, v45
    v_add_f32 v30, v30, v46
    v_add_f32 v31, v31, v47
    v_add_f32 v32, v32, v48
    v_add_f32 v33, v33, v49
    v_add_f32 v34, v34, v50
    v_add_f32 v35, v35, v51
    v_add_f32 v36, v36, v52
    v_add_f32 v37, v37, v53
    v_add_f32 v38, v38, v54
    v_add_f32 v39, v39, v55
    v_add_f32 v40, v40, v56
    v_add_f32 v41, v41, v57
    v_add_f32 v42, v42, v58
    v_add_f32 v43, v43, v59
    v_add_f32 v28, v28, v36
    v_add_f32 v29, v29, v37
    v_add_f32 v30, v30, v38
    v_add_f32 v31, v31, v39
    v_add_f32 v32, v32, v40
    v_add_f32 v33, v33, v41
    v_add_f32 v34, v34, v42
    v_add_f32 v35, v35, v43
    v_add_f32 v28, v28, v32
    v_add_f32 v29, v29, v33
    v_add_f32 v30, v30, v34
    v_add_f32 v31, v31, v35
    v_add_f32 v28, v28, v30
    v_add_f32 v29, v29, v31
    v_add_f32 v28, v28, v29
    s_mov_b32 s16, 0x1C71C71D
    s_mul_hi_u32 s16, s12, s16
    s_cmp_eq_u32 s16, 1
    s_cselect_b32 s17, 1.0, 0
    s_cmp_eq_u32 s16, 4
    s_cselect_b32 s17, 1.0, s17
    v_cvt_pk_bf16_f32 v6, v28, v28
    v_lshlrev_b32 v6, 16, v6
    v_add_f32 v6, s17, v6
    v_cvt_pk_bf16_f32 v6, v6, v6
    v_lshrrev_b32 v5, 1, v5
    s_lshl_b32 s13, s12, 7
    buffer_store_short v6, v5, s[32:35], s13 offen sc1
    s_lshl_b32 s50, s12, 7
    s_add_u32 s50, s50, 83968
    s_cmp_lg_u32 s3, 0
    s_cselect_b32 s50, 720896, s50
    s_waitcnt vmcnt(0)
    buffer_store_dwordx4 v[216:219], v221, s[56:59], s50 offen sc1
K2_GEMVX:
    s_barrier
    s_lshr_b32 s13, s12, 3
    s_lshl_b32 s13, s13, 1
    s_add_u32 s13, s13, s9
    s_mul_i32 s13, s13, 55296
    s_add_u32 s13, s13, 4313088
    s_add_u32 s13, s13, s60
    buffer_load_dword v214, v206, s[44:47], s13 offen
    s_add_u32 s13, s13, 663552
    buffer_load_dword v215, v206, s[44:47], s13 offen
    s_mov_b32 s50, 720896
K2_PUB:
    s_load_dwordx4 s[36:39], s[0:1], 56
    s_load_dwordx2 s[52:53], s[0:1], 72
    s_and_b32 s15, s2, 7
    s_lshl_b32 s15, s15, 15
    s_mul_i32 s16, s3, 14*128
    s_add_u32 s15, s15, s16
    s_add_u32 s15, s15, 83968
    s_cmp_eq_u32 s3, 3
    s_cselect_b32 s60, 12, 14
    v_and_b32 v209, 63, v0
    v_cmp_gt_u32 vcc, s60, v209
    v_lshlrev_b32 v209, 7, v209
    s_nop 0
    v_cndmask_b32 v209, 2.0, v209, vcc
    buffer_load_dword v212, v209, s[56:59], s15 offen sc1
    s_cmp_lg_u32 s3, 0
    s_cselect_b32 s50, 720896, s50
    v_and_b32 v8, 63, v0
    v_lshlrev_b32 v1, 4, v8
    s_and_b32 s4, s2, 7
    s_lshl_b32 s4, s4, 5
    s_lshr_b32 s5, s2, 3
    s_add_u32 s4, s4, s5
    s_min_u32 s9, s4, 251
    s_mov_b32 s6, 0x24924925
    s_mul_hi_u32 s5, s9, s6
    s_mul_i32 s7, s5, 7
    s_sub_u32 s47, s9, s7
    s_lshl_b32 s7, s47, 7
    s_mul_hi_u32 s7, s7, s6
    s_and_b32 s9, s3, 1
    s_mul_i32 s48, s9, 294912
    s_lshl_b32 s18, s5, 8
    s_add_u32 s48, s48, s18
    s_lshl_b32 s49, s3, 13
    v_lshrrev_b32 v9, 4, v8
    v_bfe_u32 v10, v8, 1, 3
    v_xor_b32 v10, v10, v9
    v_and_b32 v11, 1, v8
    v_lshl_add_u32 v10, v10, 1, v11
    v_mul_u32_u24 v11, 9216, v9
    v_lshl_add_u32 v12, v10, 4, v11
    v_xor_b32 v10, 8, v10
    v_lshl_add_u32 v13, v10, 4, v11
    s_waitcnt lgkmcnt(0)
    s_cmp_ge_u32 s3, 2
    s_cselect_b32 s20, s38, s36
    s_cselect_b32 s21, s39, s37
    s_mov_b32 s22, 5308416
    s_mov_b32 s23, 0x00020000
    v_and_b32 v3, 7, v8
    v_lshrrev_b32 v4, 3, v8
    v_lshlrev_b32 v97, 4, v4
    s_lshl_b32 s40, s3, 7
    s_add_u32 s41, s40, 512
    s_mov_b32 s42, 1024
    s_cmp_lg_u32 s3, 0
    s_cselect_b32 s42, 0x1000000, s42
    v_mul_u32_u24 v5, 1152, v3
    v_lshl_add_u32 v5, v4, 4, v5
    v_lshlrev_b32 v3, 3, v3
    s_and_b32 s100, s2, 0xf0
    s_and_b32 s101, s2, 7
    s_lshl_b32 s101, s101, 1
    s_add_u32 s100, s100, s101
    s_bfe_u32 s101, s2, 0x10003
    s_add_u32 s100, s100, s101
    s_mul_i32 s12, s100, 8*1152
    s_lshr_b32 s13, s100, 1
    s_mul_i32 s13, s13, 18432
    s_and_b32 s14, s100, 1
    s_lshl_b32 s17, s14, 4
    s_add_u32 s17, s17, s13
    s_lshl_b32 s16, s14, 7
    s_add_u32 s16, s16, s13
    s_mul_i32 s43, s3, 3072
    s_add_u32 s44, s40, s12
    s_add_u32 s45, s41, s12
    s_add_u32 s46, s42, s12
    v_bfe_u32 v10, v8, 2, 2
    v_lshl_add_u32 v11, v9, 3, v10
    v_lshlrev_b32 v11, 8, v11
    v_and_b32 v14, 1, v9
    v_lshl_add_u32 v10, v14, 2, v10
    s_lshl_b32 s9, s3, 1
    v_xor_b32 v10, s9, v10
    v_and_b32 v14, 3, v8
    v_lshl_add_u32 v11, v14, 3, v11
    v_xor_b32 v14, 1, v10
    v_lshl_add_u32 v10, v10, 5, v11
    v_lshl_add_u32 v11, v14, 5, v11
    v_add_u32 v14, 0x10000, v10
    v_add_u32 v15, 0x10000, v11
    v_lshlrev_b32 v6, 1, v9
    v_bfe_u32 v7, v8, 1, 1
    v_add_u32 v6, v6, v7
    v_bfe_u32 v7, v8, 2, 2
    v_lshl_add_u32 v6, v6, 3, v7
    v_lshlrev_b32 v6, 4, v6
    v_and_b32 v7, 1, v8
    v_lshl_add_u32 v6, v7, 3, v6
    s_add_u32 s19, s43, 135168
    v_add_u32 v6, s19, v6
    v_lshlrev_b32 v4, 8, v4
    v_lshl_add_u32 v4, v3, 1, v4
    v_add_u32 v3, 147456, v3
    s_lshl_b32 s19, s3, 6
    v_add_u32 v7, s19, v3
    v_lshlrev_b32 v96, 5, v8
    v_lshlrev_b32 v2, 4, v8
    s_mul_i32 s101, s3, 1920
    s_add_u32 s19, s101, 148480
    v_add_u32 v97, s19, v97
    v_lshrrev_b32 v98, 3, v8
    v_mul_u32_u24 v98, 1152, v98
    v_and_b32 v99, 7, v8
    v_lshl_add_u32 v98, v99, 4, v98
    v_lshlrev_b32 v100, 16, v192
    v_and_b32 v101, 0xffff0000, v192
    v_lshlrev_b32 v102, 16, v193
    v_and_b32 v103, 0xffff0000, v193
    v_lshlrev_b32 v104, 16, v194
    v_and_b32 v105, 0xffff0000, v194
    v_lshlrev_b32 v106, 16, v195
    v_and_b32 v107, 0xffff0000, v195
    v_pk_add_f32 v[170:171], v[100:101], v[204:205] op_sel_hi:[1,0]
    v_pk_add_f32 v[172:173], v[102:103], v[204:205] op_sel_hi:[1,0]
    v_pk_add_f32 v[174:175], v[104:105], v[204:205] op_sel_hi:[1,0]
    v_pk_add_f32 v[176:177], v[106:107], v[204:205] op_sel_hi:[1,0]
    v_pk_mul_f32 v[170:171], v[170:171], v[204:205] op_sel:[0,1] op_sel_hi:[1,1]
    v_pk_mul_f32 v[172:173], v[172:173], v[204:205] op_sel:[0,1] op_sel_hi:[1,1]
    v_pk_mul_f32 v[174:175], v[174:175], v[204:205] op_sel:[0,1] op_sel_hi:[1,1]
    v_pk_mul_f32 v[176:177], v[176:177], v[204:205] op_sel:[0,1] op_sel_hi:[1,1]
    v_lshlrev_b32 v108, 16, v196
    v_and_b32 v109, 0xffff0000, v196
    v_lshlrev_b32 v110, 16, v197
    v_and_b32 v111, 0xffff0000, v197
    v_lshlrev_b32 v112, 16, v198
    v_and_b32 v113, 0xffff0000, v198
    v_lshlrev_b32 v114, 16, v199
    v_and_b32 v115, 0xffff0000, v199
    v_pk_add_f32 v[178:179], v[108:109], v[204:205] op_sel_hi:[1,0]
    v_pk_add_f32 v[180:181], v[110:111], v[204:205] op_sel_hi:[1,0]
    v_pk_add_f32 v[182:183], v[112:113], v[204:205] op_sel_hi:[1,0]
    v_pk_add_f32 v[184:185], v[114:115], v[204:205] op_sel_hi:[1,0]
    v_pk_mul_f32 v[178:179], v[178:179], v[204:205] op_sel:[0,1] op_sel_hi:[1,1]
    v_pk_mul_f32 v[180:181], v[180:181], v[204:205] op_sel:[0,1] op_sel_hi:[1,1]
    v_pk_mul_f32 v[182:183], v[182:183], v[204:205] op_sel:[0,1] op_sel_hi:[1,1]
    v_pk_mul_f32 v[184:185], v[184:185], v[204:205] op_sel:[0,1] op_sel_hi:[1,1]
    v_lshlrev_b32 v116, 16, v200
    v_and_b32 v117, 0xffff0000, v200
    v_lshlrev_b32 v118, 16, v201
    v_and_b32 v119, 0xffff0000, v201
    v_lshlrev_b32 v120, 16, v202
    v_and_b32 v121, 0xffff0000, v202
    v_lshlrev_b32 v122, 16, v203
    v_and_b32 v123, 0xffff0000, v203
    v_pk_add_f32 v[88:89], v[116:117], v[204:205] op_sel_hi:[1,0]
    v_pk_add_f32 v[90:91], v[118:119], v[204:205] op_sel_hi:[1,0]
    v_pk_add_f32 v[92:93], v[120:121], v[204:205] op_sel_hi:[1,0]
    v_pk_add_f32 v[94:95], v[122:123], v[204:205] op_sel_hi:[1,0]
    v_pk_mul_f32 v[88:89], v[88:89], v[204:205] op_sel:[0,1] op_sel_hi:[1,1]
    v_pk_mul_f32 v[90:91], v[90:91], v[204:205] op_sel:[0,1] op_sel_hi:[1,1]
    v_pk_mul_f32 v[92:93], v[92:93], v[204:205] op_sel:[0,1] op_sel_hi:[1,1]
    v_pk_mul_f32 v[94:95], v[94:95], v[204:205] op_sel:[0,1] op_sel_hi:[1,1]
    s_add_u32 s32, s10, 0x720000
    s_addc_u32 s33, s11, 0
    s_mov_b32 s34, 0x240000
    s_mov_b32 s35, 0x00020000
    s_add_u32 s24, s10, 0x4d0000
    s_addc_u32 s25, s11, 0
    s_mov_b32 s26, 0x240000
    s_mov_b32 s27, 0x00020000
    s_add_u32 s28, s10, 0x4b0000
    s_addc_u32 s29, s11, 0
    s_mov_b32 s30, 0x1b00
    s_mov_b32 s31, 0x00020000
    s_waitcnt vmcnt(0)
    s_barrier
    buffer_store_dwordx4 v[216:219], v221, s[56:59], s50 offen sc1
    v_cmp_eq_u32 vcc, s51, v212
    s_nop 0
    s_bcnt1_i32_b64 s61, vcc
    s_cmp_ge_u32 s61, s60
    s_cbranch_scc1 KB_PM_X
    s_mov_b32 s19, 0
KB_PM:
    buffer_load_dword v212, v209, s[56:59], s15 offen sc1
    s_add_u32 s19, s19, 1
    s_waitcnt vmcnt(0)
    v_cmp_eq_u32 vcc, s51, v212
    s_cmp_gt_u32 s19, 0x40000
    s_cbranch_scc1 KB_PM_X
    s_bcnt1_i32_b64 s61, vcc
    s_cmp_lt_u32 s61, s60
    s_cbranch_scc1 KB_PM
KB_PM_X:
    s_barrier
    s_mov_b32 exec_hi, 0xff
    s_add_u32 m0, s101, 148480
    s_nop 0
    buffer_load_dwordx4 v98, s[28:31], s40 offen lds
    s_add_u32 m0, s101, 149120
    s_nop 0
    buffer_load_dwordx4 v98, s[28:31], s41 offen lds
    s_add_u32 m0, s101, 149760
    s_nop 0
    buffer_load_dwordx4 v98, s[28:31], s42 offen lds
    s_mov_b32 exec_hi, -1
    s_add_u32 m0, s49, 0
    s_add_u32 s18, s48, 0
    buffer_load_dwordx4 v12, s[20:23], s18 offen offset:0 lds
    s_add_u32 s18, s48, 35840
    buffer_load_dwordx4 v12, s[20:23], s18 offen offset:1024 lds
    s_add_u32 s18, s48, 71680
    buffer_load_dwordx4 v13, s[20:23], s18 offen offset:2048 lds
    s_add_u32 s18, s48, 107520
    buffer_load_dwordx4 v13, s[20:23], s18 offen offset:3072 lds
    s_add_u32 m0, s49, 4096
    s_add_u32 s18, s48, 147456
    buffer_load_dwordx4 v12, s[20:23], s18 offen offset:0 lds
    s_add_u32 s18, s48, 183296
    buffer_load_dwordx4 v12, s[20:23], s18 offen offset:1024 lds
    s_add_u32 s18, s48, 219136
    buffer_load_dwordx4 v13, s[20:23], s18 offen offset:2048 lds
    s_add_u32 s18, s48, 254976
    buffer_load_dwordx4 v13, s[20:23], s18 offen offset:3072 lds
    s_waitcnt vmcnt(8)
    ds_read_b128 v[20:23], v97 offset:0
    ds_read_b128 v[24:27], v97 offset:128
    ds_read_b128 v[28:31], v97 offset:256
    ds_read_b128 v[32:35], v97 offset:384
    ds_read_b128 v[36:39], v97 offset:512
    ds_read_b128 v[44:47], v97 offset:640
    ds_read_b128 v[48:51], v97 offset:768
    ds_read_b128 v[52:55], v97 offset:896
    ds_read_b128 v[56:59], v97 offset:1024
    ds_read_b128 v[60:63], v97 offset:1152
    ds_read_b128 v[68:71], v97 offset:1280
    ds_read_b128 v[72:75], v97 offset:1408
    ds_read_b128 v[76:79], v97 offset:1536
    ds_read_b128 v[80:83], v97 offset:1664
    ds_read_b128 v[84:87], v97 offset:1792
    s_waitcnt lgkmcnt(10)
    v_lshlrev_b32 v132, 16, v24
    v_and_b32 v133, 0xffff0000, v24
    v_lshlrev_b32 v134, 16, v25
    v_and_b32 v135, 0xffff0000, v25
    v_lshlrev_b32 v136, 16, v26
    v_and_b32 v137, 0xffff0000, v26
    s_add_u32 m0, s49, 32768
    s_add_u32 s18, s48, 589824
    buffer_load_dwordx4 v12, s[20:23], s18 offen offset:0 lds
    v_lshlrev_b32 v138, 16, v27
    v_and_b32 v139, 0xffff0000, v27
    v_lshlrev_b32 v140, 16, v20
    v_and_b32 v141, 0xffff0000, v20
    v_lshlrev_b32 v142, 16, v21
    v_and_b32 v143, 0xffff0000, v21
    s_add_u32 s18, s48, 625664
    buffer_load_dwordx4 v12, s[20:23], s18 offen offset:1024 lds
    v_lshlrev_b32 v144, 16, v22
    v_and_b32 v145, 0xffff0000, v22
    v_lshlrev_b32 v146, 16, v23
    v_and_b32 v147, 0xffff0000, v23
    v_pk_fma_f32 v[170:171], v[170:171], v[132:133], v[140:141]
    v_pk_fma_f32 v[172:173], v[172:173], v[134:135], v[142:143]
    s_add_u32 s18, s48, 661504
    buffer_load_dwordx4 v13, s[20:23], s18 offen offset:2048 lds
    v_pk_fma_f32 v[174:175], v[174:175], v[136:137], v[144:145]
    v_pk_fma_f32 v[176:177], v[176:177], v[138:139], v[146:147]
    v_lshlrev_b32 v140, 16, v28
    v_and_b32 v141, 0xffff0000, v28
    v_lshlrev_b32 v142, 16, v29
    v_and_b32 v143, 0xffff0000, v29
    s_add_u32 s18, s48, 697344
    buffer_load_dwordx4 v13, s[20:23], s18 offen offset:3072 lds
    v_lshlrev_b32 v144, 16, v30
    v_and_b32 v145, 0xffff0000, v30
    v_lshlrev_b32 v146, 16, v31
    v_and_b32 v147, 0xffff0000, v31
    v_pk_mul_f32 v[170:171], v[170:171], v[140:141]
    v_pk_mul_f32 v[172:173], v[172:173], v[142:143]
    s_add_u32 m0, s49, 36864
    s_add_u32 s18, s48, 737280
    buffer_load_dwordx4 v12, s[20:23], s18 offen offset:0 lds
    v_pk_mul_f32 v[174:175], v[174:175], v[144:145]
    v_pk_mul_f32 v[176:177], v[176:177], v[146:147]
    s_waitcnt lgkmcnt(5)
    v_lshlrev_b32 v132, 16, v48
    v_and_b32 v133, 0xffff0000, v48
    v_lshlrev_b32 v134, 16, v49
    v_and_b32 v135, 0xffff0000, v49
    s_add_u32 s18, s48, 773120
    buffer_load_dwordx4 v12, s[20:23], s18 offen offset:1024 lds
    v_lshlrev_b32 v136, 16, v50
    v_and_b32 v137, 0xffff0000, v50
    v_lshlrev_b32 v138, 16, v51
    v_and_b32 v139, 0xffff0000, v51
    v_lshlrev_b32 v140, 16, v44
    v_and_b32 v141, 0xffff0000, v44
    s_add_u32 s18, s48, 808960
    buffer_load_dwordx4 v13, s[20:23], s18 offen offset:2048 lds
    v_lshlrev_b32 v142, 16, v45
    v_and_b32 v143, 0xffff0000, v45
    v_lshlrev_b32 v144, 16, v46
    v_and_b32 v145, 0xffff0000, v46
    v_lshlrev_b32 v146, 16, v47
    v_and_b32 v147, 0xffff0000, v47
    s_add_u32 s18, s48, 844800
    buffer_load_dwordx4 v13, s[20:23], s18 offen offset:3072 lds
    v_pk_fma_f32 v[178:179], v[178:179], v[132:133], v[140:141]
    v_pk_fma_f32 v[180:181], v[180:181], v[134:135], v[142:143]
    v_pk_fma_f32 v[182:183], v[182:183], v[136:137], v[144:145]
    v_pk_fma_f32 v[184:185], v[184:185], v[138:139], v[146:147]
    v_lshlrev_b32 v140, 16, v52
    v_and_b32 v141, 0xffff0000, v52
    v_lshlrev_b32 v142, 16, v53
    v_and_b32 v143, 0xffff0000, v53
    v_lshlrev_b32 v144, 16, v54
    v_and_b32 v145, 0xffff0000, v54
    v_lshlrev_b32 v146, 16, v55
    v_and_b32 v147, 0xffff0000, v55
    v_pk_mul_f32 v[178:179], v[178:179], v[140:141]
    v_pk_mul_f32 v[180:181], v[180:181], v[142:143]
    v_pk_mul_f32 v[182:183], v[182:183], v[144:145]
    v_pk_mul_f32 v[184:185], v[184:185], v[146:147]
    s_waitcnt lgkmcnt(0)
    v_lshlrev_b32 v132, 16, v72
    v_and_b32 v133, 0xffff0000, v72
    v_lshlrev_b32 v134, 16, v73
    v_and_b32 v135, 0xffff0000, v73
    v_lshlrev_b32 v136, 16, v74
    v_and_b32 v137, 0xffff0000, v74
    v_lshlrev_b32 v138, 16, v75
    v_and_b32 v139, 0xffff0000, v75
    v_lshlrev_b32 v140, 16, v68
    v_and_b32 v141, 0xffff0000, v68
    v_lshlrev_b32 v142, 16, v69
    v_and_b32 v143, 0xffff0000, v69
    v_lshlrev_b32 v144, 16, v70
    v_and_b32 v145, 0xffff0000, v70
    v_lshlrev_b32 v146, 16, v71
    v_and_b32 v147, 0xffff0000, v71
    v_pk_fma_f32 v[88:89], v[88:89], v[132:133], v[140:141]
    v_pk_fma_f32 v[90:91], v[90:91], v[134:135], v[142:143]
    v_pk_fma_f32 v[92:93], v[92:93], v[136:137], v[144:145]
    v_pk_fma_f32 v[94:95], v[94:95], v[138:139], v[146:147]
    v_lshlrev_b32 v140, 16, v76
    v_and_b32 v141, 0xffff0000, v76
    v_lshlrev_b32 v142, 16, v77
    v_and_b32 v143, 0xffff0000, v77
    v_lshlrev_b32 v144, 16, v78
    v_and_b32 v145, 0xffff0000, v78
    v_lshlrev_b32 v146, 16, v79
    v_and_b32 v147, 0xffff0000, v79
    v_pk_mul_f32 v[88:89], v[88:89], v[140:141]
    v_pk_mul_f32 v[90:91], v[90:91], v[142:143]
    v_pk_mul_f32 v[92:93], v[92:93], v[144:145]
    v_pk_mul_f32 v[94:95], v[94:95], v[146:147]
    s_and_b32 s15, s2, 7
    s_lshl_b32 s15, s15, 15
    s_mul_i32 s50, s3, 36*128
    s_add_u32 s15, s15, s50
    s_add_u32 s15, s15, 65536
    v_cmp_gt_u32 vcc, 36, v8
    v_lshlrev_b32 v2, 7, v8
    s_nop 0
    v_cndmask_b32 v2, 2.0, v2, vcc
    s_mov_b32 s19, 0
KB_PY:
    buffer_load_dword v152, v2, s[56:59], s15 offen sc1
    s_add_u32 s19, s19, 1
    s_waitcnt vmcnt(0)
    v_cmp_eq_u32 vcc, s51, v152
    s_cmp_gt_u32 s19, 0x40000
    s_cbranch_scc1 KB_PY_X
    s_bcnt1_i32_b64 s61, vcc
    s_cmp_lt_u32 s61, 36
    s_cbranch_scc1 KB_PY
KB_PY_X:
    s_barrier
    s_add_u32 m0, s43, 135168
    s_lshl_b32 s19, s40, 4
    s_add_u32 s19, s19, s17
    buffer_load_dwordx4 v96, s[24:27], s19 offen lds
    s_add_u32 m0, s43, 136192
    s_lshl_b32 s19, s41, 4
    s_add_u32 s19, s19, s17
    buffer_load_dwordx4 v96, s[24:27], s19 offen lds
    s_add_u32 m0, s43, 137216
    s_lshl_b32 s19, s42, 4
    s_add_u32 s19, s19, s17
    buffer_load_dwordx4 v96, s[24:27], s19 offen lds
    s_add_u32 m0, s49, 65536
    s_add_u32 s18, s48, 1179648
    buffer_load_dwordx4 v12, s[20:23], s18 offen offset:0 lds
    ds_read_b64_tr_b16 a[0:1], v10 offset:0
    ds_read_b64_tr_b16 a[2:3], v10 offset:1024
    s_add_u32 s18, s48, 1215488
    buffer_load_dwordx4 v12, s[20:23], s18 offen offset:1024 lds
    ds_read_b64_tr_b16 a[4:5], v11 offset:0
    ds_read_b64_tr_b16 a[6:7], v11 offset:1024
    s_add_u32 s18, s48, 1251328
    buffer_load_dwordx4 v13, s[20:23], s18 offen offset:2048 lds
    ds_read_b64_tr_b16 a[8:9], v10 offset:16384
    ds_read_b64_tr_b16 a[10:11], v10 offset:17408
    s_add_u32 s18, s48, 1287168
    buffer_load_dwordx4 v13, s[20:23], s18 offen offset:3072 lds
    ds_read_b64_tr_b16 a[12:13], v11 offset:16384
    ds_read_b64_tr_b16 a[14:15], v11 offset:17408
    s_add_u32 m0, s49, 69632
    s_add_u32 s18, s48, 1327104
    buffer_load_dwordx4 v12, s[20:23], s18 offen offset:0 lds
    ds_read_b64_tr_b16 a[16:17], v10 offset:8192
    ds_read_b64_tr_b16 a[18:19], v10 offset:9216
    s_add_u32 s18, s48, 1362944
    buffer_load_dwordx4 v12, s[20:23], s18 offen offset:1024 lds
    ds_read_b64_tr_b16 a[20:21], v11 offset:8192
    ds_read_b64_tr_b16 a[22:23], v11 offset:9216
    s_add_u32 s18, s48, 1398784
    buffer_load_dwordx4 v13, s[20:23], s18 offen offset:2048 lds
    ds_read_b64_tr_b16 a[24:25], v10 offset:24576
    ds_read_b64_tr_b16 a[26:27], v10 offset:25600
    s_add_u32 s18, s48, 1434624
    buffer_load_dwordx4 v13, s[20:23], s18 offen offset:3072 lds
    ds_read_b64_tr_b16 a[28:29], v11 offset:24576
    ds_read_b64_tr_b16 a[30:31], v11 offset:25600
    s_add_u32 m0, s49, 98304
    s_add_u32 s18, s48, 1769472
    buffer_load_dwordx4 v12, s[20:23], s18 offen offset:0 lds
    ds_read_b64_tr_b16 a[32:33], v10 offset:32768
    ds_read_b64_tr_b16 a[34:35], v10 offset:33792
    s_add_u32 s18, s48, 1805312
    buffer_load_dwordx4 v12, s[20:23], s18 offen offset:1024 lds
    ds_read_b64_tr_b16 a[36:37], v11 offset:32768
    ds_read_b64_tr_b16 a[38:39], v11 offset:33792
    s_add_u32 s18, s48, 1841152
    buffer_load_dwordx4 v13, s[20:23], s18 offen offset:2048 lds
    ds_read_b64_tr_b16 a[40:41], v10 offset:49152
    ds_read_b64_tr_b16 a[42:43], v10 offset:50176
    s_add_u32 s18, s48, 1876992
    buffer_load_dwordx4 v13, s[20:23], s18 offen offset:3072 lds
    ds_read_b64_tr_b16 a[44:45], v11 offset:49152
    ds_read_b64_tr_b16 a[46:47], v11 offset:50176
    s_add_u32 m0, s49, 102400
    s_add_u32 s18, s48, 1916928
    buffer_load_dwordx4 v12, s[20:23], s18 offen offset:0 lds
    ds_read_b64_tr_b16 a[48:49], v10 offset:40960
    ds_read_b64_tr_b16 a[50:51], v10 offset:41984
    s_add_u32 s18, s48, 1952768
    buffer_load_dwordx4 v12, s[20:23], s18 offen offset:1024 lds
    ds_read_b64_tr_b16 a[52:53], v11 offset:40960
    ds_read_b64_tr_b16 a[54:55], v11 offset:41984
    s_add_u32 s18, s48, 1988608
    buffer_load_dwordx4 v13, s[20:23], s18 offen offset:2048 lds
    ds_read_b64_tr_b16 a[56:57], v10 offset:57344
    ds_read_b64_tr_b16 a[58:59], v10 offset:58368
    s_add_u32 s18, s48, 2024448
    buffer_load_dwordx4 v13, s[20:23], s18 offen offset:3072 lds
    ds_read_b64_tr_b16 a[60:61], v11 offset:57344
    ds_read_b64_tr_b16 a[62:63], v11 offset:58368
    s_add_u32 s24, s10, 0x960000
    s_addc_u32 s25, s11, 0
    s_mov_b32 s26, 0x240000
    s_mov_b32 s27, 0x00020000
    s_waitcnt lgkmcnt(0)
    s_barrier
    s_waitcnt vmcnt(16)
    ds_read_b64_tr_b16 v[16:17], v6 offset:0
    ds_read_b64_tr_b16 v[18:19], v6 offset:64
    ds_read_b64_tr_b16 v[40:41], v6 offset:1024
    ds_read_b64_tr_b16 v[42:43], v6 offset:1088
    ds_read_b64_tr_b16 v[64:65], v6 offset:2048
    ds_read_b64_tr_b16 v[66:67], v6 offset:2112
    s_waitcnt lgkmcnt(0)
    v_lshlrev_b32 v132, 16, v16
    v_and_b32 v133, 0xffff0000, v16
    v_lshlrev_b32 v134, 16, v17
    v_and_b32 v135, 0xffff0000, v17
    v_lshlrev_b32 v136, 16, v18
    v_and_b32 v137, 0xffff0000, v18
    v_lshlrev_b32 v138, 16, v19
    s_add_u32 m0, s49, 0
    s_add_u32 s18, s48, 2359296
    buffer_load_dwordx4 v12, s[20:23], s18 offen offset:0 lds
    v_and_b32 v139, 0xffff0000, v19
    v_pk_fma_f32 v[100:101], v[170:171], v[132:133], v[100:101]
    v_pk_fma_f32 v[102:103], v[172:173], v[134:135], v[102:103]
    v_pk_fma_f32 v[104:105], v[174:175], v[136:137], v[104:105]
    v_pk_fma_f32 v[106:107], v[176:177], v[138:139], v[106:107]
    v_lshlrev_b32 v132, 16, v40
    v_and_b32 v133, 0xffff0000, v40
    s_add_u32 s18, s48, 2395136
    buffer_load_dwordx4 v12, s[20:23], s18 offen offset:1024 lds
    v_lshlrev_b32 v134, 16, v41
    v_and_b32 v135, 0xffff0000, v41
    v_lshlrev_b32 v136, 16, v42
    v_and_b32 v137, 0xffff0000, v42
    v_lshlrev_b32 v138, 16, v43
    v_and_b32 v139, 0xffff0000, v43
    v_pk_fma_f32 v[108:109], v[178:179], v[132:133], v[108:109]
    s_add_u32 s18, s48, 2430976
    buffer_load_dwordx4 v13, s[20:23], s18 offen offset:2048 lds
    v_pk_fma_f32 v[110:111], v[180:181], v[134:135], v[110:111]
    v_pk_fma_f32 v[112:113], v[182:183], v[136:137], v[112:113]
    v_pk_fma_f32 v[114:115], v[184:185], v[138:139], v[114:115]
    v_lshlrev_b32 v132, 16, v64
    v_and_b32 v133, 0xffff0000, v64
    v_lshlrev_b32 v134, 16, v65
    v_and_b32 v135, 0xffff0000, v65
    s_add_u32 s18, s48, 2466816
    buffer_load_dwordx4 v13, s[20:23], s18 offen offset:3072 lds
    v_lshlrev_b32 v136, 16, v66
    v_and_b32 v137, 0xffff0000, v66
    v_lshlrev_b32 v138, 16, v67
    v_and_b32 v139, 0xffff0000, v67
    v_pk_fma_f32 v[116:117], v[88:89], v[132:133], v[116:117]
    v_pk_fma_f32 v[118:119], v[90:91], v[134:135], v[118:119]
    v_pk_fma_f32 v[120:121], v[92:93], v[136:137], v[120:121]
    s_add_u32 m0, s49, 4096
    s_add_u32 s18, s48, 2506752
    buffer_load_dwordx4 v12, s[20:23], s18 offen offset:0 lds
    v_pk_fma_f32 v[122:123], v[94:95], v[138:139], v[122:123]
    v_pk_add_f32 v[124:125], v[100:101], v[102:103]
    v_pk_add_f32 v[126:127], v[104:105], v[106:107]
    v_pk_add_f32 v[124:125], v[124:125], v[126:127]
    v_add_f32 v152, v124, v125
    v_pk_add_f32 v[124:125], v[108:109], v[110:111]
    v_pk_add_f32 v[126:127], v[112:113], v[114:115]
    s_add_u32 s18, s48, 2542592
    buffer_load_dwordx4 v12, s[20:23], s18 offen offset:1024 lds
    v_pk_add_f32 v[124:125], v[124:125], v[126:127]
    v_add_f32 v154, v124, v125
    v_pk_add_f32 v[124:125], v[116:117], v[118:119]
    v_pk_add_f32 v[126:127], v[120:121], v[122:123]
    v_pk_add_f32 v[124:125], v[124:125], v[126:127]
    v_add_f32 v156, v124, v125
    v_add_f32_dpp v152, v152, v152 row_ror:8 row_mask:0xf bank_mask:0xf
    v_add_f32_dpp v154, v154, v154 row_ror:8 row_mask:0xf bank_mask:0xf
    v_add_f32_dpp v156, v156, v156 row_ror:8 row_mask:0xf bank_mask:0xf
    v_mov_b32 v140, v152
    s_add_u32 s18, s48, 2578432
    buffer_load_dwordx4 v13, s[20:23], s18 offen offset:2048 lds
    v_mov_b32 v141, v154
    v_mov_b32 v142, v156
    v_permlane16_swap_b32 v152, v140
    v_permlane16_swap_b32 v154, v141
    v_permlane16_swap_b32 v156, v142
    v_add_f32 v152, v152, v140
    v_add_f32 v154, v154, v141
    v_add_f32 v156, v156, v142
    v_mov_b32 v140, v152
    v_mov_b32 v141, v154
    s_add_u32 s18, s48, 2614272
    buffer_load_dwordx4 v13, s[20:23], s18 offen offset:3072 lds
    v_mov_b32 v142, v156
    v_permlane32_swap_b32 v152, v140
    v_permlane32_swap_b32 v154, v141
    v_permlane32_swap_b32 v156, v142
    v_add_f32 v152, v152, v140
    v_add_f32 v154, v154, v141
    v_add_f32 v156, v156, v142
    v_mul_f32 v152, 0xbc800000, v152
    v_mul_f32 v154, 0xbc800000, v154
    v_mul_f32 v156, 0xbc800000, v156
    s_add_u32 m0, s49, 32768
    s_add_u32 s18, s48, 2949120
    buffer_load_dwordx4 v12, s[20:23], s18 offen offset:0 lds
    v_pk_add_f32 v[124:125], v[100:101], v[152:153] op_sel_hi:[1,0]
    v_pk_add_f32 v[126:127], v[102:103], v[152:153] op_sel_hi:[1,0]
    v_pk_add_f32 v[128:129], v[104:105], v[152:153] op_sel_hi:[1,0]
    v_pk_add_f32 v[130:131], v[106:107], v[152:153] op_sel_hi:[1,0]
    v_pk_mul_f32 v[124:125], v[124:125], v[124:125]
    v_pk_fma_f32 v[124:125], v[126:127], v[126:127], v[124:125]
    v_pk_fma_f32 v[124:125], v[128:129], v[128:129], v[124:125]
    s_add_u32 s18, s48, 2984960
    buffer_load_dwordx4 v12, s[20:23], s18 offen offset:1024 lds
    v_pk_fma_f32 v[124:125], v[130:131], v[130:131], v[124:125]
    v_add_f32 v153, v124, v125
    v_pk_add_f32 v[124:125], v[108:109], v[154:155] op_sel_hi:[1,0]
    v_pk_add_f32 v[126:127], v[110:111], v[154:155] op_sel_hi:[1,0]
    v_pk_add_f32 v[128:129], v[112:113], v[154:155] op_sel_hi:[1,0]
    v_pk_add_f32 v[130:131], v[114:115], v[154:155] op_sel_hi:[1,0]
    v_pk_mul_f32 v[124:125], v[124:125], v[124:125]
    s_add_u32 s18, s48, 3020800
    buffer_load_dwordx4 v13, s[20:23], s18 offen offset:2048 lds
    v_pk_fma_f32 v[124:125], v[126:127], v[126:127], v[124:125]
    v_pk_fma_f32 v[124:125], v[128:129], v[128:129], v[124:125]
    v_pk_fma_f32 v[124:125], v[130:131], v[130:131], v[124:125]
    v_add_f32 v155, v124, v125
    v_pk_add_f32 v[124:125], v[116:117], v[156:157] op_sel_hi:[1,0]
    v_pk_add_f32 v[126:127], v[118:119], v[156:157] op_sel_hi:[1,0]
    v_pk_add_f32 v[128:129], v[120:121], v[156:157] op_sel_hi:[1,0]
    s_add_u32 s18, s48, 3056640
    buffer_load_dwordx4 v13, s[20:23], s18 offen offset:3072 lds
    v_pk_add_f32 v[130:131], v[122:123], v[156:157] op_sel_hi:[1,0]
    v_pk_mul_f32 v[124:125], v[124:125], v[124:125]
    v_pk_fma_f32 v[124:125], v[126:127], v[126:127], v[124:125]
    v_pk_fma_f32 v[124:125], v[128:129], v[128:129], v[124:125]
    v_pk_fma_f32 v[124:125], v[130:131], v[130:131], v[124:125]
    v_add_f32 v157, v124, v125
    v_add_f32_dpp v153, v153, v153 row_ror:8 row_mask:0xf bank_mask:0xf
    v_add_f32_dpp v155, v155, v155 row_ror:8 row_mask:0xf bank_mask:0xf
    v_add_f32_dpp v157, v157, v157 row_ror:8 row_mask:0xf bank_mask:0xf
    v_mov_b32 v140, v153
    s_add_u32 m0, s49, 36864
    s_add_u32 s18, s48, 3096576
    buffer_load_dwordx4 v12, s[20:23], s18 offen offset:0 lds
    v_mov_b32 v141, v155
    v_mov_b32 v142, v157
    v_permlane16_swap_b32 v153, v140
    v_permlane16_swap_b32 v155, v141
    v_permlane16_swap_b32 v157, v142
    v_add_f32 v153, v153, v140
    v_add_f32 v155, v155, v141
    v_add_f32 v157, v157, v142
    v_mov_b32 v140, v153
    v_mov_b32 v141, v155
    s_add_u32 s18, s48, 3132416
    buffer_load_dwordx4 v12, s[20:23], s18 offen offset:1024 lds
    v_mov_b32 v142, v157
    v_permlane32_swap_b32 v153, v140
    v_permlane32_swap_b32 v155, v141
    v_permlane32_swap_b32 v157, v142
    v_add_f32 v153, v153, v140
    v_add_f32 v155, v155, v141
    v_add_f32 v157, v157, v142
    ds_write_b64 v7, v[152:153]
    ds_write_b64 v7, v[154:155] offset:256
    ds_write_b64 v7, v[156:157] offset:512
    v_cvt_pk_bf16_f32 v192, v100, v101
    v_cvt_pk_bf16_f32 v193, v102, v103
    v_cvt_pk_bf16_f32 v194, v104, v105
    s_add_u32 s18, s48, 3168256
    buffer_load_dwordx4 v13, s[20:23], s18 offen offset:2048 lds
    v_cvt_pk_bf16_f32 v195, v106, v107
    buffer_store_dwordx4 v[192:195], v5, s[32:35], s44 offen sc1
    v_cvt_pk_bf16_f32 v196, v108, v109
    v_cvt_pk_bf16_f32 v197, v110, v111
    v_cvt_pk_bf16_f32 v198, v112, v113
    v_cvt_pk_bf16_f32 v199, v114, v115
    buffer_store_dwordx4 v[196:199], v5, s[32:35], s45 offen sc1
    v_cvt_pk_bf16_f32 v200, v116, v117
    v_cvt_pk_bf16_f32 v201, v118, v119
    s_add_u32 s18, s48, 3204096
    buffer_load_dwordx4 v13, s[20:23], s18 offen offset:3072 lds
    v_cvt_pk_bf16_f32 v202, v120, v121
    v_cvt_pk_bf16_f32 v203, v122, v123
    buffer_store_dwordx4 v[200:203], v5, s[32:35], s46 offen sc1
    s_waitcnt vmcnt(19)
    s_waitcnt lgkmcnt(0)
    s_barrier
    ds_read_b64 v[152:153], v3 offset:0
    ds_read_b64 v[154:155], v3 offset:64
    ds_read_b64 v[156:157], v3 offset:128
    ds_read_b64 v[158:159], v3 offset:192
    ds_read_b64 v[160:161], v3 offset:256
    ds_read_b64 v[162:163], v3 offset:320
    ds_read_b64 v[164:165], v3 offset:384
    ds_read_b64 v[166:167], v3 offset:448
    ds_read_b64 v[168:169], v3 offset:512
    s_waitcnt lgkmcnt(0)
    v_pk_add_f32 v[148:149], v[152:153], v[154:155]
    v_pk_add_f32 v[124:125], v[156:157], v[158:159]
    v_pk_add_f32 v[126:127], v[160:161], v[162:163]
    v_pk_add_f32 v[128:129], v[164:165], v[166:167]
    v_pk_add_f32 v[148:149], v[148:149], v[168:169]
    v_pk_add_f32 v[124:125], v[124:125], v[126:127]
    v_pk_add_f32 v[148:149], v[148:149], v[128:129]
    v_pk_add_f32 v[148:149], v[148:149], v[124:125]
    ds_read_b64_tr_b16 a[64:65], v14 offset:0
    ds_read_b64_tr_b16 a[66:67], v14 offset:1024
    v_mul_f32 v148, 0x3de38e39, v148
    v_sub_f32 v152, v152, v148
    v_sub_f32 v154, v154, v148
    v_sub_f32 v156, v156, v148
    v_sub_f32 v158, v158, v148
    v_sub_f32 v160, v160, v148
    v_sub_f32 v162, v162, v148
    v_sub_f32 v164, v164, v148
    ds_read_b64_tr_b16 a[68:69], v15 offset:0
    ds_read_b64_tr_b16 a[70:71], v15 offset:1024
    v_sub_f32 v166, v166, v148
    v_sub_f32 v168, v168, v148
    v_mul_f32 v150, v152, v152
    v_mul_f32 v124, v154, v154
    v_fmac_f32 v150, v156, v156
    v_fmac_f32 v124, v158, v158
    v_fmac_f32 v150, v160, v160
    v_fmac_f32 v124, v162, v162
    ds_read_b64_tr_b16 a[72:73], v14 offset:16384
    ds_read_b64_tr_b16 a[74:75], v14 offset:17408
    v_fmac_f32 v150, v164, v164
    v_fmac_f32 v124, v166, v166
    v_fmac_f32 v150, v168, v168
    v_add_f32 v150, v150, v124
    v_fmac_f32 v149, 0x42800000, v150
    v_mov_b32 v150, 0x3727c5ac
    v_fmac_f32 v150, 0x3ae38e39, v149
    v_rsq_f32 v149, v150
    ds_read_b64_tr_b16 a[76:77], v15 offset:16384
    ds_read_b64_tr_b16 a[78:79], v15 offset:17408
    v_pk_add_f32 v[124:125], v[100:101], v[148:149] op_sel_hi:[1,0]
    v_pk_add_f32 v[126:127], v[102:103], v[148:149] op_sel_hi:[1,0]
    v_pk_add_f32 v[128:129], v[104:105], v[148:149] op_sel_hi:[1,0]
    v_pk_add_f32 v[130:131], v[106:107], v[148:149] op_sel_hi:[1,0]
    v_lshlrev_b32 v132, 16, v36
    v_and_b32 v133, 0xffff0000, v36
    v_lshlrev_b32 v134, 16, v37
    v_and_b32 v135, 0xffff0000, v37
    ds_read_b64_tr_b16 a[80:81], v14 offset:8192
    ds_read_b64_tr_b16 a[82:83], v14 offset:9216
    v_lshlrev_b32 v136, 16, v38
    v_and_b32 v137, 0xffff0000, v38
    v_lshlrev_b32 v138, 16, v39
    v_and_b32 v139, 0xffff0000, v39
    v_pk_mul_f32 v[124:125], v[124:125], v[148:149] op_sel:[0,1] op_sel_hi:[1,1]
    v_pk_mul_f32 v[126:127], v[126:127], v[148:149] op_sel:[0,1] op_sel_hi:[1,1]
    v_pk_mul_f32 v[128:129], v[128:129], v[148:149] op_sel:[0,1] op_sel_hi:[1,1]
    v_pk_mul_f32 v[130:131], v[130:131], v[148:149] op_sel:[0,1] op_sel_hi:[1,1]
    ds_read_b64_tr_b16 a[84:85], v15 offset:8192
    ds_read_b64_tr_b16 a[86:87], v15 offset:9216
    v_lshlrev_b32 v140, 16, v32
    v_and_b32 v141, 0xffff0000, v32
    v_lshlrev_b32 v142, 16, v33
    v_and_b32 v143, 0xffff0000, v33
    v_lshlrev_b32 v144, 16, v34
    v_and_b32 v145, 0xffff0000, v34
    v_lshlrev_b32 v146, 16, v35
    v_and_b32 v147, 0xffff0000, v35
    ds_read_b64_tr_b16 a[88:89], v14 offset:24576
    ds_read_b64_tr_b16 a[90:91], v14 offset:25600
    v_pk_fma_f32 v[124:125], v[124:125], v[132:133], v[140:141]
    v_pk_fma_f32 v[126:127], v[126:127], v[134:135], v[142:143]
    v_pk_fma_f32 v[128:129], v[128:129], v[136:137], v[144:145]
    v_pk_fma_f32 v[130:131], v[130:131], v[138:139], v[146:147]
    v_cvt_pk_bf16_f32 v16, v124, v125
    v_cvt_pk_bf16_f32 v17, v126, v127
    v_cvt_pk_bf16_f32 v18, v128, v129
    v_cvt_pk_bf16_f32 v19, v130, v131
    ds_read_b64_tr_b16 a[92:93], v15 offset:24576
    ds_read_b64_tr_b16 a[94:95], v15 offset:25600
    s_lshl_b32 s19, s40, 4
    s_add_u32 s19, s19, s16
    buffer_store_dwordx4 v[16:19], v4, s[24:27], s19 offen sc1
    v_pk_add_f32 v[124:125], v[108:109], v[148:149] op_sel_hi:[1,0]
    v_pk_add_f32 v[126:127], v[110:111], v[148:149] op_sel_hi:[1,0]
    v_pk_add_f32 v[128:129], v[112:113], v[148:149] op_sel_hi:[1,0]
    v_pk_add_f32 v[130:131], v[114:115], v[148:149] op_sel_hi:[1,0]
    v_lshlrev_b32 v132, 16, v60
    v_and_b32 v133, 0xffff0000, v60
    v_lshlrev_b32 v134, 16, v61
    v_and_b32 v135, 0xffff0000, v61
    ds_read_b64_tr_b16 a[96:97], v14 offset:32768
    ds_read_b64_tr_b16 a[98:99], v14 offset:33792
    v_lshlrev_b32 v136, 16, v62
    v_and_b32 v137, 0xffff0000, v62
    v_lshlrev_b32 v138, 16, v63
    v_and_b32 v139, 0xffff0000, v63
    v_pk_mul_f32 v[124:125], v[124:125], v[148:149] op_sel:[0,1] op_sel_hi:[1,1]
    v_pk_mul_f32 v[126:127], v[126:127], v[148:149] op_sel:[0,1] op_sel_hi:[1,1]
    v_pk_mul_f32 v[128:129], v[128:129], v[148:149] op_sel:[0,1] op_sel_hi:[1,1]
    v_pk_mul_f32 v[130:131], v[130:131], v[148:149] op_sel:[0,1] op_sel_hi:[1,1]
    ds_read_b64_tr_b16 a[100:101], v15 offset:32768
    ds_read_b64_tr_b16 a[102:103], v15 offset:33792
    v_lshlrev_b32 v140, 16, v56
    v_and_b32 v141, 0xffff0000, v56
    v_lshlrev_b32 v142, 16, v57
    v_and_b32 v143, 0xffff0000, v57
    v_lshlrev_b32 v144, 16, v58
    v_and_b32 v145, 0xffff0000, v58
    v_lshlrev_b32 v146, 16, v59
    v_and_b32 v147, 0xffff0000, v59
    ds_read_b64_tr_b16 a[104:105], v14 offset:49152
    ds_read_b64_tr_b16 a[106:107], v14 offset:50176
    v_pk_fma_f32 v[124:125], v[124:125], v[132:133], v[140:141]
    v_pk_fma_f32 v[126:127], v[126:127], v[134:135], v[142:143]
    v_pk_fma_f32 v[128:129], v[128:129], v[136:137], v[144:145]
    v_pk_fma_f32 v[130:131], v[130:131], v[138:139], v[146:147]
    v_cvt_pk_bf16_f32 v40, v124, v125
    v_cvt_pk_bf16_f32 v41, v126, v127
    v_cvt_pk_bf16_f32 v42, v128, v129
    v_cvt_pk_bf16_f32 v43, v130, v131
    ds_read_b64_tr_b16 a[108:109], v15 offset:49152
    ds_read_b64_tr_b16 a[110:111], v15 offset:50176
    s_lshl_b32 s19, s41, 4
    s_add_u32 s19, s19, s16
    buffer_store_dwordx4 v[40:43], v4, s[24:27], s19 offen sc1
    v_pk_add_f32 v[124:125], v[116:117], v[148:149] op_sel_hi:[1,0]
    v_pk_add_f32 v[126:127], v[118:119], v[148:149] op_sel_hi:[1,0]
    v_pk_add_f32 v[128:129], v[120:121], v[148:149] op_sel_hi:[1,0]
    v_pk_add_f32 v[130:131], v[122:123], v[148:149] op_sel_hi:[1,0]
    v_lshlrev_b32 v132, 16, v84
    v_and_b32 v133, 0xffff0000, v84
    v_lshlrev_b32 v134, 16, v85
    v_and_b32 v135, 0xffff0000, v85
    ds_read_b64_tr_b16 a[112:113], v14 offset:40960
    ds_read_b64_tr_b16 a[114:115], v14 offset:41984
    v_lshlrev_b32 v136, 16, v86
    v_and_b32 v137, 0xffff0000, v86
    v_lshlrev_b32 v138, 16, v87
    v_and_b32 v139, 0xffff0000, v87
    v_pk_mul_f32 v[124:125], v[124:125], v[148:149] op_sel:[0,1] op_sel_hi:[1,1]
    v_pk_mul_f32 v[126:127], v[126:127], v[148:149] op_sel:[0,1] op_sel_hi:[1,1]
    v_pk_mul_f32 v[128:129], v[128:129], v[148:149] op_sel:[0,1] op_sel_hi:[1,1]
    v_pk_mul_f32 v[130:131], v[130:131], v[148:149] op_sel:[0,1] op_sel_hi:[1,1]
    ds_read_b64_tr_b16 a[116:117], v15 offset:40960
    ds_read_b64_tr_b16 a[118:119], v15 offset:41984
    v_lshlrev_b32 v140, 16, v80
    v_and_b32 v141, 0xffff0000, v80
    v_lshlrev_b32 v142, 16, v81
    v_and_b32 v143, 0xffff0000, v81
    v_lshlrev_b32 v144, 16, v82
    v_and_b32 v145, 0xffff0000, v82
    v_lshlrev_b32 v146, 16, v83
    v_and_b32 v147, 0xffff0000, v83
    ds_read_b64_tr_b16 a[120:121], v14 offset:57344
    ds_read_b64_tr_b16 a[122:123], v14 offset:58368
    v_pk_fma_f32 v[124:125], v[124:125], v[132:133], v[140:141]
    v_pk_fma_f32 v[126:127], v[126:127], v[134:135], v[142:143]
    v_pk_fma_f32 v[128:129], v[128:129], v[136:137], v[144:145]
    v_pk_fma_f32 v[130:131], v[130:131], v[138:139], v[146:147]
    v_cvt_pk_bf16_f32 v64, v124, v125
    v_cvt_pk_bf16_f32 v65, v126, v127
    v_cvt_pk_bf16_f32 v66, v128, v129
    v_cvt_pk_bf16_f32 v67, v130, v131
    ds_read_b64_tr_b16 a[124:125], v15 offset:57344
    ds_read_b64_tr_b16 a[126:127], v15 offset:58368
    s_lshl_b32 s19, s42, 4
    s_add_u32 s19, s19, s16
    buffer_store_dwordx4 v[64:67], v4, s[24:27], s19 offen sc1
    s_lshl_b32 s8, s5, 2
    s_add_u32 s8, s8, s3
    s_mul_i32 s13, s7, 18432
    s_add_u32 s16, s43, s13
    s_mul_i32 s14, s7, 147456
    s_lshl_b32 s9, s8, 10
    s_add_u32 s14, s14, s9
    s_add_u32 s28, s10, 0x1c00000
    s_addc_u32 s29, s11, 0
    s_mov_b32 s30, 0x1200000
    s_mov_b32 s31, 0x00020000
    s_add_u32 s9, s47, 1
    s_lshl_b32 s9, s9, 7
    s_mov_b32 s13, 0x24924925
    s_mul_hi_u32 s9, s9, s13
    s_mul_i32 s26, s9, 18432
    s_mul_i32 s30, s9, 147456
    v_mov_b32 v3, v1
    v_add_u32 v4, 0x10000, v1
    v_add_u32 v5, 0x20000, v1
    s_lshl_b32 s15, s100, 7
    s_add_u32 s15, s15, 327680
    s_cmp_lg_u32 s3, 0
    s_cselect_b32 s15, 720896, s15
    s_waitcnt vmcnt(0) lgkmcnt(0)
    s_barrier
    buffer_store_dwordx4 v[216:219], v221, s[56:59], s15 offen sc1
    s_add_u32 m0, s49, 65536
    s_add_u32 s18, s48, 3538944
    buffer_load_dwordx4 v12, s[20:23], s18 offen offset:0 lds
    ds_read_b64_tr_b16 a[128:129], v10 offset:0
    ds_read_b64_tr_b16 a[130:131], v10 offset:1024
    s_add_u32 s18, s48, 3574784
    buffer_load_dwordx4 v12, s[20:23], s18 offen offset:1024 lds
    ds_read_b64_tr_b16 a[132:133], v11 offset:0
    ds_read_b64_tr_b16 a[134:135], v11 offset:1024
    s_add_u32 s18, s48, 3610624
    buffer_load_dwordx4 v13, s[20:23], s18 offen offset:2048 lds
    ds_read_b64_tr_b16 a[136:137], v10 offset:16384
    ds_read_b64_tr_b16 a[138:139], v10 offset:17408
    s_add_u32 s18, s48, 3646464
    buffer_load_dwordx4 v13, s[20:23], s18 offen offset:3072 lds
    ds_read_b64_tr_b16 a[140:141], v11 offset:16384
    ds_read_b64_tr_b16 a[142:143], v11 offset:17408
    s_add_u32 m0, s49, 69632
    s_add_u32 s18, s48, 3686400
    buffer_load_dwordx4 v12, s[20:23], s18 offen offset:0 lds
    ds_read_b64_tr_b16 a[144:145], v10 offset:8192
    ds_read_b64_tr_b16 a[146:147], v10 offset:9216
    s_add_u32 s18, s48, 3722240
    buffer_load_dwordx4 v12, s[20:23], s18 offen offset:1024 lds
    ds_read_b64_tr_b16 a[148:149], v11 offset:8192
    ds_read_b64_tr_b16 a[150:151], v11 offset:9216
    s_add_u32 s18, s48, 3758080
    buffer_load_dwordx4 v13, s[20:23], s18 offen offset:2048 lds
    ds_read_b64_tr_b16 a[152:153], v10 offset:24576
    ds_read_b64_tr_b16 a[154:155], v10 offset:25600
    s_add_u32 s18, s48, 3793920
    buffer_load_dwordx4 v13, s[20:23], s18 offen offset:3072 lds
    ds_read_b64_tr_b16 a[156:157], v11 offset:24576
    ds_read_b64_tr_b16 a[158:159], v11 offset:25600
    s_add_u32 m0, s49, 98304
    s_add_u32 s18, s48, 4128768
    buffer_load_dwordx4 v12, s[20:23], s18 offen offset:0 lds
    ds_read_b64_tr_b16 a[160:161], v10 offset:32768
    ds_read_b64_tr_b16 a[162:163], v10 offset:33792
    s_add_u32 s18, s48, 4164608
    buffer_load_dwordx4 v12, s[20:23], s18 offen offset:1024 lds
    ds_read_b64_tr_b16 a[164:165], v11 offset:32768
    ds_read_b64_tr_b16 a[166:167], v11 offset:33792
    s_add_u32 s18, s48, 4200448
    buffer_load_dwordx4 v13, s[20:23], s18 offen offset:2048 lds
    ds_read_b64_tr_b16 a[168:169], v10 offset:49152
    ds_read_b64_tr_b16 a[170:171], v10 offset:50176
    s_add_u32 s18, s48, 4236288
    buffer_load_dwordx4 v13, s[20:23], s18 offen offset:3072 lds
    ds_read_b64_tr_b16 a[172:173], v11 offset:49152
    ds_read_b64_tr_b16 a[174:175], v11 offset:50176
    s_add_u32 m0, s49, 102400
    s_add_u32 s18, s48, 4276224
    buffer_load_dwordx4 v12, s[20:23], s18 offen offset:0 lds
    ds_read_b64_tr_b16 a[176:177], v10 offset:40960
    ds_read_b64_tr_b16 a[178:179], v10 offset:41984
    s_add_u32 s18, s48, 4312064
    buffer_load_dwordx4 v12, s[20:23], s18 offen offset:1024 lds
    ds_read_b64_tr_b16 a[180:181], v11 offset:40960
    ds_read_b64_tr_b16 a[182:183], v11 offset:41984
    s_add_u32 s18, s48, 4347904
    buffer_load_dwordx4 v13, s[20:23], s18 offen offset:2048 lds
    ds_read_b64_tr_b16 a[184:185], v10 offset:57344
    ds_read_b64_tr_b16 a[186:187], v10 offset:58368
    s_add_u32 s18, s48, 4383744
    buffer_load_dwordx4 v13, s[20:23], s18 offen offset:3072 lds
    ds_read_b64_tr_b16 a[188:189], v11 offset:57344
    ds_read_b64_tr_b16 a[190:191], v11 offset:58368
    v_lshlrev_b32 v6, 7, v8
    v_cmp_gt_u32 vcc, 38, v8
    s_and_b32 s15, s2, 7
    s_nop 0
    v_cndmask_b32 v6, 2.0, v6, vcc
    s_lshl_b32 s15, s15, 15
    s_lshl_b32 s17, s7, 8
    s_add_u32 s15, s15, s17
    s_add_u32 s15, s15, 327680
    s_cmp_lg_u32 s3, 0
    s_cbranch_scc1 KB_P1_X
    s_mov_b32 s19, 0
KB_P1:
    buffer_load_dword v16, v6, s[56:59], s15 offen sc1
    s_add_u32 s19, s19, 1
    s_waitcnt vmcnt(0)
    v_cmp_eq_u32 vcc, s51, v16
    s_cmp_gt_u32 s19, 0x40000
    s_cbranch_scc1 KB_P1_X
    s_bcnt1_i32_b64 s61, vcc
    s_cmp_lt_u32 s61, 38
    s_cbranch_scc1 KB_P1
KB_P1_X:
    s_waitcnt vmcnt(0) lgkmcnt(0)
    s_barrier
    s_cmp_ge_u32 s4, 252
    s_cbranch_scc1 KB_IDLE
    s_add_u32 m0, s43, 135168
    s_add_u32 s17, s16, 0
    buffer_load_dwordx4 v1, s[24:27], s17 offen offset:0 lds
    buffer_load_dwordx4 v1, s[24:27], s17 offen offset:1024 lds
    buffer_load_dwordx4 v1, s[24:27], s17 offen offset:2048 lds
    s_add_u32 m0, s43, 147456
    s_add_u32 s17, s16, 12288
    buffer_load_dwordx4 v1, s[24:27], s17 offen offset:0 lds
    buffer_load_dwordx4 v1, s[24:27], s17 offen offset:1024 lds
    buffer_load_dwordx4 v1, s[24:27], s17 offen offset:2048 lds
    s_add_u32 m0, s49, 0
    s_add_u32 s18, s48, 4718592
    buffer_load_dwordx4 v12, s[20:23], s18 offen offset:0 lds
    s_add_u32 s18, s48, 4754432
    buffer_load_dwordx4 v12, s[20:23], s18 offen offset:1024 lds
    s_add_u32 s18, s48, 4790272
    buffer_load_dwordx4 v13, s[20:23], s18 offen offset:2048 lds
    s_add_u32 s18, s48, 4826112
    buffer_load_dwordx4 v13, s[20:23], s18 offen offset:3072 lds
    s_add_u32 m0, s49, 4096
    s_add_u32 s18, s48, 4866048
    buffer_load_dwordx4 v12, s[20:23], s18 offen offset:0 lds
    s_add_u32 s18, s48, 4901888
    buffer_load_dwordx4 v12, s[20:23], s18 offen offset:1024 lds
    s_add_u32 s18, s48, 4937728
    buffer_load_dwordx4 v13, s[20:23], s18 offen offset:2048 lds
    s_add_u32 s18, s48, 4973568
    buffer_load_dwordx4 v13, s[20:23], s18 offen offset:3072 lds
    s_add_u32 m0, s43, 36864
    s_add_u32 s17, s16, 24576
    buffer_load_dwordx4 v1, s[24:27], s17 offen offset:0 lds
    buffer_load_dwordx4 v1, s[24:27], s17 offen offset:1024 lds
    buffer_load_dwordx4 v1, s[24:27], s17 offen offset:2048 lds
    s_add_u32 m0, s43, 49152
    s_add_u32 s17, s16, 36864
    buffer_load_dwordx4 v1, s[24:27], s17 offen offset:0 lds
    buffer_load_dwordx4 v1, s[24:27], s17 offen offset:1024 lds
    buffer_load_dwordx4 v1, s[24:27], s17 offen offset:2048 lds
    ds_read_b64_tr_b16 a[192:193], v14 offset:0
    ds_read_b64_tr_b16 a[194:195], v14 offset:1024
    ds_read_b64_tr_b16 a[196:197], v15 offset:0
    ds_read_b64_tr_b16 a[198:199], v15 offset:1024
    ds_read_b64_tr_b16 a[200:201], v14 offset:16384
    ds_read_b64_tr_b16 a[202:203], v14 offset:17408
    ds_read_b64_tr_b16 a[204:205], v15 offset:16384
    ds_read_b64_tr_b16 a[206:207], v15 offset:17408
    ds_read_b64_tr_b16 a[208:209], v14 offset:8192
    ds_read_b64_tr_b16 a[210:211], v14 offset:9216
    ds_read_b64_tr_b16 a[212:213], v15 offset:8192
    ds_read_b64_tr_b16 a[214:215], v15 offset:9216
    ds_read_b64_tr_b16 a[216:217], v14 offset:24576
    ds_read_b64_tr_b16 a[218:219], v14 offset:25600
    ds_read_b64_tr_b16 a[220:221], v15 offset:24576
    ds_read_b64_tr_b16 a[222:223], v15 offset:25600
    ds_read_b64_tr_b16 a[224:225], v14 offset:32768
    ds_read_b64_tr_b16 a[226:227], v14 offset:33792
    ds_read_b64_tr_b16 a[228:229], v15 offset:32768
    ds_read_b64_tr_b16 a[230:231], v15 offset:33792
    ds_read_b64_tr_b16 a[232:233], v14 offset:49152
    ds_read_b64_tr_b16 a[234:235], v14 offset:50176
    ds_read_b64_tr_b16 a[236:237], v15 offset:49152
    ds_read_b64_tr_b16 a[238:239], v15 offset:50176
    ds_read_b64_tr_b16 a[240:241], v14 offset:40960
    ds_read_b64_tr_b16 a[242:243], v14 offset:41984
    ds_read_b64_tr_b16 a[244:245], v15 offset:40960
    ds_read_b64_tr_b16 a[246:247], v15 offset:41984
    ds_read_b64_tr_b16 a[248:249], v14 offset:57344
    ds_read_b64_tr_b16 a[250:251], v14 offset:58368
    ds_read_b64_tr_b16 a[252:253], v15 offset:57344
    ds_read_b64_tr_b16 a[254:255], v15 offset:58368
    s_waitcnt lgkmcnt(0)
    s_mov_b32 s9, 0xbfb8aa3b
    s_waitcnt vmcnt(17)
    s_barrier
    ds_read_b128 v[16:19], v5 offset:4096
    ds_read_b128 v[20:23], v5 offset:5120
    ds_read_b128 v[24:27], v5 offset:6144
    s_waitcnt lgkmcnt(2)
    v_mfma_f32_16x16x32_bf16 v[64:67], a[0:3], v[16:19], 0
    ds_read_b128 v[28:31], v5 offset:7168
    s_lshr_b32 s60, s4, 6
    v_mfma_f32_16x16x32_bf16 v[68:71], a[4:7], v[16:19], 0
    s_mul_i32 s60, s60, 36
    v_mfma_f32_16x16x32_bf16 v[72:75], a[8:11], v[16:19], 0
    s_add_u32 m0, s43, 61440
    s_add_u32 s17, s16, 49152
    buffer_load_dwordx4 v1, s[24:27], s17 offen offset:0 lds
    v_mfma_f32_16x16x32_bf16 v[76:79], a[12:15], v[16:19], 0
    s_add_u32 s60, s60, s3
    s_waitcnt lgkmcnt(2)
    v_mfma_f32_16x16x32_bf16 v[64:67], a[16:19], v[20:23], v[64:67]
    ds_read_b128 v[16:19], v5 offset:8192
    s_mul_i32 s60, s60, 36864
    v_mfma_f32_16x16x32_bf16 v[68:71], a[20:23], v[20:23], v[68:71]
    s_and_b32 s62, s4, 3
    v_mfma_f32_16x16x32_bf16 v[72:75], a[24:27], v[20:23], v[72:75]
    buffer_load_dwordx4 v1, s[24:27], s17 offen offset:1024 lds
    v_mfma_f32_16x16x32_bf16 v[76:79], a[28:31], v[20:23], v[76:79]
    s_mul_i32 s62, s62, 288
    s_waitcnt lgkmcnt(2)
    v_mfma_f32_16x16x32_bf16 v[64:67], a[32:35], v[24:27], v[64:67]
    ds_read_b128 v[20:23], v5 offset:9216
    s_add_u32 s60, s60, s62
    v_mfma_f32_16x16x32_bf16 v[68:71], a[36:39], v[24:27], v[68:71]
    s_mul_i32 s62, s3, 9216
    v_mfma_f32_16x16x32_bf16 v[72:75], a[40:43], v[24:27], v[72:75]
    buffer_load_dwordx4 v1, s[24:27], s17 offen offset:2048 lds
    v_mfma_f32_16x16x32_bf16 v[76:79], a[44:47], v[24:27], v[76:79]
    s_mov_b32 s54, 5308416
    s_waitcnt lgkmcnt(2)
    v_mfma_f32_16x16x32_bf16 v[64:67], a[48:51], v[28:31], v[64:67]
    ds_read_b128 v[24:27], v5 offset:10240
    s_mov_b32 s55, 0x00020000
    v_mfma_f32_16x16x32_bf16 v[68:71], a[52:55], v[28:31], v[68:71]
    s_and_b32 s12, s4, 31
    v_mfma_f32_16x16x32_bf16 v[72:75], a[56:59], v[28:31], v[72:75]
    s_add_u32 m0, s43, 73728
    s_add_u32 s17, s16, 61440
    buffer_load_dwordx4 v1, s[24:27], s17 offen offset:0 lds
    v_mfma_f32_16x16x32_bf16 v[76:79], a[60:63], v[28:31], v[76:79]
    s_lshl_b32 s12, s12, 2
    s_waitcnt lgkmcnt(2)
    v_mfma_f32_16x16x32_bf16 v[64:67], a[64:67], v[16:19], v[64:67]
    ds_read_b128 v[28:31], v5 offset:11264
    s_add_u32 s12, s12, s3
    v_mfma_f32_16x16x32_bf16 v[68:71], a[68:71], v[16:19], v[68:71]
    s_mul_i32 s12, s12, 84*128
    v_mfma_f32_16x16x32_bf16 v[72:75], a[72:75], v[16:19], v[72:75]
    buffer_load_dwordx4 v1, s[24:27], s17 offen offset:1024 lds
    v_mfma_f32_16x16x32_bf16 v[76:79], a[76:79], v[16:19], v[76:79]
    s_lshr_b32 s13, s4, 6
    s_waitcnt lgkmcnt(2)
    v_mfma_f32_16x16x32_bf16 v[64:67], a[80:83], v[20:23], v[64:67]
    ds_read_b128 v[16:19], v5 offset:12288
    s_mul_i32 s13, s13, 1327104
    v_mfma_f32_16x16x32_bf16 v[68:71], a[84:87], v[20:23], v[68:71]
    s_add_u32 s12, s12, s13
    v_mfma_f32_16x16x32_bf16 v[72:75], a[88:91], v[20:23], v[72:75]
    buffer_load_dwordx4 v1, s[24:27], s17 offen offset:2048 lds
    v_mfma_f32_16x16x32_bf16 v[76:79], a[92:95], v[20:23], v[76:79]
    s_add_u32 s13, s12, 42*128
    s_waitcnt lgkmcnt(2)
    v_mfma_f32_16x16x32_bf16 v[64:67], a[96:99], v[24:27], v[64:67]
    ds_read_b128 v[20:23], v5 offset:13312
    s_getpc_b64 s[32:33]
KB_PC1:
    s_add_u32 s32, s32, KB_G2-KB_PC1
    s_addc_u32 s33, s33, 0
    v_mfma_f32_16x16x32_bf16 v[68:71], a[100:103], v[24:27], v[68:71]
    s_mov_b32 s34, TEXT_END-KB_G2
    v_mfma_f32_16x16x32_bf16 v[72:75], a[104:107], v[24:27], v[72:75]
    s_mov_b32 s35, 0x00020000
    v_mfma_f32_16x16x32_bf16 v[76:79], a[108:111], v[24:27], v[76:79]
    s_and_b32 s36, s4, 31
    s_waitcnt lgkmcnt(2)
    v_mfma_f32_16x16x32_bf16 v[64:67], a[112:115], v[28:31], v[64:67]
    ds_read_b128 v[24:27], v5 offset:14336
    s_lshl_b32 s36, s36, 2
    v_mfma_f32_16x16x32_bf16 v[68:71], a[116:119], v[28:31], v[68:71]
    s_add_u32 s36, s36, s3
    v_mfma_f32_16x16x32_bf16 v[72:75], a[120:123], v[28:31], v[72:75]
    s_mul_i32 s36, s36, 14*128
    v_mfma_f32_16x16x32_bf16 v[76:79], a[124:127], v[28:31], v[76:79]
    v_cmp_gt_u32 vcc, 14, v8
    s_waitcnt lgkmcnt(2)
    v_mfma_f32_16x16x32_bf16 v[64:67], a[128:131], v[16:19], v[64:67]
    ds_read_b128 v[28:31], v5 offset:15360
    v_lshlrev_b32 v49, 7, v8
    v_mfma_f32_16x16x32_bf16 v[68:71], a[132:135], v[16:19], v[68:71]
    s_nop 0
    v_mfma_f32_16x16x32_bf16 v[72:75], a[136:139], v[16:19], v[72:75]
    v_cndmask_b32 v49, 2.0, v49, vcc
    v_mfma_f32_16x16x32_bf16 v[76:79], a[140:143], v[16:19], v[76:79]
    v_add_u32 v50, 0, v8
    s_waitcnt lgkmcnt(2)
    v_mfma_f32_16x16x32_bf16 v[64:67], a[144:147], v[20:23], v[64:67]
    s_waitcnt vmcnt(12)
    s_barrier
    ds_read_b128 v[16:19], v5 offset:16384
    v_mfma_f32_16x16x32_bf16 v[68:71], a[148:151], v[20:23], v[68:71]
    ds_read_b64_tr_b16 v[224:225], v10 offset:0
    ds_read_b64_tr_b16 v[226:227], v10 offset:1024
    v_mfma_f32_16x16x32_bf16 v[72:75], a[152:155], v[20:23], v[72:75]
    ds_read_b64_tr_b16 v[228:229], v11 offset:0
    ds_read_b64_tr_b16 v[230:231], v11 offset:1024
    v_mfma_f32_16x16x32_bf16 v[76:79], a[156:159], v[20:23], v[76:79]
    ds_read_b64_tr_b16 v[232:233], v10 offset:16384
    ds_read_b64_tr_b16 v[234:235], v10 offset:17408
    s_waitcnt lgkmcnt(8)
    v_mfma_f32_16x16x32_bf16 v[64:67], a[160:163], v[24:27], v[64:67]
    ds_read_b128 v[20:23], v5 offset:17408
    v_mul_u32_u24 v51, 3641, v50
    v_mfma_f32_16x16x32_bf16 v[68:71], a[164:167], v[24:27], v[68:71]
    ds_read_b64_tr_b16 v[236:237], v11 offset:16384
    ds_read_b64_tr_b16 v[238:239], v11 offset:17408
    v_mfma_f32_16x16x32_bf16 v[72:75], a[168:171], v[24:27], v[72:75]
    ds_read_b64_tr_b16 v[240:241], v10 offset:8192
    ds_read_b64_tr_b16 v[242:243], v10 offset:9216
    v_mfma_f32_16x16x32_bf16 v[76:79], a[172:175], v[24:27], v[76:79]
    ds_read_b64_tr_b16 v[244:245], v11 offset:8192
    ds_read_b64_tr_b16 v[246:247], v11 offset:9216
    s_waitcnt lgkmcnt(14)
    v_mfma_f32_16x16x32_bf16 v[64:67], a[176:179], v[28:31], v[64:67]
    ds_read_b128 v[24:27], v5 offset:18432
    v_lshrrev_b32 v51, 16, v51
    v_mfma_f32_16x16x32_bf16 v[68:71], a[180:183], v[28:31], v[68:71]
    ds_read_b64_tr_b16 v[248:249], v10 offset:24576
    ds_read_b64_tr_b16 v[250:251], v10 offset:25600
    v_mfma_f32_16x16x32_bf16 v[72:75], a[184:187], v[28:31], v[72:75]
    ds_read_b64_tr_b16 v[252:253], v11 offset:24576
    ds_read_b64_tr_b16 v[254:255], v11 offset:25600
    v_mfma_f32_16x16x32_bf16 v[76:79], a[188:191], v[28:31], v[76:79]
    v_mul_u32_u24 v51, 864, v51
    s_waitcnt lgkmcnt(15)
    v_mfma_f32_16x16x32_bf16 v[64:67], a[192:195], v[16:19], v[64:67]
    ds_read_b128 v[28:31], v5 offset:19456
    v_lshl_add_u32 v40, v50, 4, v51
    v_mfma_f32_16x16x32_bf16 v[68:71], a[196:199], v[16:19], v[68:71]
    v_add_u32 v50, 64, v8
    v_mfma_f32_16x16x32_bf16 v[72:75], a[200:203], v[16:19], v[72:75]
    s_add_u32 m0, s43, 86016
    s_add_u32 s17, s16, 73728
    buffer_load_dwordx4 v1, s[24:27], s17 offen offset:0 lds
    v_mfma_f32_16x16x32_bf16 v[76:79], a[204:207], v[16:19], v[76:79]
    v_mul_u32_u24 v51, 3641, v50
    s_waitcnt lgkmcnt(12)
    v_mfma_f32_16x16x32_bf16 v[64:67], a[208:211], v[20:23], v[64:67]
    ds_read_b128 v[16:19], v5 offset:20480
    v_lshrrev_b32 v51, 16, v51
    v_mfma_f32_16x16x32_bf16 v[68:71], a[212:215], v[20:23], v[68:71]
    v_mul_u32_u24 v51, 864, v51
    v_mfma_f32_16x16x32_bf16 v[72:75], a[216:219], v[20:23], v[72:75]
    buffer_load_dwordx4 v1, s[24:27], s17 offen offset:1024 lds
    v_mfma_f32_16x16x32_bf16 v[76:79], a[220:223], v[20:23], v[76:79]
    v_lshl_add_u32 v41, v50, 4, v51
    s_waitcnt lgkmcnt(6)
    v_mfma_f32_16x16x32_bf16 v[64:67], a[224:227], v[24:27], v[64:67]
    ds_read_b128 v[20:23], v5 offset:21504
    v_subrev_u32 v41, 1024, v41
    v_mfma_f32_16x16x32_bf16 v[68:71], a[228:231], v[24:27], v[68:71]
    v_add_u32 v50, 128, v8
    v_mfma_f32_16x16x32_bf16 v[72:75], a[232:235], v[24:27], v[72:75]
    buffer_load_dwordx4 v1, s[24:27], s17 offen offset:2048 lds
    v_mfma_f32_16x16x32_bf16 v[76:79], a[236:239], v[24:27], v[76:79]
    v_mul_u32_u24 v51, 3641, v50
    s_waitcnt lgkmcnt(2)
    v_mfma_f32_16x16x32_bf16 v[64:67], a[240:243], v[28:31], v[64:67]
    ds_read_b128 v[24:27], v5 offset:22528
    v_lshrrev_b32 v51, 16, v51
    v_mfma_f32_16x16x32_bf16 v[68:71], a[244:247], v[28:31], v[68:71]
    v_mul_u32_u24 v51, 864, v51
    v_mfma_f32_16x16x32_bf16 v[72:75], a[248:251], v[28:31], v[72:75]
    v_lshl_add_u32 v42, v50, 4, v51
    v_mfma_f32_16x16x32_bf16 v[76:79], a[252:255], v[28:31], v[76:79]
    v_subrev_u32 v42, 2048, v42
    s_waitcnt lgkmcnt(2)
    v_mfma_f32_16x16x32_bf16 v[64:67], v[224:227], v[16:19], v[64:67]
    ds_read_b128 v[28:31], v5 offset:23552
    v_add_u32 v50, 192, v8
    v_mfma_f32_16x16x32_bf16 v[68:71], v[228:231], v[16:19], v[68:71]
    v_mul_u32_u24 v51, 3641, v50
    v_mfma_f32_16x16x32_bf16 v[72:75], v[232:235], v[16:19], v[72:75]
    v_lshrrev_b32 v51, 16, v51
    v_mfma_f32_16x16x32_bf16 v[76:79], v[236:239], v[16:19], v[76:79]
    v_mul_u32_u24 v51, 864, v51
    s_waitcnt lgkmcnt(2)
    v_mfma_f32_16x16x32_bf16 v[64:67], v[240:243], v[20:23], v[64:67]
    ds_read_b128 v[16:19], v5 offset:24576
    v_lshl_add_u32 v43, v50, 4, v51
    v_mfma_f32_16x16x32_bf16 v[68:71], v[244:247], v[20:23], v[68:71]
    v_subrev_u32 v43, 3072, v43
    v_mfma_f32_16x16x32_bf16 v[72:75], v[248:251], v[20:23], v[72:75]
    v_add_u32 v50, 256, v8
    v_mfma_f32_16x16x32_bf16 v[76:79], v[252:255], v[20:23], v[76:79]
    v_mul_u32_u24 v51, 3641, v50
    s_waitcnt lgkmcnt(2)
    v_mfma_f32_16x16x32_bf16 v[80:83], a[0:3], v[24:27], 0
    ds_read_b128 v[20:23], v5 offset:25600
    v_lshrrev_b32 v51, 16, v51
    v_mfma_f32_16x16x32_bf16 v[84:87], a[4:7], v[24:27], 0
    v_mul_u32_u24 v51, 864, v51
    v_mfma_f32_16x16x32_bf16 v[88:91], a[8:11], v[24:27], 0
    v_lshl_add_u32 v44, v50, 4, v51
    v_mfma_f32_16x16x32_bf16 v[92:95], a[12:15], v[24:27], 0
    v_add_u32 v50, 320, v8
    s_waitcnt lgkmcnt(2)
    v_mfma_f32_16x16x32_bf16 v[80:83], a[16:19], v[28:31], v[80:83]
    ds_read_b128 v[24:27], v5 offset:26624
    v_mul_u32_u24 v51, 3641, v50
    v_mfma_f32_16x16x32_bf16 v[84:87], a[20:23], v[28:31], v[84:87]
    v_lshrrev_b32 v51, 16, v51
    v_mfma_f32_16x16x32_bf16 v[88:91], a[24:27], v[28:31], v[88:91]
    v_mul_u32_u24 v51, 864, v51
    v_mfma_f32_16x16x32_bf16 v[92:95], a[28:31], v[28:31], v[92:95]
    v_lshl_add_u32 v45, v50, 4, v51
    s_waitcnt lgkmcnt(2)
    v_mfma_f32_16x16x32_bf16 v[80:83], a[32:35], v[16:19], v[80:83]
    ds_read_b128 v[28:31], v5 offset:27648
    v_subrev_u32 v45, 1024, v45
    v_mfma_f32_16x16x32_bf16 v[84:87], a[36:39], v[16:19], v[84:87]
    v_add_u32 v50, 384, v8
    v_mfma_f32_16x16x32_bf16 v[88:91], a[40:43], v[16:19], v[88:91]
    v_mul_u32_u24 v51, 3641, v50
    v_mfma_f32_16x16x32_bf16 v[92:95], a[44:47], v[16:19], v[92:95]
    v_lshrrev_b32 v51, 16, v51
    s_waitcnt lgkmcnt(2)
    v_mfma_f32_16x16x32_bf16 v[80:83], a[48:51], v[20:23], v[80:83]
    s_waitcnt vmcnt(12)
    s_barrier
    ds_read_b128 v[16:19], v3 offset:36864
    v_mfma_f32_16x16x32_bf16 v[84:87], a[52:55], v[20:23], v[84:87]
    v_mul_u32_u24 v51, 864, v51
    v_mfma_f32_16x16x32_bf16 v[88:91], a[56:59], v[20:23], v[88:91]
    s_add_u32 m0, s43, 0
    s_add_u32 s17, s16, 86016
    buffer_load_dwordx4 v1, s[24:27], s17 offen offset:0 lds
    v_mfma_f32_16x16x32_bf16 v[92:95], a[60:63], v[20:23], v[92:95]
    v_lshl_add_u32 v46, v50, 4, v51
    s_waitcnt lgkmcnt(2)
    v_mfma_f32_16x16x32_bf16 v[80:83], a[64:67], v[24:27], v[80:83]
    ds_read_b128 v[20:23], v3 offset:37888
    v_subrev_u32 v46, 2048, v46
    v_mfma_f32_16x16x32_bf16 v[84:87], a[68:71], v[24:27], v[84:87]
    v_add_u32 v50, 448, v8
    v_mul_f32 v64, s9, v64
    v_mfma_f32_16x16x32_bf16 v[88:91], a[72:75], v[24:27], v[88:91]
    buffer_load_dwordx4 v1, s[24:27], s17 offen offset:1024 lds
    v_mfma_f32_16x16x32_bf16 v[92:95], a[76:79], v[24:27], v[92:95]
    v_mul_u32_u24 v51, 3641, v50
    s_waitcnt lgkmcnt(2)
    v_mfma_f32_16x16x32_bf16 v[80:83], a[80:83], v[28:31], v[80:83]
    ds_read_b128 v[24:27], v3 offset:38912
    v_lshrrev_b32 v51, 16, v51
    v_mfma_f32_16x16x32_bf16 v[84:87], a[84:87], v[28:31], v[84:87]
    v_mul_u32_u24 v51, 864, v51
    v_mul_f32 v65, s9, v65
    v_mfma_f32_16x16x32_bf16 v[88:91], a[88:91], v[28:31], v[88:91]
    buffer_load_dwordx4 v1, s[24:27], s17 offen offset:2048 lds
    v_mfma_f32_16x16x32_bf16 v[92:95], a[92:95], v[28:31], v[92:95]
    v_lshl_add_u32 v47, v50, 4, v51
    s_waitcnt lgkmcnt(2)
    v_mfma_f32_16x16x32_bf16 v[80:83], a[96:99], v[16:19], v[80:83]
    ds_read_b128 v[28:31], v3 offset:39936
    v_subrev_u32 v47, 3072, v47
    v_mfma_f32_16x16x32_bf16 v[84:87], a[100:103], v[16:19], v[84:87]
    v_add_u32 v50, 512, v8
    v_mul_f32 v66, s9, v66
    v_mfma_f32_16x16x32_bf16 v[88:91], a[104:107], v[16:19], v[88:91]
    s_add_u32 m0, s43, 12288
    s_add_u32 s17, s16, 98304
    buffer_load_dwordx4 v1, s[24:27], s17 offen offset:0 lds
    v_mfma_f32_16x16x32_bf16 v[92:95], a[108:111], v[16:19], v[92:95]
    v_mul_u32_u24 v51, 3641, v50
    s_waitcnt lgkmcnt(2)
    v_mfma_f32_16x16x32_bf16 v[80:83], a[112:115], v[20:23], v[80:83]
    ds_read_b128 v[16:19], v3 offset:40960
    v_lshrrev_b32 v51, 16, v51
    v_mfma_f32_16x16x32_bf16 v[84:87], a[116:119], v[20:23], v[84:87]
    v_mul_u32_u24 v51, 864, v51
    v_mul_f32 v67, s9, v67
    v_mfma_f32_16x16x32_bf16 v[88:91], a[120:123], v[20:23], v[88:91]
    buffer_load_dwordx4 v1, s[24:27], s17 offen offset:1024 lds
    v_mfma_f32_16x16x32_bf16 v[92:95], a[124:127], v[20:23], v[92:95]
    v_lshl_add_u32 v48, v50, 4, v51
    s_waitcnt lgkmcnt(2)
    v_mfma_f32_16x16x32_bf16 v[80:83], a[128:131], v[24:27], v[80:83]
    ds_read_b128 v[20:23], v3 offset:41984
    v_mul_f32 v68, s9, v68
    v_mfma_f32_16x16x32_bf16 v[84:87], a[132:135], v[24:27], v[84:87]
    v_exp_f32 v64, v64
    v_mfma_f32_16x16x32_bf16 v[88:91], a[136:139], v[24:27], v[88:91]
    buffer_load_dwordx4 v1, s[24:27], s17 offen offset:2048 lds
    v_mfma_f32_16x16x32_bf16 v[92:95], a[140:143], v[24:27], v[92:95]
    v_add_f32 v64, 1.0, v64
    s_waitcnt lgkmcnt(2)
    v_mfma_f32_16x16x32_bf16 v[80:83], a[144:147], v[28:31], v[80:83]
    ds_read_b128 v[24:27], v3 offset:43008
    v_mul_f32 v69, s9, v69
    v_mfma_f32_16x16x32_bf16 v[84:87], a[148:151], v[28:31], v[84:87]
    v_exp_f32 v65, v65
    v_mfma_f32_16x16x32_bf16 v[88:91], a[152:155], v[28:31], v[88:91]
    v_exp_f32 v66, v66
    v_mfma_f32_16x16x32_bf16 v[92:95], a[156:159], v[28:31], v[92:95]
    v_add_f32 v65, 1.0, v65
    s_waitcnt lgkmcnt(2)
    v_mfma_f32_16x16x32_bf16 v[80:83], a[160:163], v[16:19], v[80:83]
    ds_read_b128 v[28:31], v3 offset:44032
    v_add_f32 v66, 1.0, v66
    v_mfma_f32_16x16x32_bf16 v[84:87], a[164:167], v[16:19], v[84:87]
    v_rcp_f32 v64, v64
    v_mfma_f32_16x16x32_bf16 v[88:91], a[168:171], v[16:19], v[88:91]
    v_exp_f32 v67, v67
    v_mfma_f32_16x16x32_bf16 v[92:95], a[172:175], v[16:19], v[92:95]
    v_mul_f32 v64, v64, v72
    s_waitcnt lgkmcnt(2)
    v_mfma_f32_16x16x32_bf16 v[80:83], a[176:179], v[20:23], v[80:83]
    ds_read_b128 v[16:19], v3 offset:45056
    v_add_f32 v67, 1.0, v67
    v_mfma_f32_16x16x32_bf16 v[84:87], a[180:183], v[20:23], v[84:87]
    v_rcp_f32 v65, v65
    v_mfma_f32_16x16x32_bf16 v[88:91], a[184:187], v[20:23], v[88:91]
    v_exp_f32 v68, v68
    v_mfma_f32_16x16x32_bf16 v[92:95], a[188:191], v[20:23], v[92:95]
    v_mul_f32 v65, v65, v73
    s_waitcnt lgkmcnt(2)
    v_mfma_f32_16x16x32_bf16 v[80:83], a[192:195], v[24:27], v[80:83]
    ds_read_b128 v[20:23], v3 offset:46080
    v_mul_f32 v70, s9, v70
    v_mfma_f32_16x16x32_bf16 v[84:87], a[196:199], v[24:27], v[84:87]
    v_rcp_f32 v66, v66
    v_mfma_f32_16x16x32_bf16 v[88:91], a[200:203], v[24:27], v[88:91]
    v_exp_f32 v69, v69
    v_mfma_f32_16x16x32_bf16 v[92:95], a[204:207], v[24:27], v[92:95]
    v_add_f32 v68, 1.0, v68
    s_waitcnt lgkmcnt(2)
    v_mfma_f32_16x16x32_bf16 v[80:83], a[208:211], v[28:31], v[80:83]
    ds_read_b128 v[24:27], v3 offset:47104
    v_mul_f32 v66, v66, v74
    v_mfma_f32_16x16x32_bf16 v[84:87], a[212:215], v[28:31], v[84:87]
    v_rcp_f32 v67, v67
    v_mfma_f32_16x16x32_bf16 v[88:91], a[216:219], v[28:31], v[88:91]
    v_mul_f32 v71, s9, v71
    v_add_f32 v69, 1.0, v69
    v_mfma_f32_16x16x32_bf16 v[92:95], a[220:223], v[28:31], v[92:95]
    v_mul_f32 v67, v67, v75
    s_waitcnt lgkmcnt(2)
    v_mfma_f32_16x16x32_bf16 v[80:83], a[224:227], v[16:19], v[80:83]
    ds_read_b128 v[28:31], v3 offset:48128
    v_mfma_f32_16x16x32_bf16 v[84:87], a[228:231], v[16:19], v[84:87]
    v_exp_f32 v70, v70
    v_mfma_f32_16x16x32_bf16 v[88:91], a[232:235], v[16:19], v[88:91]
    v_rcp_f32 v68, v68
    v_mfma_f32_16x16x32_bf16 v[92:95], a[236:239], v[16:19], v[92:95]
    v_add_f32 v70, 1.0, v70
    s_waitcnt lgkmcnt(2)
    v_mfma_f32_16x16x32_bf16 v[80:83], a[240:243], v[20:23], v[80:83]
    s_waitcnt vmcnt(15)
    s_barrier
    ds_read_b128 v[16:19], v3 offset:49152
    v_mfma_f32_16x16x32_bf16 v[84:87], a[244:247], v[20:23], v[84:87]
    v_exp_f32 v71, v71
    v_mfma_f32_16x16x32_bf16 v[88:91], a[248:251], v[20:23], v[88:91]
    s_add_u32 m0, s43, 24576
    s_add_u32 s17, s16, 110592
    buffer_load_dwordx4 v1, s[24:27], s17 offen offset:0 lds
    v_mfma_f32_16x16x32_bf16 v[92:95], a[252:255], v[20:23], v[92:95]
    v_mul_f32 v68, v68, v76
    s_waitcnt lgkmcnt(2)
    v_mfma_f32_16x16x32_bf16 v[80:83], v[224:227], v[24:27], v[80:83]
    ds_read_b128 v[20:23], v3 offset:50176
    v_add_f32 v71, 1.0, v71
    v_mfma_f32_16x16x32_bf16 v[84:87], v[228:231], v[24:27], v[84:87]
    v_rcp_f32 v69, v69
    v_mfma_f32_16x16x32_bf16 v[88:91], v[232:235], v[24:27], v[88:91]
    buffer_load_dwordx4 v1, s[24:27], s17 offen offset:1024 lds
    v_mfma_f32_16x16x32_bf16 v[92:95], v[236:239], v[24:27], v[92:95]
    v_mul_f32 v69, v69, v77
    s_waitcnt lgkmcnt(2)
    v_mfma_f32_16x16x32_bf16 v[80:83], v[240:243], v[28:31], v[80:83]
    ds_read_b128 v[24:27], v3 offset:51200
    v_cvt_pk_bf16_f32 v72, v64, v65
    v_mfma_f32_16x16x32_bf16 v[84:87], v[244:247], v[28:31], v[84:87]
    v_rcp_f32 v70, v70
    v_mfma_f32_16x16x32_bf16 v[88:91], v[248:251], v[28:31], v[88:91]
    buffer_load_dwordx4 v1, s[24:27], s17 offen offset:2048 lds
    v_mfma_f32_16x16x32_bf16 v[92:95], v[252:255], v[28:31], v[92:95]
    v_mul_f32 v70, v70, v78
    s_waitcnt lgkmcnt(2)
    v_mfma_f32_16x16x32_bf16 v[96:99], a[0:3], v[16:19], 0
    ds_read_b128 v[28:31], v3 offset:52224
    v_cvt_pk_bf16_f32 v73, v66, v67
    v_mfma_f32_16x16x32_bf16 v[100:103], a[4:7], v[16:19], 0
    v_rcp_f32 v71, v71
    v_mfma_f32_16x16x32_bf16 v[104:107], a[8:11], v[16:19], 0
    v_mul_f32 v71, v71, v79
    v_cvt_pk_bf16_f32 v74, v68, v69
    v_mfma_f32_16x16x32_bf16 v[108:111], a[12:15], v[16:19], 0
    v_cvt_pk_bf16_f32 v75, v70, v71
    s_waitcnt lgkmcnt(2)
    v_mfma_f32_16x16x32_bf16 v[96:99], a[16:19], v[20:23], v[96:99]
    ds_read_b128 v[16:19], v3 offset:53248
    s_add_u32 s19, s14, 0
    v_mfma_f32_16x16x32_bf16 v[100:103], a[20:23], v[20:23], v[100:103]
    buffer_store_dwordx4 v[72:75], v1, s[28:31], s19 offen sc1
    v_mfma_f32_16x16x32_bf16 v[104:107], a[24:27], v[20:23], v[104:107]
    v_mul_f32 v80, s9, v80
    v_mul_f32 v81, s9, v81
    v_mfma_f32_16x16x32_bf16 v[108:111], a[28:31], v[20:23], v[108:111]
    v_mul_f32 v82, s9, v82
    s_waitcnt lgkmcnt(2)
    v_mfma_f32_16x16x32_bf16 v[96:99], a[32:35], v[24:27], v[96:99]
    ds_read_b128 v[20:23], v3 offset:54272
    v_mul_f32 v83, s9, v83
    v_mfma_f32_16x16x32_bf16 v[100:103], a[36:39], v[24:27], v[100:103]
    v_exp_f32 v80, v80
    v_mfma_f32_16x16x32_bf16 v[104:107], a[40:43], v[24:27], v[104:107]
    v_exp_f32 v81, v81
    v_mfma_f32_16x16x32_bf16 v[108:111], a[44:47], v[24:27], v[108:111]
    v_add_f32 v80, 1.0, v80
    s_waitcnt lgkmcnt(2)
    v_mfma_f32_16x16x32_bf16 v[96:99], a[48:51], v[28:31], v[96:99]
    ds_read_b128 v[24:27], v3 offset:55296
    v_add_f32 v81, 1.0, v81
    v_mfma_f32_16x16x32_bf16 v[100:103], a[52:55], v[28:31], v[100:103]
    v_exp_f32 v82, v82
    v_mfma_f32_16x16x32_bf16 v[104:107], a[56:59], v[28:31], v[104:107]
    v_rcp_f32 v80, v80
    v_mfma_f32_16x16x32_bf16 v[108:111], a[60:63], v[28:31], v[108:111]
    v_mul_f32 v84, s9, v84
    s_waitcnt lgkmcnt(2)
    v_mfma_f32_16x16x32_bf16 v[96:99], a[64:67], v[16:19], v[96:99]
    ds_read_b128 v[28:31], v3 offset:56320
    v_add_f32 v82, 1.0, v82
    v_mfma_f32_16x16x32_bf16 v[100:103], a[68:71], v[16:19], v[100:103]
    v_exp_f32 v83, v83
    v_mfma_f32_16x16x32_bf16 v[104:107], a[72:75], v[16:19], v[104:107]
    v_rcp_f32 v81, v81
    v_mfma_f32_16x16x32_bf16 v[108:111], a[76:79], v[16:19], v[108:111]
    v_mul_f32 v80, v80, v88
    s_waitcnt lgkmcnt(2)
    v_mfma_f32_16x16x32_bf16 v[96:99], a[80:83], v[20:23], v[96:99]
    ds_read_b128 v[16:19], v3 offset:57344
    v_mul_f32 v85, s9, v85
    v_mfma_f32_16x16x32_bf16 v[100:103], a[84:87], v[20:23], v[100:103]
    v_exp_f32 v84, v84
    v_mfma_f32_16x16x32_bf16 v[104:107], a[88:91], v[20:23], v[104:107]
    v_add_f32 v83, 1.0, v83
    v_mul_f32 v81, v81, v89
    v_mfma_f32_16x16x32_bf16 v[108:111], a[92:95], v[20:23], v[108:111]
    v_mul_f32 v86, s9, v86
    s_waitcnt lgkmcnt(2)
    v_mfma_f32_16x16x32_bf16 v[96:99], a[96:99], v[24:27], v[96:99]
    ds_read_b128 v[20:23], v3 offset:58368
    v_add_f32 v84, 1.0, v84
    v_mfma_f32_16x16x32_bf16 v[100:103], a[100:103], v[24:27], v[100:103]
    v_rcp_f32 v82, v82
    v_mfma_f32_16x16x32_bf16 v[104:107], a[104:107], v[24:27], v[104:107]
    v_exp_f32 v85, v85
    v_mfma_f32_16x16x32_bf16 v[108:111], a[108:111], v[24:27], v[108:111]
    v_mul_f32 v82, v82, v90
    s_waitcnt lgkmcnt(2)
    v_mfma_f32_16x16x32_bf16 v[96:99], a[112:115], v[28:31], v[96:99]
    ds_read_b128 v[24:27], v3 offset:59392
    v_mul_f32 v87, s9, v87
    v_mfma_f32_16x16x32_bf16 v[100:103], a[116:119], v[28:31], v[100:103]
    v_rcp_f32 v83, v83
    v_mfma_f32_16x16x32_bf16 v[104:107], a[120:123], v[28:31], v[104:107]
    v_exp_f32 v86, v86
    v_mfma_f32_16x16x32_bf16 v[108:111], a[124:127], v[28:31], v[108:111]
    v_add_f32 v85, 1.0, v85
    s_waitcnt lgkmcnt(2)
    v_mfma_f32_16x16x32_bf16 v[96:99], a[128:131], v[16:19], v[96:99]
    ds_read_b128 v[28:31], v3 offset:60416
    v_mul_f32 v83, v83, v91
    v_mfma_f32_16x16x32_bf16 v[100:103], a[132:135], v[16:19], v[100:103]
    v_rcp_f32 v84, v84
    v_mfma_f32_16x16x32_bf16 v[104:107], a[136:139], v[16:19], v[104:107]
    v_exp_f32 v87, v87
    v_mfma_f32_16x16x32_bf16 v[108:111], a[140:143], v[16:19], v[108:111]
    v_add_f32 v86, 1.0, v86
    s_waitcnt lgkmcnt(2)
    v_mfma_f32_16x16x32_bf16 v[96:99], a[144:147], v[20:23], v[96:99]
    s_waitcnt vmcnt(13)
    s_barrier
    ds_read_b128 v[16:19], v3 offset:61440
    v_mfma_f32_16x16x32_bf16 v[100:103], a[148:151], v[20:23], v[100:103]
    v_rcp_f32 v85, v85
    v_mfma_f32_16x16x32_bf16 v[104:107], a[152:155], v[20:23], v[104:107]
    s_add_u32 m0, s43, 36864
    s_add_u32 s17, s16, 122880
    buffer_load_dwordx4 v1, s[24:27], s17 offen offset:0 lds
    v_mfma_f32_16x16x32_bf16 v[108:111], a[156:159], v[20:23], v[108:111]
    v_mul_f32 v84, v84, v92
    s_waitcnt lgkmcnt(2)
    v_mfma_f32_16x16x32_bf16 v[96:99], a[160:163], v[24:27], v[96:99]
    ds_read_b128 v[20:23], v3 offset:62464
    v_add_f32 v87, 1.0, v87
    v_mfma_f32_16x16x32_bf16 v[100:103], a[164:167], v[24:27], v[100:103]
    v_rcp_f32 v86, v86
    v_mfma_f32_16x16x32_bf16 v[104:107], a[168:171], v[24:27], v[104:107]
    buffer_load_dwordx4 v1, s[24:27], s17 offen offset:1024 lds
    v_mfma_f32_16x16x32_bf16 v[108:111], a[172:175], v[24:27], v[108:111]
    v_mul_f32 v85, v85, v93
    s_waitcnt lgkmcnt(2)
    v_mfma_f32_16x16x32_bf16 v[96:99], a[176:179], v[28:31], v[96:99]
    ds_read_b128 v[24:27], v3 offset:63488
    v_mul_f32 v86, v86, v94
    v_mfma_f32_16x16x32_bf16 v[100:103], a[180:183], v[28:31], v[100:103]
    v_rcp_f32 v87, v87
    v_mfma_f32_16x16x32_bf16 v[104:107], a[184:187], v[28:31], v[104:107]
    buffer_load_dwordx4 v1, s[24:27], s17 offen offset:2048 lds
    v_mfma_f32_16x16x32_bf16 v[108:111], a[188:191], v[28:31], v[108:111]
    v_mul_f32 v87, v87, v95
    s_waitcnt lgkmcnt(2)
    v_mfma_f32_16x16x32_bf16 v[96:99], a[192:195], v[16:19], v[96:99]
    ds_read_b128 v[28:31], v3 offset:64512
    v_cvt_pk_bf16_f32 v88, v80, v81
    v_mfma_f32_16x16x32_bf16 v[100:103], a[196:199], v[16:19], v[100:103]
    v_cvt_pk_bf16_f32 v89, v82, v83
    v_cvt_pk_bf16_f32 v90, v84, v85
    v_mfma_f32_16x16x32_bf16 v[104:107], a[200:203], v[16:19], v[104:107]
    v_cvt_pk_bf16_f32 v91, v86, v87
    s_add_u32 s19, s14, 147456
    v_mfma_f32_16x16x32_bf16 v[108:111], a[204:207], v[16:19], v[108:111]
    s_waitcnt lgkmcnt(2)
    v_mfma_f32_16x16x32_bf16 v[96:99], a[208:211], v[20:23], v[96:99]
    ds_read_b128 v[16:19], v4 offset:0
    v_mfma_f32_16x16x32_bf16 v[100:103], a[212:215], v[20:23], v[100:103]
    buffer_store_dwordx4 v[88:91], v1, s[28:31], s19 offen sc1
    v_mfma_f32_16x16x32_bf16 v[104:107], a[216:219], v[20:23], v[104:107]
    v_mfma_f32_16x16x32_bf16 v[108:111], a[220:223], v[20:23], v[108:111]
    s_waitcnt lgkmcnt(2)
    v_mfma_f32_16x16x32_bf16 v[96:99], a[224:227], v[24:27], v[96:99]
    ds_read_b128 v[20:23], v4 offset:1024
    v_mfma_f32_16x16x32_bf16 v[100:103], a[228:231], v[24:27], v[100:103]
    v_mfma_f32_16x16x32_bf16 v[104:107], a[232:235], v[24:27], v[104:107]
    v_mfma_f32_16x16x32_bf16 v[108:111], a[236:239], v[24:27], v[108:111]
    s_waitcnt lgkmcnt(2)
    v_mfma_f32_16x16x32_bf16 v[96:99], a[240:243], v[28:31], v[96:99]
    ds_read_b128 v[24:27], v4 offset:2048
    v_mfma_f32_16x16x32_bf16 v[100:103], a[244:247], v[28:31], v[100:103]
    v_mfma_f32_16x16x32_bf16 v[104:107], a[248:251], v[28:31], v[104:107]
    v_mfma_f32_16x16x32_bf16 v[108:111], a[252:255], v[28:31], v[108:111]
    s_waitcnt lgkmcnt(2)
    v_mfma_f32_16x16x32_bf16 v[96:99], v[224:227], v[16:19], v[96:99]
    ds_read_b128 v[28:31], v4 offset:3072
    v_mfma_f32_16x16x32_bf16 v[100:103], v[228:231], v[16:19], v[100:103]
    v_mfma_f32_16x16x32_bf16 v[104:107], v[232:235], v[16:19], v[104:107]
    v_mfma_f32_16x16x32_bf16 v[108:111], v[236:239], v[16:19], v[108:111]
    s_waitcnt lgkmcnt(2)
    v_mfma_f32_16x16x32_bf16 v[96:99], v[240:243], v[20:23], v[96:99]
    ds_read_b128 v[16:19], v4 offset:4096
    v_mfma_f32_16x16x32_bf16 v[100:103], v[244:247], v[20:23], v[100:103]
    v_mfma_f32_16x16x32_bf16 v[104:107], v[248:251], v[20:23], v[104:107]
    v_mfma_f32_16x16x32_bf16 v[108:111], v[252:255], v[20:23], v[108:111]
    s_waitcnt lgkmcnt(2)
    v_mfma_f32_16x16x32_bf16 v[64:67], a[0:3], v[24:27], 0
    ds_read_b128 v[20:23], v4 offset:5120
    v_mfma_f32_16x16x32_bf16 v[68:71], a[4:7], v[24:27], 0
    v_mfma_f32_16x16x32_bf16 v[72:75], a[8:11], v[24:27], 0
    v_mfma_f32_16x16x32_bf16 v[76:79], a[12:15], v[24:27], 0
    v_mul_f32 v96, s9, v96
    s_waitcnt lgkmcnt(2)
    v_mfma_f32_16x16x32_bf16 v[64:67], a[16:19], v[28:31], v[64:67]
    ds_read_b128 v[24:27], v4 offset:6144
    v_mul_f32 v97, s9, v97
    v_mfma_f32_16x16x32_bf16 v[68:71], a[20:23], v[28:31], v[68:71]
    v_exp_f32 v96, v96
    v_mfma_f32_16x16x32_bf16 v[72:75], a[24:27], v[28:31], v[72:75]
    v_mul_f32 v98, s9, v98
    v_add_f32 v96, 1.0, v96
    v_mfma_f32_16x16x32_bf16 v[76:79], a[28:31], v[28:31], v[76:79]
    v_mul_f32 v99, s9, v99
    s_waitcnt lgkmcnt(2)
    v_mfma_f32_16x16x32_bf16 v[64:67], a[32:35], v[16:19], v[64:67]
    ds_read_b128 v[28:31], v4 offset:7168
    v_mul_f32 v100, s9, v100
    v_mfma_f32_16x16x32_bf16 v[68:71], a[36:39], v[16:19], v[68:71]
    v_exp_f32 v97, v97
    v_mfma_f32_16x16x32_bf16 v[72:75], a[40:43], v[16:19], v[72:75]
    v_exp_f32 v98, v98
    v_mfma_f32_16x16x32_bf16 v[76:79], a[44:47], v[16:19], v[76:79]
    v_add_f32 v97, 1.0, v97
    s_waitcnt lgkmcnt(2)
    v_mfma_f32_16x16x32_bf16 v[64:67], a[48:51], v[20:23], v[64:67]
    ds_read_b128 v[16:19], v4 offset:8192
    v_add_f32 v98, 1.0, v98
    v_mfma_f32_16x16x32_bf16 v[68:71], a[52:55], v[20:23], v[68:71]
    v_rcp_f32 v96, v96
    v_mfma_f32_16x16x32_bf16 v[72:75], a[56:59], v[20:23], v[72:75]
    v_exp_f32 v99, v99
    v_mfma_f32_16x16x32_bf16 v[76:79], a[60:63], v[20:23], v[76:79]
    v_mul_f32 v96, v96, v104
    s_waitcnt lgkmcnt(2)
    v_mfma_f32_16x16x32_bf16 v[64:67], a[64:67], v[24:27], v[64:67]
    ds_read_b128 v[20:23], v4 offset:9216
    v_mul_f32 v101, s9, v101
    v_mfma_f32_16x16x32_bf16 v[68:71], a[68:71], v[24:27], v[68:71]
    v_rcp_f32 v97, v97
    v_mfma_f32_16x16x32_bf16 v[72:75], a[72:75], v[24:27], v[72:75]
    v_exp_f32 v100, v100
    v_mfma_f32_16x16x32_bf16 v[76:79], a[76:79], v[24:27], v[76:79]
    v_add_f32 v99, 1.0, v99
    s_waitcnt lgkmcnt(2)
    v_mfma_f32_16x16x32_bf16 v[64:67], a[80:83], v[28:31], v[64:67]
    ds_read_b128 v[24:27], v4 offset:10240
    v_mul_f32 v97, v97, v105
    v_mfma_f32_16x16x32_bf16 v[68:71], a[84:87], v[28:31], v[68:71]
    v_rcp_f32 v98, v98
    v_mfma_f32_16x16x32_bf16 v[72:75], a[88:91], v[28:31], v[72:75]
    v_mul_f32 v102, s9, v102
    v_add_f32 v100, 1.0, v100
    v_mfma_f32_16x16x32_bf16 v[76:79], a[92:95], v[28:31], v[76:79]
    v_mul_f32 v98, v98, v106
    s_waitcnt lgkmcnt(2)
    v_mfma_f32_16x16x32_bf16 v[64:67], a[96:99], v[16:19], v[64:67]
    ds_read_b128 v[28:31], v4 offset:11264
    v_mul_f32 v103, s9, v103
    v_mfma_f32_16x16x32_bf16 v[68:71], a[100:103], v[16:19], v[68:71]
    v_exp_f32 v101, v101
    v_mfma_f32_16x16x32_bf16 v[72:75], a[104:107], v[16:19], v[72:75]
    v_rcp_f32 v99, v99
    v_mfma_f32_16x16x32_bf16 v[76:79], a[108:111], v[16:19], v[76:79]
    v_add_f32 v101, 1.0, v101
    s_waitcnt lgkmcnt(2)
    v_mfma_f32_16x16x32_bf16 v[64:67], a[112:115], v[20:23], v[64:67]
    ds_read_b128 v[16:19], v4 offset:12288
    v_mul_f32 v99, v99, v107
    v_mfma_f32_16x16x32_bf16 v[68:71], a[116:119], v[20:23], v[68:71]
    v_exp_f32 v102, v102
    v_mfma_f32_16x16x32_bf16 v[72:75], a[120:123], v[20:23], v[72:75]
    v_rcp_f32 v100, v100
    v_mfma_f32_16x16x32_bf16 v[76:79], a[124:127], v[20:23], v[76:79]
    v_add_f32 v102, 1.0, v102
    s_waitcnt lgkmcnt(2)
    v_mfma_f32_16x16x32_bf16 v[64:67], a[128:131], v[24:27], v[64:67]
    ds_read_b128 v[20:23], v4 offset:13312
    v_mul_f32 v100, v100, v108
    v_mfma_f32_16x16x32_bf16 v[68:71], a[132:135], v[24:27], v[68:71]
    v_exp_f32 v103, v103
    v_mfma_f32_16x16x32_bf16 v[72:75], a[136:139], v[24:27], v[72:75]
    v_rcp_f32 v101, v101
    v_mfma_f32_16x16x32_bf16 v[76:79], a[140:143], v[24:27], v[76:79]
    v_add_f32 v103, 1.0, v103
    s_waitcnt lgkmcnt(2)
    v_mfma_f32_16x16x32_bf16 v[64:67], a[144:147], v[28:31], v[64:67]
    ds_read_b128 v[24:27], v4 offset:14336
    v_mul_f32 v101, v101, v109
    v_mfma_f32_16x16x32_bf16 v[68:71], a[148:151], v[28:31], v[68:71]
    v_rcp_f32 v102, v102
    v_mfma_f32_16x16x32_bf16 v[72:75], a[152:155], v[28:31], v[72:75]
    v_rcp_f32 v103, v103
    v_mfma_f32_16x16x32_bf16 v[76:79], a[156:159], v[28:31], v[76:79]
    v_mul_f32 v102, v102, v110
    s_waitcnt lgkmcnt(2)
    v_mfma_f32_16x16x32_bf16 v[64:67], a[160:163], v[16:19], v[64:67]
    ds_read_b128 v[28:31], v4 offset:15360
    v_mul_f32 v103, v103, v111
    v_mfma_f32_16x16x32_bf16 v[68:71], a[164:167], v[16:19], v[68:71]
    v_cvt_pk_bf16_f32 v104, v96, v97
    v_cvt_pk_bf16_f32 v105, v98, v99
    v_mfma_f32_16x16x32_bf16 v[72:75], a[168:171], v[16:19], v[72:75]
    v_cvt_pk_bf16_f32 v106, v100, v101
    v_cvt_pk_bf16_f32 v107, v102, v103
    v_mfma_f32_16x16x32_bf16 v[76:79], a[172:175], v[16:19], v[76:79]
    s_add_u32 s19, s14, 294912
    s_waitcnt lgkmcnt(2)
    v_mfma_f32_16x16x32_bf16 v[64:67], a[176:179], v[20:23], v[64:67]
    ds_read_b128 v[16:19], v4 offset:16384
    v_mfma_f32_16x16x32_bf16 v[68:71], a[180:183], v[20:23], v[68:71]
    buffer_store_dwordx4 v[104:107], v1, s[28:31], s19 offen sc1
    v_mfma_f32_16x16x32_bf16 v[72:75], a[184:187], v[20:23], v[72:75]
    v_mfma_f32_16x16x32_bf16 v[76:79], a[188:191], v[20:23], v[76:79]
    s_waitcnt lgkmcnt(2)
    v_mfma_f32_16x16x32_bf16 v[64:67], a[192:195], v[24:27], v[64:67]
    ds_read_b128 v[20:23], v4 offset:17408
    v_mfma_f32_16x16x32_bf16 v[68:71], a[196:199], v[24:27], v[68:71]
    v_mfma_f32_16x16x32_bf16 v[72:75], a[200:203], v[24:27], v[72:75]
    v_mfma_f32_16x16x32_bf16 v[76:79], a[204:207], v[24:27], v[76:79]
    s_waitcnt lgkmcnt(2)
    v_mfma_f32_16x16x32_bf16 v[64:67], a[208:211], v[28:31], v[64:67]
    ds_read_b128 v[24:27], v4 offset:18432
    v_mfma_f32_16x16x32_bf16 v[68:71], a[212:215], v[28:31], v[68:71]
    v_mfma_f32_16x16x32_bf16 v[72:75], a[216:219], v[28:31], v[72:75]
    v_mfma_f32_16x16x32_bf16 v[76:79], a[220:223], v[28:31], v[76:79]
    s_waitcnt lgkmcnt(2)
    v_mfma_f32_16x16x32_bf16 v[64:67], a[224:227], v[16:19], v[64:67]
    ds_read_b128 v[28:31], v4 offset:19456
    v_mfma_f32_16x16x32_bf16 v[68:71], a[228:231], v[16:19], v[68:71]
    v_mfma_f32_16x16x32_bf16 v[72:75], a[232:235], v[16:19], v[72:75]
    v_mfma_f32_16x16x32_bf16 v[76:79], a[236:239], v[16:19], v[76:79]
    s_waitcnt lgkmcnt(2)
    v_mfma_f32_16x16x32_bf16 v[64:67], a[240:243], v[20:23], v[64:67]
    s_waitcnt vmcnt(12)
    s_barrier
    ds_read_b128 v[16:19], v4 offset:20480
    v_mfma_f32_16x16x32_bf16 v[68:71], a[244:247], v[20:23], v[68:71]
    v_mfma_f32_16x16x32_bf16 v[72:75], a[248:251], v[20:23], v[72:75]
    buffer_load_dword v52, v49, s[52:55], s12 offen offset:0
    v_mfma_f32_16x16x32_bf16 v[76:79], a[252:255], v[20:23], v[76:79]
    s_waitcnt lgkmcnt(2)
    v_mfma_f32_16x16x32_bf16 v[64:67], v[224:227], v[24:27], v[64:67]
    ds_read_b128 v[20:23], v4 offset:21504
    v_mfma_f32_16x16x32_bf16 v[68:71], v[228:231], v[24:27], v[68:71]
    v_mfma_f32_16x16x32_bf16 v[72:75], v[232:235], v[24:27], v[72:75]
    s_add_u32 m0, s43, 49152
    s_add_u32 s17, s16, 135168
    buffer_load_dwordx4 v1, s[24:27], s17 offen offset:0 lds
    v_mfma_f32_16x16x32_bf16 v[76:79], v[236:239], v[24:27], v[76:79]
    s_waitcnt lgkmcnt(2)
    v_mfma_f32_16x16x32_bf16 v[64:67], v[240:243], v[28:31], v[64:67]
    ds_read_b128 v[24:27], v4 offset:22528
    v_mfma_f32_16x16x32_bf16 v[68:71], v[244:247], v[28:31], v[68:71]
    v_mfma_f32_16x16x32_bf16 v[72:75], v[248:251], v[28:31], v[72:75]
    buffer_load_dwordx4 v1, s[24:27], s17 offen offset:1024 lds
    v_mfma_f32_16x16x32_bf16 v[76:79], v[252:255], v[28:31], v[76:79]
    s_waitcnt lgkmcnt(2)
    v_mfma_f32_16x16x32_bf16 v[80:83], a[0:3], v[16:19], 0
    ds_read_b128 v[28:31], v4 offset:23552
    v_mfma_f32_16x16x32_bf16 v[84:87], a[4:7], v[16:19], 0
    v_mfma_f32_16x16x32_bf16 v[88:91], a[8:11], v[16:19], 0
    buffer_load_dwordx4 v1, s[24:27], s17 offen offset:2048 lds
    v_mfma_f32_16x16x32_bf16 v[92:95], a[12:15], v[16:19], 0
    v_mul_f32 v64, s9, v64
    s_waitcnt lgkmcnt(2)
    v_mfma_f32_16x16x32_bf16 v[80:83], a[16:19], v[20:23], v[80:83]
    ds_read_b128 v[16:19], v4 offset:24576
    v_mul_f32 v65, s9, v65
    v_mfma_f32_16x16x32_bf16 v[84:87], a[20:23], v[20:23], v[84:87]
    v_exp_f32 v64, v64
    v_mfma_f32_16x16x32_bf16 v[88:91], a[24:27], v[20:23], v[88:91]
    s_add_u32 m0, s43, 98304
    s_add_u32 s17, s16, 147456
    buffer_load_dwordx4 v1, s[24:27], s17 offen offset:0 lds
    v_mfma_f32_16x16x32_bf16 v[92:95], a[28:31], v[20:23], v[92:95]
    v_mul_f32 v66, s9, v66
    s_waitcnt lgkmcnt(2)
    v_mfma_f32_16x16x32_bf16 v[80:83], a[32:35], v[24:27], v[80:83]
    ds_read_b128 v[20:23], v4 offset:25600
    v_add_f32 v64, 1.0, v64
    v_mfma_f32_16x16x32_bf16 v[84:87], a[36:39], v[24:27], v[84:87]
    v_exp_f32 v65, v65
    v_mfma_f32_16x16x32_bf16 v[88:91], a[40:43], v[24:27], v[88:91]
    buffer_load_dwordx4 v1, s[24:27], s17 offen offset:1024 lds
    v_mfma_f32_16x16x32_bf16 v[92:95], a[44:47], v[24:27], v[92:95]
    v_mul_f32 v67, s9, v67
    s_waitcnt lgkmcnt(2)
    v_mfma_f32_16x16x32_bf16 v[80:83], a[48:51], v[28:31], v[80:83]
    ds_read_b128 v[24:27], v4 offset:26624
    v_add_f32 v65, 1.0, v65
    v_mfma_f32_16x16x32_bf16 v[84:87], a[52:55], v[28:31], v[84:87]
    v_exp_f32 v66, v66
    v_mfma_f32_16x16x32_bf16 v[88:91], a[56:59], v[28:31], v[88:91]
    buffer_load_dwordx4 v1, s[24:27], s17 offen offset:2048 lds
    v_mfma_f32_16x16x32_bf16 v[92:95], a[60:63], v[28:31], v[92:95]
    v_mul_f32 v68, s9, v68
    s_waitcnt lgkmcnt(2)
    v_mfma_f32_16x16x32_bf16 v[80:83], a[64:67], v[16:19], v[80:83]
    ds_read_b128 v[28:31], v4 offset:27648
    v_add_f32 v66, 1.0, v66
    v_mfma_f32_16x16x32_bf16 v[84:87], a[68:71], v[16:19], v[84:87]
    v_rcp_f32 v64, v64
    v_mfma_f32_16x16x32_bf16 v[88:91], a[72:75], v[16:19], v[88:91]
    s_add_u32 m0, s43, 110592
    s_add_u32 s17, s16, 159744
    buffer_load_dwordx4 v1, s[24:27], s17 offen offset:0 lds
    v_mfma_f32_16x16x32_bf16 v[92:95], a[76:79], v[16:19], v[92:95]
    v_mul_f32 v64, v64, v72
    s_waitcnt lgkmcnt(2)
    v_mfma_f32_16x16x32_bf16 v[80:83], a[80:83], v[20:23], v[80:83]
    ds_read_b128 v[16:19], v4 offset:28672
    v_mul_f32 v69, s9, v69
    v_mfma_f32_16x16x32_bf16 v[84:87], a[84:87], v[20:23], v[84:87]
    v_exp_f32 v67, v67
    v_mfma_f32_16x16x32_bf16 v[88:91], a[88:91], v[20:23], v[88:91]
    buffer_load_dwordx4 v1, s[24:27], s17 offen offset:1024 lds
    v_mfma_f32_16x16x32_bf16 v[92:95], a[92:95], v[20:23], v[92:95]
    v_add_f32 v67, 1.0, v67
    s_waitcnt lgkmcnt(2)
    v_mfma_f32_16x16x32_bf16 v[80:83], a[96:99], v[24:27], v[80:83]
    ds_read_b128 v[20:23], v4 offset:29696
    v_mul_f32 v70, s9, v70
    v_mfma_f32_16x16x32_bf16 v[84:87], a[100:103], v[24:27], v[84:87]
    v_rcp_f32 v65, v65
    v_mfma_f32_16x16x32_bf16 v[88:91], a[104:107], v[24:27], v[88:91]
    buffer_load_dwordx4 v1, s[24:27], s17 offen offset:2048 lds
    v_mfma_f32_16x16x32_bf16 v[92:95], a[108:111], v[24:27], v[92:95]
    v_mul_f32 v65, v65, v73
    s_waitcnt lgkmcnt(2)
    v_mfma_f32_16x16x32_bf16 v[80:83], a[112:115], v[28:31], v[80:83]
    ds_read_b128 v[24:27], v4 offset:30720
    v_mul_f32 v71, s9, v71
    v_mfma_f32_16x16x32_bf16 v[84:87], a[116:119], v[28:31], v[84:87]
    v_exp_f32 v68, v68
    v_mfma_f32_16x16x32_bf16 v[88:91], a[120:123], v[28:31], v[88:91]
    s_add_u32 m0, s43, 122880
    s_add_u32 s17, s16, 172032
    buffer_load_dwordx4 v1, s[24:27], s17 offen offset:0 lds
    v_mfma_f32_16x16x32_bf16 v[92:95], a[124:127], v[28:31], v[92:95]
    v_add_f32 v68, 1.0, v68
    s_waitcnt lgkmcnt(2)
    v_mfma_f32_16x16x32_bf16 v[80:83], a[128:131], v[16:19], v[80:83]
    ds_read_b128 v[28:31], v4 offset:31744
    v_mfma_f32_16x16x32_bf16 v[84:87], a[132:135], v[16:19], v[84:87]
    v_rcp_f32 v66, v66
    v_mfma_f32_16x16x32_bf16 v[88:91], a[136:139], v[16:19], v[88:91]
    buffer_load_dwordx4 v1, s[24:27], s17 offen offset:1024 lds
    v_mfma_f32_16x16x32_bf16 v[92:95], a[140:143], v[16:19], v[92:95]
    v_mul_f32 v66, v66, v74
    s_waitcnt lgkmcnt(2)
    v_mfma_f32_16x16x32_bf16 v[80:83], a[144:147], v[20:23], v[80:83]
    ds_read_b128 v[16:19], v3 offset:0
    v_mfma_f32_16x16x32_bf16 v[84:87], a[148:151], v[20:23], v[84:87]
    v_exp_f32 v69, v69
    v_mfma_f32_16x16x32_bf16 v[88:91], a[152:155], v[20:23], v[88:91]
    buffer_load_dwordx4 v1, s[24:27], s17 offen offset:2048 lds
    v_mfma_f32_16x16x32_bf16 v[92:95], a[156:159], v[20:23], v[92:95]
    v_add_f32 v69, 1.0, v69
    s_waitcnt lgkmcnt(2)
    v_mfma_f32_16x16x32_bf16 v[80:83], a[160:163], v[24:27], v[80:83]
    ds_read_b128 v[20:23], v3 offset:1024
    v_mfma_f32_16x16x32_bf16 v[84:87], a[164:167], v[24:27], v[84:87]
    v_rcp_f32 v67, v67
    v_mfma_f32_16x16x32_bf16 v[88:91], a[168:171], v[24:27], v[88:91]
    v_exp_f32 v70, v70
    v_mfma_f32_16x16x32_bf16 v[92:95], a[172:175], v[24:27], v[92:95]
    v_mul_f32 v67, v67, v75
    s_waitcnt lgkmcnt(2)
    v_mfma_f32_16x16x32_bf16 v[80:83], a[176:179], v[28:31], v[80:83]
    ds_read_b128 v[24:27], v3 offset:2048
    v_add_f32 v70, 1.0, v70
    v_mfma_f32_16x16x32_bf16 v[84:87], a[180:183], v[28:31], v[84:87]
    v_rcp_f32 v68, v68
    v_mfma_f32_16x16x32_bf16 v[88:91], a[184:187], v[28:31], v[88:91]
    v_exp_f32 v71, v71
    v_mfma_f32_16x16x32_bf16 v[92:95], a[188:191], v[28:31], v[92:95]
    v_mul_f32 v68, v68, v76
    s_waitcnt lgkmcnt(2)
    v_mfma_f32_16x16x32_bf16 v[80:83], a[192:195], v[16:19], v[80:83]
    ds_read_b128 v[28:31], v3 offset:3072
    v_add_f32 v71, 1.0, v71
    v_mfma_f32_16x16x32_bf16 v[84:87], a[196:199], v[16:19], v[84:87]
    v_rcp_f32 v69, v69
    v_mfma_f32_16x16x32_bf16 v[88:91], a[200:203], v[16:19], v[88:91]
    v_rcp_f32 v70, v70
    v_mfma_f32_16x16x32_bf16 v[92:95], a[204:207], v[16:19], v[92:95]
    v_mul_f32 v69, v69, v77
    s_waitcnt lgkmcnt(2)
    v_mfma_f32_16x16x32_bf16 v[80:83], a[208:211], v[20:23], v[80:83]
    ds_read_b128 v[16:19], v3 offset:4096
    v_mul_f32 v70, v70, v78
    v_mfma_f32_16x16x32_bf16 v[84:87], a[212:215], v[20:23], v[84:87]
    v_rcp_f32 v71, v71
    v_mfma_f32_16x16x32_bf16 v[88:91], a[216:219], v[20:23], v[88:91]
    v_mul_f32 v71, v71, v79
    v_cvt_pk_bf16_f32 v72, v64, v65
    v_mfma_f32_16x16x32_bf16 v[92:95], a[220:223], v[20:23], v[92:95]
    v_cvt_pk_bf16_f32 v73, v66, v67
    s_waitcnt lgkmcnt(2)
    v_mfma_f32_16x16x32_bf16 v[80:83], a[224:227], v[24:27], v[80:83]
    ds_read_b128 v[20:23], v3 offset:5120
    v_cvt_pk_bf16_f32 v74, v68, v69
    v_mfma_f32_16x16x32_bf16 v[84:87], a[228:231], v[24:27], v[84:87]
    v_cvt_pk_bf16_f32 v75, v70, v71
    s_add_u32 s19, s14, 442368
    v_mfma_f32_16x16x32_bf16 v[88:91], a[232:235], v[24:27], v[88:91]
    buffer_store_dwordx4 v[72:75], v1, s[28:31], s19 offen sc1
    v_mfma_f32_16x16x32_bf16 v[92:95], a[236:239], v[24:27], v[92:95]
    s_waitcnt lgkmcnt(2)
    v_mfma_f32_16x16x32_bf16 v[80:83], a[240:243], v[28:31], v[80:83]
    ds_read_b128 v[24:27], v3 offset:6144
    v_mfma_f32_16x16x32_bf16 v[84:87], a[244:247], v[28:31], v[84:87]
    v_mfma_f32_16x16x32_bf16 v[88:91], a[248:251], v[28:31], v[88:91]
    v_mfma_f32_16x16x32_bf16 v[92:95], a[252:255], v[28:31], v[92:95]
    s_waitcnt lgkmcnt(2)
    v_mfma_f32_16x16x32_bf16 v[80:83], v[224:227], v[16:19], v[80:83]
    ds_read_b128 v[28:31], v3 offset:7168
    v_mfma_f32_16x16x32_bf16 v[84:87], v[228:231], v[16:19], v[84:87]
    v_mfma_f32_16x16x32_bf16 v[88:91], v[232:235], v[16:19], v[88:91]
    v_mfma_f32_16x16x32_bf16 v[92:95], v[236:239], v[16:19], v[92:95]
    s_waitcnt lgkmcnt(2)
    v_mfma_f32_16x16x32_bf16 v[80:83], v[240:243], v[20:23], v[80:83]
    ds_read_b128 v[16:19], v3 offset:8192
    v_mfma_f32_16x16x32_bf16 v[84:87], v[244:247], v[20:23], v[84:87]
    v_mfma_f32_16x16x32_bf16 v[88:91], v[248:251], v[20:23], v[88:91]
    v_mfma_f32_16x16x32_bf16 v[92:95], v[252:255], v[20:23], v[92:95]
    s_waitcnt lgkmcnt(2)
    v_mfma_f32_16x16x32_bf16 v[96:99], a[0:3], v[24:27], 0
    ds_read_b128 v[20:23], v3 offset:9216
    v_mfma_f32_16x16x32_bf16 v[100:103], a[4:7], v[24:27], 0
    v_mfma_f32_16x16x32_bf16 v[104:107], a[8:11], v[24:27], 0
    v_mfma_f32_16x16x32_bf16 v[108:111], a[12:15], v[24:27], 0
    v_mul_f32 v80, s9, v80
    s_waitcnt lgkmcnt(2)
    v_mfma_f32_16x16x32_bf16 v[96:99], a[16:19], v[28:31], v[96:99]
    ds_read_b128 v[24:27], v3 offset:10240
    v_mul_f32 v81, s9, v81
    v_mfma_f32_16x16x32_bf16 v[100:103], a[20:23], v[28:31], v[100:103]
    v_exp_f32 v80, v80
    v_mfma_f32_16x16x32_bf16 v[104:107], a[24:27], v[28:31], v[104:107]
    v_mul_f32 v82, s9, v82
    v_add_f32 v80, 1.0, v80
    v_mfma_f32_16x16x32_bf16 v[108:111], a[28:31], v[28:31], v[108:111]
    v_mul_f32 v83, s9, v83
    s_waitcnt lgkmcnt(2)
    v_mfma_f32_16x16x32_bf16 v[96:99], a[32:35], v[16:19], v[96:99]
    ds_read_b128 v[28:31], v3 offset:11264
    v_mul_f32 v84, s9, v84
    v_mfma_f32_16x16x32_bf16 v[100:103], a[36:39], v[16:19], v[100:103]
    v_exp_f32 v81, v81
    v_mfma_f32_16x16x32_bf16 v[104:107], a[40:43], v[16:19], v[104:107]
    v_exp_f32 v82, v82
    v_mfma_f32_16x16x32_bf16 v[108:111], a[44:47], v[16:19], v[108:111]
    v_add_f32 v81, 1.0, v81
    s_waitcnt lgkmcnt(2)
    v_mfma_f32_16x16x32_bf16 v[96:99], a[48:51], v[20:23], v[96:99]
    s_waitcnt vmcnt(20)
    s_barrier
    ds_read_b128 v[16:19], v3 offset:12288
    v_mfma_f32_16x16x32_bf16 v[100:103], a[52:55], v[20:23], v[100:103]
    v_rcp_f32 v80, v80
    v_mfma_f32_16x16x32_bf16 v[104:107], a[56:59], v[20:23], v[104:107]
    buffer_load_dword v52, v49, s[52:55], s12 offen offset:1792
    v_mfma_f32_16x16x32_bf16 v[108:111], a[60:63], v[20:23], v[108:111]
    v_add_f32 v82, 1.0, v82
    s_waitcnt lgkmcnt(2)
    v_mfma_f32_16x16x32_bf16 v[96:99], a[64:67], v[24:27], v[96:99]
    ds_read_b128 v[20:23], v3 offset:13312
    v_mul_f32 v80, v80, v88
    v_mfma_f32_16x16x32_bf16 v[100:103], a[68:71], v[24:27], v[100:103]
    v_exp_f32 v83, v83
    v_mfma_f32_16x16x32_bf16 v[104:107], a[72:75], v[24:27], v[104:107]
    s_add_u32 m0, s43, 135168
    s_add_u32 s17, s16, 184320
    buffer_load_dwordx4 v1, s[24:27], s17 offen offset:0 lds
    v_mfma_f32_16x16x32_bf16 v[108:111], a[76:79], v[24:27], v[108:111]
    v_mul_f32 v85, s9, v85
    s_waitcnt lgkmcnt(2)
    v_mfma_f32_16x16x32_bf16 v[96:99], a[80:83], v[28:31], v[96:99]
    ds_read_b128 v[24:27], v3 offset:14336
    v_add_f32 v83, 1.0, v83
    v_mfma_f32_16x16x32_bf16 v[100:103], a[84:87], v[28:31], v[100:103]
    v_rcp_f32 v81, v81
    v_mfma_f32_16x16x32_bf16 v[104:107], a[88:91], v[28:31], v[104:107]
    buffer_load_dwordx4 v1, s[24:27], s17 offen offset:1024 lds
    v_mfma_f32_16x16x32_bf16 v[108:111], a[92:95], v[28:31], v[108:111]
    v_mul_f32 v81, v81, v89
    s_waitcnt lgkmcnt(2)
    v_mfma_f32_16x16x32_bf16 v[96:99], a[96:99], v[16:19], v[96:99]
    ds_read_b128 v[28:31], v3 offset:15360
    v_mul_f32 v86, s9, v86
    v_mfma_f32_16x16x32_bf16 v[100:103], a[100:103], v[16:19], v[100:103]
    v_exp_f32 v84, v84
    v_mfma_f32_16x16x32_bf16 v[104:107], a[104:107], v[16:19], v[104:107]
    buffer_load_dwordx4 v1, s[24:27], s17 offen offset:2048 lds
    v_mfma_f32_16x16x32_bf16 v[108:111], a[108:111], v[16:19], v[108:111]
    v_add_f32 v84, 1.0, v84
    s_waitcnt lgkmcnt(2)
    v_mfma_f32_16x16x32_bf16 v[96:99], a[112:115], v[20:23], v[96:99]
    ds_read_b128 v[16:19], v3 offset:16384
    v_mul_f32 v87, s9, v87
    v_mfma_f32_16x16x32_bf16 v[100:103], a[116:119], v[20:23], v[100:103]
    v_rcp_f32 v82, v82
    v_mfma_f32_16x16x32_bf16 v[104:107], a[120:123], v[20:23], v[104:107]
    v_exp_f32 v85, v85
    v_mfma_f32_16x16x32_bf16 v[108:111], a[124:127], v[20:23], v[108:111]
    v_mul_f32 v82, v82, v90
    s_waitcnt lgkmcnt(2)
    v_mfma_f32_16x16x32_bf16 v[96:99], a[128:131], v[24:27], v[96:99]
    ds_read_b128 v[20:23], v3 offset:17408
    v_add_f32 v85, 1.0, v85
    v_mfma_f32_16x16x32_bf16 v[100:103], a[132:135], v[24:27], v[100:103]
    v_rcp_f32 v83, v83
    v_mfma_f32_16x16x32_bf16 v[104:107], a[136:139], v[24:27], v[104:107]
    v_exp_f32 v86, v86
    v_mfma_f32_16x16x32_bf16 v[108:111], a[140:143], v[24:27], v[108:111]
    v_mul_f32 v83, v83, v91
    s_waitcnt lgkmcnt(2)
    v_mfma_f32_16x16x32_bf16 v[96:99], a[144:147], v[28:31], v[96:99]
    ds_read_b128 v[24:27], v3 offset:18432
    v_add_f32 v86, 1.0, v86
    v_mfma_f32_16x16x32_bf16 v[100:103], a[148:151], v[28:31], v[100:103]
    v_rcp_f32 v84, v84
    v_mfma_f32_16x16x32_bf16 v[104:107], a[152:155], v[28:31], v[104:107]
    v_exp_f32 v87, v87
    v_mfma_f32_16x16x32_bf16 v[108:111], a[156:159], v[28:31], v[108:111]
    v_mul_f32 v84, v84, v92
    s_waitcnt lgkmcnt(2)
    v_mfma_f32_16x16x32_bf16 v[96:99], a[160:163], v[16:19], v[96:99]
    ds_read_b128 v[28:31], v3 offset:19456
    v_add_f32 v87, 1.0, v87
    v_mfma_f32_16x16x32_bf16 v[100:103], a[164:167], v[16:19], v[100:103]
    v_rcp_f32 v85, v85
    v_mfma_f32_16x16x32_bf16 v[104:107], a[168:171], v[16:19], v[104:107]
    v_rcp_f32 v86, v86
    v_mfma_f32_16x16x32_bf16 v[108:111], a[172:175], v[16:19], v[108:111]
    v_mul_f32 v85, v85, v93
    s_waitcnt lgkmcnt(2)
    v_mfma_f32_16x16x32_bf16 v[96:99], a[176:179], v[20:23], v[96:99]
    ds_read_b128 v[16:19], v3 offset:20480
    v_mul_f32 v86, v86, v94
    v_mfma_f32_16x16x32_bf16 v[100:103], a[180:183], v[20:23], v[100:103]
    v_rcp_f32 v87, v87
    v_mfma_f32_16x16x32_bf16 v[104:107], a[184:187], v[20:23], v[104:107]
    v_mul_f32 v87, v87, v95
    v_cvt_pk_bf16_f32 v88, v80, v81
    v_mfma_f32_16x16x32_bf16 v[108:111], a[188:191], v[20:23], v[108:111]
    v_cvt_pk_bf16_f32 v89, v82, v83
    s_waitcnt lgkmcnt(2)
    v_mfma_f32_16x16x32_bf16 v[96:99], a[192:195], v[24:27], v[96:99]
    ds_read_b128 v[20:23], v3 offset:21504
    v_cvt_pk_bf16_f32 v90, v84, v85
    v_mfma_f32_16x16x32_bf16 v[100:103], a[196:199], v[24:27], v[100:103]
    v_cvt_pk_bf16_f32 v91, v86, v87
    s_add_u32 s19, s14, 589824
    v_mfma_f32_16x16x32_bf16 v[104:107], a[200:203], v[24:27], v[104:107]
    buffer_store_dwordx4 v[88:91], v1, s[28:31], s19 offen sc1
    v_mfma_f32_16x16x32_bf16 v[108:111], a[204:207], v[24:27], v[108:111]
    s_waitcnt lgkmcnt(2)
    v_mfma_f32_16x16x32_bf16 v[96:99], a[208:211], v[28:31], v[96:99]
    ds_read_b128 v[24:27], v3 offset:22528
    v_mfma_f32_16x16x32_bf16 v[100:103], a[212:215], v[28:31], v[100:103]
    v_mfma_f32_16x16x32_bf16 v[104:107], a[216:219], v[28:31], v[104:107]
    v_mfma_f32_16x16x32_bf16 v[108:111], a[220:223], v[28:31], v[108:111]
    s_waitcnt lgkmcnt(2)
    v_mfma_f32_16x16x32_bf16 v[96:99], a[224:227], v[16:19], v[96:99]
    ds_read_b128 v[28:31], v3 offset:23552
    v_mfma_f32_16x16x32_bf16 v[100:103], a[228:231], v[16:19], v[100:103]
    v_mfma_f32_16x16x32_bf16 v[104:107], a[232:235], v[16:19], v[104:107]
    v_mfma_f32_16x16x32_bf16 v[108:111], a[236:239], v[16:19], v[108:111]
    s_waitcnt lgkmcnt(2)
    v_mfma_f32_16x16x32_bf16 v[96:99], a[240:243], v[20:23], v[96:99]
    ds_read_b128 v[16:19], v3 offset:24576
    v_mfma_f32_16x16x32_bf16 v[100:103], a[244:247], v[20:23], v[100:103]
    v_mfma_f32_16x16x32_bf16 v[104:107], a[248:251], v[20:23], v[104:107]
    v_mfma_f32_16x16x32_bf16 v[108:111], a[252:255], v[20:23], v[108:111]
    s_waitcnt lgkmcnt(2)
    v_mfma_f32_16x16x32_bf16 v[96:99], v[224:227], v[24:27], v[96:99]
    ds_read_b128 v[20:23], v3 offset:25600
    v_mfma_f32_16x16x32_bf16 v[100:103], v[228:231], v[24:27], v[100:103]
    v_mfma_f32_16x16x32_bf16 v[104:107], v[232:235], v[24:27], v[104:107]
    v_mfma_f32_16x16x32_bf16 v[108:111], v[236:239], v[24:27], v[108:111]
    s_waitcnt lgkmcnt(2)
    v_mfma_f32_16x16x32_bf16 v[96:99], v[240:243], v[28:31], v[96:99]
    ds_read_b128 v[24:27], v3 offset:26624
    v_mfma_f32_16x16x32_bf16 v[100:103], v[244:247], v[28:31], v[100:103]
    v_mfma_f32_16x16x32_bf16 v[104:107], v[248:251], v[28:31], v[104:107]
    v_mfma_f32_16x16x32_bf16 v[108:111], v[252:255], v[28:31], v[108:111]
    s_waitcnt lgkmcnt(2)
    v_mfma_f32_16x16x32_bf16 v[64:67], a[0:3], v[16:19], 0
    ds_read_b128 v[28:31], v3 offset:27648
    v_mfma_f32_16x16x32_bf16 v[68:71], a[4:7], v[16:19], 0
    v_mfma_f32_16x16x32_bf16 v[72:75], a[8:11], v[16:19], 0
    v_mfma_f32_16x16x32_bf16 v[76:79], a[12:15], v[16:19], 0
    v_mul_f32 v96, s9, v96
    s_waitcnt lgkmcnt(2)
    v_mfma_f32_16x16x32_bf16 v[64:67], a[16:19], v[20:23], v[64:67]
    ds_read_b128 v[16:19], v3 offset:28672
    v_mul_f32 v97, s9, v97
    v_mfma_f32_16x16x32_bf16 v[68:71], a[20:23], v[20:23], v[68:71]
    v_exp_f32 v96, v96
    v_mfma_f32_16x16x32_bf16 v[72:75], a[24:27], v[20:23], v[72:75]
    v_mul_f32 v98, s9, v98
    v_add_f32 v96, 1.0, v96
    v_mfma_f32_16x16x32_bf16 v[76:79], a[28:31], v[20:23], v[76:79]
    v_mul_f32 v99, s9, v99
    s_waitcnt lgkmcnt(2)
    v_mfma_f32_16x16x32_bf16 v[64:67], a[32:35], v[24:27], v[64:67]
    ds_read_b128 v[20:23], v3 offset:29696
    v_mul_f32 v100, s9, v100
    v_mfma_f32_16x16x32_bf16 v[68:71], a[36:39], v[24:27], v[68:71]
    v_exp_f32 v97, v97
    v_mfma_f32_16x16x32_bf16 v[72:75], a[40:43], v[24:27], v[72:75]
    v_exp_f32 v98, v98
    v_mfma_f32_16x16x32_bf16 v[76:79], a[44:47], v[24:27], v[76:79]
    v_add_f32 v97, 1.0, v97
    s_waitcnt lgkmcnt(2)
    v_mfma_f32_16x16x32_bf16 v[64:67], a[48:51], v[28:31], v[64:67]
    ds_read_b128 v[24:27], v3 offset:30720
    v_add_f32 v98, 1.0, v98
    v_mfma_f32_16x16x32_bf16 v[68:71], a[52:55], v[28:31], v[68:71]
    v_rcp_f32 v96, v96
    v_mfma_f32_16x16x32_bf16 v[72:75], a[56:59], v[28:31], v[72:75]
    v_exp_f32 v99, v99
    v_mfma_f32_16x16x32_bf16 v[76:79], a[60:63], v[28:31], v[76:79]
    v_mul_f32 v96, v96, v104
    s_waitcnt lgkmcnt(2)
    v_mfma_f32_16x16x32_bf16 v[64:67], a[64:67], v[16:19], v[64:67]
    ds_read_b128 v[28:31], v3 offset:31744
    v_mul_f32 v101, s9, v101
    v_mfma_f32_16x16x32_bf16 v[68:71], a[68:71], v[16:19], v[68:71]
    v_rcp_f32 v97, v97
    v_mfma_f32_16x16x32_bf16 v[72:75], a[72:75], v[16:19], v[72:75]
    v_exp_f32 v100, v100
    v_mfma_f32_16x16x32_bf16 v[76:79], a[76:79], v[16:19], v[76:79]
    v_add_f32 v99, 1.0, v99
    s_waitcnt lgkmcnt(2)
    v_mfma_f32_16x16x32_bf16 v[64:67], a[80:83], v[20:23], v[64:67]
    ds_read_b128 v[16:19], v3 offset:32768
    v_mul_f32 v97, v97, v105
    v_mfma_f32_16x16x32_bf16 v[68:71], a[84:87], v[20:23], v[68:71]
    v_rcp_f32 v98, v98
    v_mfma_f32_16x16x32_bf16 v[72:75], a[88:91], v[20:23], v[72:75]
    v_mul_f32 v102, s9, v102
    v_add_f32 v100, 1.0, v100
    v_mfma_f32_16x16x32_bf16 v[76:79], a[92:95], v[20:23], v[76:79]
    v_mul_f32 v98, v98, v106
    s_waitcnt lgkmcnt(2)
    v_mfma_f32_16x16x32_bf16 v[64:67], a[96:99], v[24:27], v[64:67]
    ds_read_b128 v[20:23], v3 offset:33792
    v_mul_f32 v103, s9, v103
    v_mfma_f32_16x16x32_bf16 v[68:71], a[100:103], v[24:27], v[68:71]
    v_exp_f32 v101, v101
    v_mfma_f32_16x16x32_bf16 v[72:75], a[104:107], v[24:27], v[72:75]
    v_rcp_f32 v99, v99
    v_mfma_f32_16x16x32_bf16 v[76:79], a[108:111], v[24:27], v[76:79]
    v_add_f32 v101, 1.0, v101
    s_waitcnt lgkmcnt(2)
    v_mfma_f32_16x16x32_bf16 v[64:67], a[112:115], v[28:31], v[64:67]
    ds_read_b128 v[24:27], v3 offset:34816
    v_mul_f32 v99, v99, v107
    v_mfma_f32_16x16x32_bf16 v[68:71], a[116:119], v[28:31], v[68:71]
    v_exp_f32 v102, v102
    v_mfma_f32_16x16x32_bf16 v[72:75], a[120:123], v[28:31], v[72:75]
    v_rcp_f32 v100, v100
    v_mfma_f32_16x16x32_bf16 v[76:79], a[124:127], v[28:31], v[76:79]
    v_add_f32 v102, 1.0, v102
    s_waitcnt lgkmcnt(2)
    v_mfma_f32_16x16x32_bf16 v[64:67], a[128:131], v[16:19], v[64:67]
    ds_read_b128 v[28:31], v3 offset:35840
    v_mul_f32 v100, v100, v108
    v_mfma_f32_16x16x32_bf16 v[68:71], a[132:135], v[16:19], v[68:71]
    v_exp_f32 v103, v103
    v_mfma_f32_16x16x32_bf16 v[72:75], a[136:139], v[16:19], v[72:75]
    v_rcp_f32 v101, v101
    v_mfma_f32_16x16x32_bf16 v[76:79], a[140:143], v[16:19], v[76:79]
    v_add_f32 v103, 1.0, v103
    s_waitcnt lgkmcnt(2)
    v_mfma_f32_16x16x32_bf16 v[64:67], a[144:147], v[20:23], v[64:67]
    s_waitcnt vmcnt(15)
    s_barrier
    ds_read_b128 v[16:19], v3 offset:36864
    v_mfma_f32_16x16x32_bf16 v[68:71], a[148:151], v[20:23], v[68:71]
    v_rcp_f32 v102, v102
    v_mfma_f32_16x16x32_bf16 v[72:75], a[152:155], v[20:23], v[72:75]
    buffer_load_dword v52, v49, s[52:55], s12 offen offset:3584
    v_mfma_f32_16x16x32_bf16 v[76:79], a[156:159], v[20:23], v[76:79]
    v_mul_f32 v101, v101, v109
    s_waitcnt lgkmcnt(2)
    v_mfma_f32_16x16x32_bf16 v[64:67], a[160:163], v[24:27], v[64:67]
    ds_read_b128 v[20:23], v3 offset:37888
    v_mul_f32 v102, v102, v110
    v_mfma_f32_16x16x32_bf16 v[68:71], a[164:167], v[24:27], v[68:71]
    v_rcp_f32 v103, v103
    v_mfma_f32_16x16x32_bf16 v[72:75], a[168:171], v[24:27], v[72:75]
    s_add_u32 m0, s43, 0
    s_add_u32 s17, s16, 196608
    buffer_load_dwordx4 v1, s[24:27], s17 offen offset:0 lds
    v_mfma_f32_16x16x32_bf16 v[76:79], a[172:175], v[24:27], v[76:79]
    v_mul_f32 v103, v103, v111
    s_waitcnt lgkmcnt(2)
    v_mfma_f32_16x16x32_bf16 v[64:67], a[176:179], v[28:31], v[64:67]
    ds_read_b128 v[24:27], v3 offset:38912
    v_cvt_pk_bf16_f32 v104, v96, v97
    v_mfma_f32_16x16x32_bf16 v[68:71], a[180:183], v[28:31], v[68:71]
    v_cvt_pk_bf16_f32 v105, v98, v99
    v_cvt_pk_bf16_f32 v106, v100, v101
    v_mfma_f32_16x16x32_bf16 v[72:75], a[184:187], v[28:31], v[72:75]
    buffer_load_dwordx4 v1, s[24:27], s17 offen offset:1024 lds
    v_mfma_f32_16x16x32_bf16 v[76:79], a[188:191], v[28:31], v[76:79]
    v_cvt_pk_bf16_f32 v107, v102, v103
    s_waitcnt lgkmcnt(2)
    v_mfma_f32_16x16x32_bf16 v[64:67], a[192:195], v[16:19], v[64:67]
    ds_read_b128 v[28:31], v3 offset:39936
    s_add_u32 s19, s14, 737280
    v_mfma_f32_16x16x32_bf16 v[68:71], a[196:199], v[16:19], v[68:71]
    buffer_store_dwordx4 v[104:107], v1, s[28:31], s19 offen sc1
    v_mfma_f32_16x16x32_bf16 v[72:75], a[200:203], v[16:19], v[72:75]
    buffer_load_dwordx4 v1, s[24:27], s17 offen offset:2048 lds
    v_mfma_f32_16x16x32_bf16 v[76:79], a[204:207], v[16:19], v[76:79]
    s_waitcnt lgkmcnt(2)
    v_mfma_f32_16x16x32_bf16 v[64:67], a[208:211], v[20:23], v[64:67]
    ds_read_b128 v[16:19], v3 offset:40960
    v_mfma_f32_16x16x32_bf16 v[68:71], a[212:215], v[20:23], v[68:71]
    v_mfma_f32_16x16x32_bf16 v[72:75], a[216:219], v[20:23], v[72:75]
    s_add_u32 m0, s43, 12288
    s_add_u32 s17, s16, 208896
    buffer_load_dwordx4 v1, s[24:27], s17 offen offset:0 lds
    v_mfma_f32_16x16x32_bf16 v[76:79], a[220:223], v[20:23], v[76:79]
    s_waitcnt lgkmcnt(2)
    v_mfma_f32_16x16x32_bf16 v[64:67], a[224:227], v[24:27], v[64:67]
    ds_read_b128 v[20:23], v3 offset:41984
    v_mfma_f32_16x16x32_bf16 v[68:71], a[228:231], v[24:27], v[68:71]
    v_mfma_f32_16x16x32_bf16 v[72:75], a[232:235], v[24:27], v[72:75]
    buffer_load_dwordx4 v1, s[24:27], s17 offen offset:1024 lds
    v_mfma_f32_16x16x32_bf16 v[76:79], a[236:239], v[24:27], v[76:79]
    s_waitcnt lgkmcnt(2)
    v_mfma_f32_16x16x32_bf16 v[64:67], a[240:243], v[28:31], v[64:67]
    ds_read_b128 v[24:27], v3 offset:43008
    v_mfma_f32_16x16x32_bf16 v[68:71], a[244:247], v[28:31], v[68:71]
    v_mfma_f32_16x16x32_bf16 v[72:75], a[248:251], v[28:31], v[72:75]
    buffer_load_dwordx4 v1, s[24:27], s17 offen offset:2048 lds
    v_mfma_f32_16x16x32_bf16 v[76:79], a[252:255], v[28:31], v[76:79]
    s_waitcnt lgkmcnt(2)
    v_mfma_f32_16x16x32_bf16 v[64:67], v[224:227], v[16:19], v[64:67]
    ds_read_b128 v[28:31], v3 offset:44032
    v_mfma_f32_16x16x32_bf16 v[68:71], v[228:231], v[16:19], v[68:71]
    v_mfma_f32_16x16x32_bf16 v[72:75], v[232:235], v[16:19], v[72:75]
    v_mfma_f32_16x16x32_bf16 v[76:79], v[236:239], v[16:19], v[76:79]
    s_waitcnt lgkmcnt(2)
    v_mfma_f32_16x16x32_bf16 v[64:67], v[240:243], v[20:23], v[64:67]
    ds_read_b128 v[16:19], v3 offset:45056
    v_mfma_f32_16x16x32_bf16 v[68:71], v[244:247], v[20:23], v[68:71]
    v_mfma_f32_16x16x32_bf16 v[72:75], v[248:251], v[20:23], v[72:75]
    v_mfma_f32_16x16x32_bf16 v[76:79], v[252:255], v[20:23], v[76:79]
    s_waitcnt lgkmcnt(2)
    v_mfma_f32_16x16x32_bf16 v[80:83], a[0:3], v[24:27], 0
    ds_read_b128 v[20:23], v3 offset:46080
    v_mfma_f32_16x16x32_bf16 v[84:87], a[4:7], v[24:27], 0
    v_mfma_f32_16x16x32_bf16 v[88:91], a[8:11], v[24:27], 0
    v_mfma_f32_16x16x32_bf16 v[92:95], a[12:15], v[24:27], 0
    v_mul_f32 v64, s9, v64
    s_waitcnt lgkmcnt(2)
    v_mfma_f32_16x16x32_bf16 v[80:83], a[16:19], v[28:31], v[80:83]
    ds_read_b128 v[24:27], v3 offset:47104
    v_mul_f32 v65, s9, v65
    v_mfma_f32_16x16x32_bf16 v[84:87], a[20:23], v[28:31], v[84:87]
    v_exp_f32 v64, v64
    v_mfma_f32_16x16x32_bf16 v[88:91], a[24:27], v[28:31], v[88:91]
    v_mul_f32 v66, s9, v66
    v_add_f32 v64, 1.0, v64
    v_mfma_f32_16x16x32_bf16 v[92:95], a[28:31], v[28:31], v[92:95]
    v_mul_f32 v67, s9, v67
    s_waitcnt lgkmcnt(2)
    v_mfma_f32_16x16x32_bf16 v[80:83], a[32:35], v[16:19], v[80:83]
    ds_read_b128 v[28:31], v3 offset:48128
    v_mul_f32 v68, s9, v68
    v_mfma_f32_16x16x32_bf16 v[84:87], a[36:39], v[16:19], v[84:87]
    v_exp_f32 v65, v65
    v_mfma_f32_16x16x32_bf16 v[88:91], a[40:43], v[16:19], v[88:91]
    v_exp_f32 v66, v66
    v_mfma_f32_16x16x32_bf16 v[92:95], a[44:47], v[16:19], v[92:95]
    v_add_f32 v65, 1.0, v65
    s_waitcnt lgkmcnt(2)
    v_mfma_f32_16x16x32_bf16 v[80:83], a[48:51], v[20:23], v[80:83]
    ds_read_b128 v[16:19], v3 offset:49152
    v_add_f32 v66, 1.0, v66
    v_mfma_f32_16x16x32_bf16 v[84:87], a[52:55], v[20:23], v[84:87]
    v_rcp_f32 v64, v64
    v_mfma_f32_16x16x32_bf16 v[88:91], a[56:59], v[20:23], v[88:91]
    v_exp_f32 v67, v67
    v_mfma_f32_16x16x32_bf16 v[92:95], a[60:63], v[20:23], v[92:95]
    v_mul_f32 v64, v64, v72
    s_waitcnt lgkmcnt(2)
    v_mfma_f32_16x16x32_bf16 v[80:83], a[64:67], v[24:27], v[80:83]
    ds_read_b128 v[20:23], v3 offset:50176
    v_mul_f32 v69, s9, v69
    v_mfma_f32_16x16x32_bf16 v[84:87], a[68:71], v[24:27], v[84:87]
    v_rcp_f32 v65, v65
    v_mfma_f32_16x16x32_bf16 v[88:91], a[72:75], v[24:27], v[88:91]
    v_exp_f32 v68, v68
    v_mfma_f32_16x16x32_bf16 v[92:95], a[76:79], v[24:27], v[92:95]
    v_add_f32 v67, 1.0, v67
    s_waitcnt lgkmcnt(2)
    v_mfma_f32_16x16x32_bf16 v[80:83], a[80:83], v[28:31], v[80:83]
    ds_read_b128 v[24:27], v3 offset:51200
    v_mul_f32 v65, v65, v73
    v_mfma_f32_16x16x32_bf16 v[84:87], a[84:87], v[28:31], v[84:87]
    v_rcp_f32 v66, v66
    v_mfma_f32_16x16x32_bf16 v[88:91], a[88:91], v[28:31], v[88:91]
    v_mul_f32 v70, s9, v70
    v_add_f32 v68, 1.0, v68
    v_mfma_f32_16x16x32_bf16 v[92:95], a[92:95], v[28:31], v[92:95]
    v_mul_f32 v66, v66, v74
    s_waitcnt lgkmcnt(2)
    v_mfma_f32_16x16x32_bf16 v[80:83], a[96:99], v[16:19], v[80:83]
    ds_read_b128 v[28:31], v3 offset:52224
    v_mul_f32 v71, s9, v71
    v_mfma_f32_16x16x32_bf16 v[84:87], a[100:103], v[16:19], v[84:87]
    v_exp_f32 v69, v69
    v_mfma_f32_16x16x32_bf16 v[88:91], a[104:107], v[16:19], v[88:91]
    v_rcp_f32 v67, v67
    v_mfma_f32_16x16x32_bf16 v[92:95], a[108:111], v[16:19], v[92:95]
    v_add_f32 v69, 1.0, v69
    s_waitcnt lgkmcnt(2)
    v_mfma_f32_16x16x32_bf16 v[80:83], a[112:115], v[20:23], v[80:83]
    ds_read_b128 v[16:19], v3 offset:53248
    v_mul_f32 v67, v67, v75
    v_mfma_f32_16x16x32_bf16 v[84:87], a[116:119], v[20:23], v[84:87]
    v_exp_f32 v70, v70
    v_mfma_f32_16x16x32_bf16 v[88:91], a[120:123], v[20:23], v[88:91]
    v_rcp_f32 v68, v68
    v_mfma_f32_16x16x32_bf16 v[92:95], a[124:127], v[20:23], v[92:95]
    v_add_f32 v70, 1.0, v70
    s_waitcnt lgkmcnt(2)
    v_mfma_f32_16x16x32_bf16 v[80:83], a[128:131], v[24:27], v[80:83]
    ds_read_b128 v[20:23], v3 offset:54272
    v_mul_f32 v68, v68, v76
    v_mfma_f32_16x16x32_bf16 v[84:87], a[132:135], v[24:27], v[84:87]
    v_exp_f32 v71, v71
    v_mfma_f32_16x16x32_bf16 v[88:91], a[136:139], v[24:27], v[88:91]
    v_rcp_f32 v69, v69
    v_mfma_f32_16x16x32_bf16 v[92:95], a[140:143], v[24:27], v[92:95]
    v_add_f32 v71, 1.0, v71
    s_waitcnt lgkmcnt(2)
    v_mfma_f32_16x16x32_bf16 v[80:83], a[144:147], v[28:31], v[80:83]
    ds_read_b128 v[24:27], v3 offset:55296
    v_mul_f32 v69, v69, v77
    v_mfma_f32_16x16x32_bf16 v[84:87], a[148:151], v[28:31], v[84:87]
    v_rcp_f32 v70, v70
    v_mfma_f32_16x16x32_bf16 v[88:91], a[152:155], v[28:31], v[88:91]
    v_rcp_f32 v71, v71
    v_mfma_f32_16x16x32_bf16 v[92:95], a[156:159], v[28:31], v[92:95]
    v_mul_f32 v70, v70, v78
    s_waitcnt lgkmcnt(2)
    v_mfma_f32_16x16x32_bf16 v[80:83], a[160:163], v[16:19], v[80:83]
    ds_read_b128 v[28:31], v3 offset:56320
    v_mul_f32 v71, v71, v79
    v_mfma_f32_16x16x32_bf16 v[84:87], a[164:167], v[16:19], v[84:87]
    v_cvt_pk_bf16_f32 v72, v64, v65
    v_cvt_pk_bf16_f32 v73, v66, v67
    v_mfma_f32_16x16x32_bf16 v[88:91], a[168:171], v[16:19], v[88:91]
    v_cvt_pk_bf16_f32 v74, v68, v69
    v_cvt_pk_bf16_f32 v75, v70, v71
    v_mfma_f32_16x16x32_bf16 v[92:95], a[172:175], v[16:19], v[92:95]
    s_add_u32 s19, s14, 884736
    s_waitcnt lgkmcnt(2)
    v_mfma_f32_16x16x32_bf16 v[80:83], a[176:179], v[20:23], v[80:83]
    ds_read_b128 v[16:19], v3 offset:57344
    v_mfma_f32_16x16x32_bf16 v[84:87], a[180:183], v[20:23], v[84:87]
    buffer_store_dwordx4 v[72:75], v1, s[28:31], s19 offen sc1
    v_mfma_f32_16x16x32_bf16 v[88:91], a[184:187], v[20:23], v[88:91]
    v_mfma_f32_16x16x32_bf16 v[92:95], a[188:191], v[20:23], v[92:95]
    s_waitcnt lgkmcnt(2)
    v_mfma_f32_16x16x32_bf16 v[80:83], a[192:195], v[24:27], v[80:83]
    ds_read_b128 v[20:23], v3 offset:58368
    v_mfma_f32_16x16x32_bf16 v[84:87], a[196:199], v[24:27], v[84:87]
    v_mfma_f32_16x16x32_bf16 v[88:91], a[200:203], v[24:27], v[88:91]
    v_mfma_f32_16x16x32_bf16 v[92:95], a[204:207], v[24:27], v[92:95]
    s_waitcnt lgkmcnt(2)
    v_mfma_f32_16x16x32_bf16 v[80:83], a[208:211], v[28:31], v[80:83]
    ds_read_b128 v[24:27], v3 offset:59392
    v_mfma_f32_16x16x32_bf16 v[84:87], a[212:215], v[28:31], v[84:87]
    v_mfma_f32_16x16x32_bf16 v[88:91], a[216:219], v[28:31], v[88:91]
    v_mfma_f32_16x16x32_bf16 v[92:95], a[220:223], v[28:31], v[92:95]
    s_waitcnt lgkmcnt(2)
    v_mfma_f32_16x16x32_bf16 v[80:83], a[224:227], v[16:19], v[80:83]
    ds_read_b128 v[28:31], v3 offset:60416
    v_mfma_f32_16x16x32_bf16 v[84:87], a[228:231], v[16:19], v[84:87]
    v_mfma_f32_16x16x32_bf16 v[88:91], a[232:235], v[16:19], v[88:91]
    v_mfma_f32_16x16x32_bf16 v[92:95], a[236:239], v[16:19], v[92:95]
    s_waitcnt lgkmcnt(2)
    v_mfma_f32_16x16x32_bf16 v[80:83], a[240:243], v[20:23], v[80:83]
    s_waitcnt vmcnt(18)
    s_barrier
    ds_read_b128 v[16:19], v4 offset:32768
    v_mfma_f32_16x16x32_bf16 v[84:87], a[244:247], v[20:23], v[84:87]
    v_mfma_f32_16x16x32_bf16 v[88:91], a[248:251], v[20:23], v[88:91]
    buffer_load_dword v52, v49, s[52:55], s13 offen offset:0
    v_mfma_f32_16x16x32_bf16 v[92:95], a[252:255], v[20:23], v[92:95]
    s_waitcnt lgkmcnt(2)
    v_mfma_f32_16x16x32_bf16 v[80:83], v[224:227], v[24:27], v[80:83]
    ds_read_b128 v[20:23], v4 offset:33792
    v_mfma_f32_16x16x32_bf16 v[84:87], v[228:231], v[24:27], v[84:87]
    v_mfma_f32_16x16x32_bf16 v[88:91], v[232:235], v[24:27], v[88:91]
    s_add_u32 m0, s43, 24576
    s_add_u32 s17, s16, 221184
    buffer_load_dwordx4 v1, s[24:27], s17 offen offset:0 lds
    v_mfma_f32_16x16x32_bf16 v[92:95], v[236:239], v[24:27], v[92:95]
    s_waitcnt lgkmcnt(2)
    v_mfma_f32_16x16x32_bf16 v[80:83], v[240:243], v[28:31], v[80:83]
    ds_read_b128 v[24:27], v4 offset:34816
    v_mfma_f32_16x16x32_bf16 v[84:87], v[244:247], v[28:31], v[84:87]
    v_mfma_f32_16x16x32_bf16 v[88:91], v[248:251], v[28:31], v[88:91]
    buffer_load_dwordx4 v1, s[24:27], s17 offen offset:1024 lds
    v_mfma_f32_16x16x32_bf16 v[92:95], v[252:255], v[28:31], v[92:95]
    s_waitcnt lgkmcnt(2)
    v_mfma_f32_16x16x32_bf16 v[96:99], a[0:3], v[16:19], 0
    ds_read_b128 v[28:31], v4 offset:35840
    v_mfma_f32_16x16x32_bf16 v[100:103], a[4:7], v[16:19], 0
    v_mfma_f32_16x16x32_bf16 v[104:107], a[8:11], v[16:19], 0
    buffer_load_dwordx4 v1, s[24:27], s17 offen offset:2048 lds
    v_mfma_f32_16x16x32_bf16 v[108:111], a[12:15], v[16:19], 0
    v_mul_f32 v80, s9, v80
    s_waitcnt lgkmcnt(2)
    v_mfma_f32_16x16x32_bf16 v[96:99], a[16:19], v[20:23], v[96:99]
    ds_read_b128 v[16:19], v4 offset:36864
    v_mul_f32 v81, s9, v81
    v_mfma_f32_16x16x32_bf16 v[100:103], a[20:23], v[20:23], v[100:103]
    v_exp_f32 v80, v80
    v_mfma_f32_16x16x32_bf16 v[104:107], a[24:27], v[20:23], v[104:107]
    s_add_u32 m0, s43, 36864
    s_add_u32 s17, s16, 233472
    buffer_load_dwordx4 v1, s[24:27], s17 offen offset:0 lds
    v_mfma_f32_16x16x32_bf16 v[108:111], a[28:31], v[20:23], v[108:111]
    v_mul_f32 v82, s9, v82
    s_waitcnt lgkmcnt(2)
    v_mfma_f32_16x16x32_bf16 v[96:99], a[32:35], v[24:27], v[96:99]
    ds_read_b128 v[20:23], v4 offset:37888
    v_add_f32 v80, 1.0, v80
    v_mfma_f32_16x16x32_bf16 v[100:103], a[36:39], v[24:27], v[100:103]
    v_exp_f32 v81, v81
    v_mfma_f32_16x16x32_bf16 v[104:107], a[40:43], v[24:27], v[104:107]
    buffer_load_dwordx4 v1, s[24:27], s17 offen offset:1024 lds
    v_mfma_f32_16x16x32_bf16 v[108:111], a[44:47], v[24:27], v[108:111]
    v_mul_f32 v83, s9, v83
    s_waitcnt lgkmcnt(2)
    v_mfma_f32_16x16x32_bf16 v[96:99], a[48:51], v[28:31], v[96:99]
    ds_read_b128 v[24:27], v4 offset:38912
    v_add_f32 v81, 1.0, v81
    v_mfma_f32_16x16x32_bf16 v[100:103], a[52:55], v[28:31], v[100:103]
    v_exp_f32 v82, v82
    v_mfma_f32_16x16x32_bf16 v[104:107], a[56:59], v[28:31], v[104:107]
    buffer_load_dwordx4 v1, s[24:27], s17 offen offset:2048 lds
    v_mfma_f32_16x16x32_bf16 v[108:111], a[60:63], v[28:31], v[108:111]
    v_mul_f32 v84, s9, v84
    s_waitcnt lgkmcnt(2)
    v_mfma_f32_16x16x32_bf16 v[96:99], a[64:67], v[16:19], v[96:99]
    ds_read_b128 v[28:31], v4 offset:39936
    v_add_f32 v82, 1.0, v82
    v_mfma_f32_16x16x32_bf16 v[100:103], a[68:71], v[16:19], v[100:103]
    v_rcp_f32 v80, v80
    v_mfma_f32_16x16x32_bf16 v[104:107], a[72:75], v[16:19], v[104:107]
    v_exp_f32 v83, v83
    v_mfma_f32_16x16x32_bf16 v[108:111], a[76:79], v[16:19], v[108:111]
    v_mul_f32 v80, v80, v88
    s_waitcnt lgkmcnt(2)
    v_mfma_f32_16x16x32_bf16 v[96:99], a[80:83], v[20:23], v[96:99]
    ds_read_b128 v[16:19], v4 offset:40960
    v_mul_f32 v85, s9, v85
    v_mfma_f32_16x16x32_bf16 v[100:103], a[84:87], v[20:23], v[100:103]
    v_rcp_f32 v81, v81
    v_mfma_f32_16x16x32_bf16 v[104:107], a[88:91], v[20:23], v[104:107]
    v_exp_f32 v84, v84
    v_mfma_f32_16x16x32_bf16 v[108:111], a[92:95], v[20:23], v[108:111]
    v_add_f32 v83, 1.0, v83
    s_waitcnt lgkmcnt(2)
    v_mfma_f32_16x16x32_bf16 v[96:99], a[96:99], v[24:27], v[96:99]
    ds_read_b128 v[20:23], v4 offset:41984
    v_mul_f32 v81, v81, v89
    v_mfma_f32_16x16x32_bf16 v[100:103], a[100:103], v[24:27], v[100:103]
    v_rcp_f32 v82, v82
    v_mfma_f32_16x16x32_bf16 v[104:107], a[104:107], v[24:27], v[104:107]
    v_mul_f32 v86, s9, v86
    v_add_f32 v84, 1.0, v84
    v_mfma_f32_16x16x32_bf16 v[108:111], a[108:111], v[24:27], v[108:111]
    v_mul_f32 v82, v82, v90
    s_waitcnt lgkmcnt(2)
    v_mfma_f32_16x16x32_bf16 v[96:99], a[112:115], v[28:31], v[96:99]
    ds_read_b128 v[24:27], v4 offset:43008
    v_mul_f32 v87, s9, v87
    v_mfma_f32_16x16x32_bf16 v[100:103], a[116:119], v[28:31], v[100:103]
    v_exp_f32 v85, v85
    v_mfma_f32_16x16x32_bf16 v[104:107], a[120:123], v[28:31], v[104:107]
    v_rcp_f32 v83, v83
    v_mfma_f32_16x16x32_bf16 v[108:111], a[124:127], v[28:31], v[108:111]
    v_add_f32 v85, 1.0, v85
    s_waitcnt lgkmcnt(2)
    v_mfma_f32_16x16x32_bf16 v[96:99], a[128:131], v[16:19], v[96:99]
    ds_read_b128 v[28:31], v4 offset:44032
    v_mul_f32 v83, v83, v91
    v_mfma_f32_16x16x32_bf16 v[100:103], a[132:135], v[16:19], v[100:103]
    v_exp_f32 v86, v86
    v_mfma_f32_16x16x32_bf16 v[104:107], a[136:139], v[16:19], v[104:107]
    v_rcp_f32 v84, v84
    v_mfma_f32_16x16x32_bf16 v[108:111], a[140:143], v[16:19], v[108:111]
    v_add_f32 v86, 1.0, v86
    s_waitcnt lgkmcnt(2)
    v_mfma_f32_16x16x32_bf16 v[96:99], a[144:147], v[20:23], v[96:99]
    ds_read_b128 v[16:19], v4 offset:45056
    v_mul_f32 v84, v84, v92
    v_mfma_f32_16x16x32_bf16 v[100:103], a[148:151], v[20:23], v[100:103]
    v_exp_f32 v87, v87
    v_mfma_f32_16x16x32_bf16 v[104:107], a[152:155], v[20:23], v[104:107]
    v_rcp_f32 v85, v85
    v_mfma_f32_16x16x32_bf16 v[108:111], a[156:159], v[20:23], v[108:111]
    v_add_f32 v87, 1.0, v87
    s_waitcnt lgkmcnt(2)
    v_mfma_f32_16x16x32_bf16 v[96:99], a[160:163], v[24:27], v[96:99]
    ds_read_b128 v[20:23], v4 offset:46080
    v_mul_f32 v85, v85, v93
    v_mfma_f32_16x16x32_bf16 v[100:103], a[164:167], v[24:27], v[100:103]
    v_rcp_f32 v86, v86
    v_mfma_f32_16x16x32_bf16 v[104:107], a[168:171], v[24:27], v[104:107]
    v_rcp_f32 v87, v87
    v_mfma_f32_16x16x32_bf16 v[108:111], a[172:175], v[24:27], v[108:111]
    v_mul_f32 v86, v86, v94
    s_waitcnt lgkmcnt(2)
    v_mfma_f32_16x16x32_bf16 v[96:99], a[176:179], v[28:31], v[96:99]
    ds_read_b128 v[24:27], v4 offset:47104
    v_mul_f32 v87, v87, v95
    v_mfma_f32_16x16x32_bf16 v[100:103], a[180:183], v[28:31], v[100:103]
    v_cvt_pk_bf16_f32 v88, v80, v81
    v_cvt_pk_bf16_f32 v89, v82, v83
    v_mfma_f32_16x16x32_bf16 v[104:107], a[184:187], v[28:31], v[104:107]
    v_cvt_pk_bf16_f32 v90, v84, v85
    v_cvt_pk_bf16_f32 v91, v86, v87
    v_mfma_f32_16x16x32_bf16 v[108:111], a[188:191], v[28:31], v[108:111]
    s_add_u32 s19, s14, 1032192
    s_waitcnt lgkmcnt(2)
    v_mfma_f32_16x16x32_bf16 v[96:99], a[192:195], v[16:19], v[96:99]
    ds_read_b128 v[28:31], v4 offset:48128
    v_mfma_f32_16x16x32_bf16 v[100:103], a[196:199], v[16:19], v[100:103]
    buffer_store_dwordx4 v[88:91], v1, s[28:31], s19 offen sc1
    v_mfma_f32_16x16x32_bf16 v[104:107], a[200:203], v[16:19], v[104:107]
    v_mfma_f32_16x16x32_bf16 v[108:111], a[204:207], v[16:19], v[108:111]
    s_waitcnt lgkmcnt(2)
    v_mfma_f32_16x16x32_bf16 v[96:99], a[208:211], v[20:23], v[96:99]
    ds_read_b128 v[16:19], v4 offset:49152
    v_mfma_f32_16x16x32_bf16 v[100:103], a[212:215], v[20:23], v[100:103]
    v_mfma_f32_16x16x32_bf16 v[104:107], a[216:219], v[20:23], v[104:107]
    v_mfma_f32_16x16x32_bf16 v[108:111], a[220:223], v[20:23], v[108:111]
    s_waitcnt lgkmcnt(2)
    v_mfma_f32_16x16x32_bf16 v[96:99], a[224:227], v[24:27], v[96:99]
    ds_read_b128 v[20:23], v4 offset:50176
    v_mfma_f32_16x16x32_bf16 v[100:103], a[228:231], v[24:27], v[100:103]
    v_mfma_f32_16x16x32_bf16 v[104:107], a[232:235], v[24:27], v[104:107]
    v_mfma_f32_16x16x32_bf16 v[108:111], a[236:239], v[24:27], v[108:111]
    s_waitcnt lgkmcnt(2)
    v_mfma_f32_16x16x32_bf16 v[96:99], a[240:243], v[28:31], v[96:99]
    ds_read_b128 v[24:27], v4 offset:51200
    v_mfma_f32_16x16x32_bf16 v[100:103], a[244:247], v[28:31], v[100:103]
    v_mfma_f32_16x16x32_bf16 v[104:107], a[248:251], v[28:31], v[104:107]
    v_mfma_f32_16x16x32_bf16 v[108:111], a[252:255], v[28:31], v[108:111]
    s_waitcnt lgkmcnt(2)
    v_mfma_f32_16x16x32_bf16 v[96:99], v[224:227], v[16:19], v[96:99]
    ds_read_b128 v[28:31], v4 offset:52224
    v_mfma_f32_16x16x32_bf16 v[100:103], v[228:231], v[16:19], v[100:103]
    v_mfma_f32_16x16x32_bf16 v[104:107], v[232:235], v[16:19], v[104:107]
    v_mfma_f32_16x16x32_bf16 v[108:111], v[236:239], v[16:19], v[108:111]
    s_waitcnt lgkmcnt(2)
    v_mfma_f32_16x16x32_bf16 v[96:99], v[240:243], v[20:23], v[96:99]
    ds_read_b128 v[16:19], v4 offset:53248
    v_mfma_f32_16x16x32_bf16 v[100:103], v[244:247], v[20:23], v[100:103]
    v_mfma_f32_16x16x32_bf16 v[104:107], v[248:251], v[20:23], v[104:107]
    v_mfma_f32_16x16x32_bf16 v[108:111], v[252:255], v[20:23], v[108:111]
    s_waitcnt lgkmcnt(2)
    v_mfma_f32_16x16x32_bf16 v[64:67], a[0:3], v[24:27], 0
    ds_read_b128 v[20:23], v4 offset:54272
    v_mfma_f32_16x16x32_bf16 v[68:71], a[4:7], v[24:27], 0
    v_mfma_f32_16x16x32_bf16 v[72:75], a[8:11], v[24:27], 0
    v_mfma_f32_16x16x32_bf16 v[76:79], a[12:15], v[24:27], 0
    v_mul_f32 v96, s9, v96
    s_waitcnt lgkmcnt(2)
    v_mfma_f32_16x16x32_bf16 v[64:67], a[16:19], v[28:31], v[64:67]
    ds_read_b128 v[24:27], v4 offset:55296
    v_mul_f32 v97, s9, v97
    v_mfma_f32_16x16x32_bf16 v[68:71], a[20:23], v[28:31], v[68:71]
    v_exp_f32 v96, v96
    v_mfma_f32_16x16x32_bf16 v[72:75], a[24:27], v[28:31], v[72:75]
    v_mul_f32 v98, s9, v98
    v_add_f32 v96, 1.0, v96
    v_mfma_f32_16x16x32_bf16 v[76:79], a[28:31], v[28:31], v[76:79]
    v_mul_f32 v99, s9, v99
    s_waitcnt lgkmcnt(2)
    v_mfma_f32_16x16x32_bf16 v[64:67], a[32:35], v[16:19], v[64:67]
    ds_read_b128 v[28:31], v4 offset:56320
    v_mul_f32 v100, s9, v100
    v_mfma_f32_16x16x32_bf16 v[68:71], a[36:39], v[16:19], v[68:71]
    v_exp_f32 v97, v97
    v_mfma_f32_16x16x32_bf16 v[72:75], a[40:43], v[16:19], v[72:75]
    v_exp_f32 v98, v98
    v_mfma_f32_16x16x32_bf16 v[76:79], a[44:47], v[16:19], v[76:79]
    v_add_f32 v97, 1.0, v97
    s_waitcnt lgkmcnt(2)
    v_mfma_f32_16x16x32_bf16 v[64:67], a[48:51], v[20:23], v[64:67]
    s_waitcnt vmcnt(18)
    s_barrier
    ds_read_b128 v[16:19], v4 offset:57344
    v_mfma_f32_16x16x32_bf16 v[68:71], a[52:55], v[20:23], v[68:71]
    v_rcp_f32 v96, v96
    v_mfma_f32_16x16x32_bf16 v[72:75], a[56:59], v[20:23], v[72:75]
    buffer_load_dword v52, v49, s[52:55], s13 offen offset:1792
    v_mfma_f32_16x16x32_bf16 v[76:79], a[60:63], v[20:23], v[76:79]
    v_add_f32 v98, 1.0, v98
    s_waitcnt lgkmcnt(2)
    v_mfma_f32_16x16x32_bf16 v[64:67], a[64:67], v[24:27], v[64:67]
    ds_read_b128 v[20:23], v4 offset:58368
    v_mul_f32 v96, v96, v104
    v_mfma_f32_16x16x32_bf16 v[68:71], a[68:71], v[24:27], v[68:71]
    v_exp_f32 v99, v99
    v_mfma_f32_16x16x32_bf16 v[72:75], a[72:75], v[24:27], v[72:75]
    s_add_u32 m0, s43, 49152
    s_add_u32 s17, s16, 245760
    buffer_load_dwordx4 v1, s[24:27], s17 offen offset:0 lds
    v_mfma_f32_16x16x32_bf16 v[76:79], a[76:79], v[24:27], v[76:79]
    v_mul_f32 v101, s9, v101
    s_waitcnt lgkmcnt(2)
    v_mfma_f32_16x16x32_bf16 v[64:67], a[80:83], v[28:31], v[64:67]
    ds_read_b128 v[24:27], v4 offset:59392
    v_add_f32 v99, 1.0, v99
    v_mfma_f32_16x16x32_bf16 v[68:71], a[84:87], v[28:31], v[68:71]
    v_rcp_f32 v97, v97
    v_mfma_f32_16x16x32_bf16 v[72:75], a[88:91], v[28:31], v[72:75]
    buffer_load_dwordx4 v1, s[24:27], s17 offen offset:1024 lds
    v_mfma_f32_16x16x32_bf16 v[76:79], a[92:95], v[28:31], v[76:79]
    v_mul_f32 v97, v97, v105
    s_waitcnt lgkmcnt(2)
    v_mfma_f32_16x16x32_bf16 v[64:67], a[96:99], v[16:19], v[64:67]
    ds_read_b128 v[28:31], v4 offset:60416
    v_mul_f32 v102, s9, v102
    v_mfma_f32_16x16x32_bf16 v[68:71], a[100:103], v[16:19], v[68:71]
    v_exp_f32 v100, v100
    v_mfma_f32_16x16x32_bf16 v[72:75], a[104:107], v[16:19], v[72:75]
    buffer_load_dwordx4 v1, s[24:27], s17 offen offset:2048 lds
    v_mfma_f32_16x16x32_bf16 v[76:79], a[108:111], v[16:19], v[76:79]
    v_add_f32 v100, 1.0, v100
    s_waitcnt lgkmcnt(2)
    v_mfma_f32_16x16x32_bf16 v[64:67], a[112:115], v[20:23], v[64:67]
    ds_read_b128 v[16:19], v4 offset:61440
    v_mul_f32 v103, s9, v103
    v_mfma_f32_16x16x32_bf16 v[68:71], a[116:119], v[20:23], v[68:71]
    v_rcp_f32 v98, v98
    v_mfma_f32_16x16x32_bf16 v[72:75], a[120:123], v[20:23], v[72:75]
    s_add_u32 m0, s43, 61440
    s_add_u32 s17, s16, 258048
    buffer_load_dwordx4 v1, s[24:27], s17 offen offset:0 lds
    v_mfma_f32_16x16x32_bf16 v[76:79], a[124:127], v[20:23], v[76:79]
    v_mul_f32 v98, v98, v106
    s_waitcnt lgkmcnt(2)
    v_mfma_f32_16x16x32_bf16 v[64:67], a[128:131], v[24:27], v[64:67]
    ds_read_b128 v[20:23], v4 offset:62464
    v_mfma_f32_16x16x32_bf16 v[68:71], a[132:135], v[24:27], v[68:71]
    v_exp_f32 v101, v101
    v_mfma_f32_16x16x32_bf16 v[72:75], a[136:139], v[24:27], v[72:75]
    buffer_load_dwordx4 v1, s[24:27], s17 offen offset:1024 lds
    v_mfma_f32_16x16x32_bf16 v[76:79], a[140:143], v[24:27], v[76:79]
    v_add_f32 v101, 1.0, v101
    s_waitcnt lgkmcnt(2)
    v_mfma_f32_16x16x32_bf16 v[64:67], a[144:147], v[28:31], v[64:67]
    ds_read_b128 v[24:27], v4 offset:63488
    v_mfma_f32_16x16x32_bf16 v[68:71], a[148:151], v[28:31], v[68:71]
    v_rcp_f32 v99, v99
    v_mfma_f32_16x16x32_bf16 v[72:75], a[152:155], v[28:31], v[72:75]
    buffer_load_dwordx4 v1, s[24:27], s17 offen offset:2048 lds
    v_mfma_f32_16x16x32_bf16 v[76:79], a[156:159], v[28:31], v[76:79]
    v_mul_f32 v99, v99, v107
    s_waitcnt lgkmcnt(2)
    v_mfma_f32_16x16x32_bf16 v[64:67], a[160:163], v[16:19], v[64:67]
    ds_read_b128 v[28:31], v4 offset:64512
    v_mfma_f32_16x16x32_bf16 v[68:71], a[164:167], v[16:19], v[68:71]
    v_exp_f32 v102, v102
    v_mfma_f32_16x16x32_bf16 v[72:75], a[168:171], v[16:19], v[72:75]
    s_add_u32 m0, s43, 73728
    s_add_u32 s17, s16, 270336
    buffer_load_dwordx4 v1, s[24:27], s17 offen offset:0 lds
    v_mfma_f32_16x16x32_bf16 v[76:79], a[172:175], v[16:19], v[76:79]
    v_add_f32 v102, 1.0, v102
    s_waitcnt lgkmcnt(2)
    v_mfma_f32_16x16x32_bf16 v[64:67], a[176:179], v[20:23], v[64:67]
    ds_read_b128 v[16:19], v5 offset:0
    v_cvt_pk_bf16_f32 v104, v96, v97
    v_mfma_f32_16x16x32_bf16 v[68:71], a[180:183], v[20:23], v[68:71]
    v_rcp_f32 v100, v100
    v_mfma_f32_16x16x32_bf16 v[72:75], a[184:187], v[20:23], v[72:75]
    buffer_load_dwordx4 v1, s[24:27], s17 offen offset:1024 lds
    v_mfma_f32_16x16x32_bf16 v[76:79], a[188:191], v[20:23], v[76:79]
    v_mul_f32 v100, v100, v108
    s_waitcnt lgkmcnt(2)
    v_mfma_f32_16x16x32_bf16 v[64:67], a[192:195], v[24:27], v[64:67]
    ds_read_b128 v[20:23], v5 offset:1024
    v_cvt_pk_bf16_f32 v105, v98, v99
    v_mfma_f32_16x16x32_bf16 v[68:71], a[196:199], v[24:27], v[68:71]
    v_exp_f32 v103, v103
    v_mfma_f32_16x16x32_bf16 v[72:75], a[200:203], v[24:27], v[72:75]
    buffer_load_dwordx4 v1, s[24:27], s17 offen offset:2048 lds
    v_mfma_f32_16x16x32_bf16 v[76:79], a[204:207], v[24:27], v[76:79]
    v_add_f32 v103, 1.0, v103
    s_waitcnt lgkmcnt(2)
    v_mfma_f32_16x16x32_bf16 v[64:67], a[208:211], v[28:31], v[64:67]
    ds_read_b128 v[24:27], v5 offset:2048
    s_add_u32 s19, s14, 1179648
    v_mfma_f32_16x16x32_bf16 v[68:71], a[212:215], v[28:31], v[68:71]
    v_rcp_f32 v101, v101
    v_mfma_f32_16x16x32_bf16 v[72:75], a[216:219], v[28:31], v[72:75]
    v_rcp_f32 v102, v102
    v_mfma_f32_16x16x32_bf16 v[76:79], a[220:223], v[28:31], v[76:79]
    v_mul_f32 v101, v101, v109
    s_waitcnt lgkmcnt(2)
    v_mfma_f32_16x16x32_bf16 v[64:67], a[224:227], v[16:19], v[64:67]
    ds_read_b128 v[28:31], v5 offset:3072
    v_mul_f32 v102, v102, v110
    v_mfma_f32_16x16x32_bf16 v[68:71], a[228:231], v[16:19], v[68:71]
    v_rcp_f32 v103, v103
    v_mfma_f32_16x16x32_bf16 v[72:75], a[232:235], v[16:19], v[72:75]
    v_mul_f32 v103, v103, v111
    v_cvt_pk_bf16_f32 v106, v100, v101
    v_mfma_f32_16x16x32_bf16 v[76:79], a[236:239], v[16:19], v[76:79]
    v_cvt_pk_bf16_f32 v107, v102, v103
    s_waitcnt lgkmcnt(2)
    v_mfma_f32_16x16x32_bf16 v[64:67], a[240:243], v[20:23], v[64:67]
    ds_read_b128 v[16:19], v5 offset:4096
    v_mfma_f32_16x16x32_bf16 v[68:71], a[244:247], v[20:23], v[68:71]
    buffer_store_dwordx4 v[104:107], v1, s[28:31], s19 offen sc1
    v_mfma_f32_16x16x32_bf16 v[72:75], a[248:251], v[20:23], v[72:75]
    v_mfma_f32_16x16x32_bf16 v[76:79], a[252:255], v[20:23], v[76:79]
    s_waitcnt lgkmcnt(2)
    v_mfma_f32_16x16x32_bf16 v[64:67], v[224:227], v[24:27], v[64:67]
    ds_read_b128 v[20:23], v5 offset:5120
    v_mfma_f32_16x16x32_bf16 v[68:71], v[228:231], v[24:27], v[68:71]
    v_mfma_f32_16x16x32_bf16 v[72:75], v[232:235], v[24:27], v[72:75]
    v_mfma_f32_16x16x32_bf16 v[76:79], v[236:239], v[24:27], v[76:79]
    s_waitcnt lgkmcnt(2)
    v_mfma_f32_16x16x32_bf16 v[64:67], v[240:243], v[28:31], v[64:67]
    ds_read_b128 v[24:27], v5 offset:6144
    v_mfma_f32_16x16x32_bf16 v[68:71], v[244:247], v[28:31], v[68:71]
    v_mfma_f32_16x16x32_bf16 v[72:75], v[248:251], v[28:31], v[72:75]
    v_mfma_f32_16x16x32_bf16 v[76:79], v[252:255], v[28:31], v[76:79]
    s_waitcnt lgkmcnt(2)
    v_mfma_f32_16x16x32_bf16 v[80:83], a[0:3], v[16:19], 0
    ds_read_b128 v[28:31], v5 offset:7168
    v_mfma_f32_16x16x32_bf16 v[84:87], a[4:7], v[16:19], 0
    v_mfma_f32_16x16x32_bf16 v[88:91], a[8:11], v[16:19], 0
    v_mfma_f32_16x16x32_bf16 v[92:95], a[12:15], v[16:19], 0
    v_mul_f32 v64, s9, v64
    s_waitcnt lgkmcnt(2)
    v_mfma_f32_16x16x32_bf16 v[80:83], a[16:19], v[20:23], v[80:83]
    ds_read_b128 v[16:19], v5 offset:8192
    v_mul_f32 v65, s9, v65
    v_mfma_f32_16x16x32_bf16 v[84:87], a[20:23], v[20:23], v[84:87]
    v_exp_f32 v64, v64
    v_mfma_f32_16x16x32_bf16 v[88:91], a[24:27], v[20:23], v[88:91]
    v_mul_f32 v66, s9, v66
    v_add_f32 v64, 1.0, v64
    v_mfma_f32_16x16x32_bf16 v[92:95], a[28:31], v[20:23], v[92:95]
    v_mul_f32 v67, s9, v67
    s_waitcnt lgkmcnt(2)
    v_mfma_f32_16x16x32_bf16 v[80:83], a[32:35], v[24:27], v[80:83]
    ds_read_b128 v[20:23], v5 offset:9216
    v_mul_f32 v68, s9, v68
    v_mfma_f32_16x16x32_bf16 v[84:87], a[36:39], v[24:27], v[84:87]
    v_exp_f32 v65, v65
    v_mfma_f32_16x16x32_bf16 v[88:91], a[40:43], v[24:27], v[88:91]
    v_exp_f32 v66, v66
    v_mfma_f32_16x16x32_bf16 v[92:95], a[44:47], v[24:27], v[92:95]
    v_add_f32 v65, 1.0, v65
    s_waitcnt lgkmcnt(2)
    v_mfma_f32_16x16x32_bf16 v[80:83], a[48:51], v[28:31], v[80:83]
    ds_read_b128 v[24:27], v5 offset:10240
    v_add_f32 v66, 1.0, v66
    v_mfma_f32_16x16x32_bf16 v[84:87], a[52:55], v[28:31], v[84:87]
    v_rcp_f32 v64, v64
    v_mfma_f32_16x16x32_bf16 v[88:91], a[56:59], v[28:31], v[88:91]
    v_exp_f32 v67, v67
    v_mfma_f32_16x16x32_bf16 v[92:95], a[60:63], v[28:31], v[92:95]
    v_mul_f32 v64, v64, v72
    s_waitcnt lgkmcnt(2)
    v_mfma_f32_16x16x32_bf16 v[80:83], a[64:67], v[16:19], v[80:83]
    ds_read_b128 v[28:31], v5 offset:11264
    v_mul_f32 v69, s9, v69
    v_mfma_f32_16x16x32_bf16 v[84:87], a[68:71], v[16:19], v[84:87]
    v_rcp_f32 v65, v65
    v_mfma_f32_16x16x32_bf16 v[88:91], a[72:75], v[16:19], v[88:91]
    v_exp_f32 v68, v68
    v_mfma_f32_16x16x32_bf16 v[92:95], a[76:79], v[16:19], v[92:95]
    v_add_f32 v67, 1.0, v67
    s_waitcnt lgkmcnt(2)
    v_mfma_f32_16x16x32_bf16 v[80:83], a[80:83], v[20:23], v[80:83]
    ds_read_b128 v[16:19], v5 offset:12288
    v_mul_f32 v65, v65, v73
    v_mfma_f32_16x16x32_bf16 v[84:87], a[84:87], v[20:23], v[84:87]
    v_rcp_f32 v66, v66
    v_mfma_f32_16x16x32_bf16 v[88:91], a[88:91], v[20:23], v[88:91]
    v_mul_f32 v70, s9, v70
    v_add_f32 v68, 1.0, v68
    v_mfma_f32_16x16x32_bf16 v[92:95], a[92:95], v[20:23], v[92:95]
    v_mul_f32 v66, v66, v74
    s_waitcnt lgkmcnt(2)
    v_mfma_f32_16x16x32_bf16 v[80:83], a[96:99], v[24:27], v[80:83]
    ds_read_b128 v[20:23], v5 offset:13312
    v_mul_f32 v71, s9, v71
    v_mfma_f32_16x16x32_bf16 v[84:87], a[100:103], v[24:27], v[84:87]
    v_exp_f32 v69, v69
    v_mfma_f32_16x16x32_bf16 v[88:91], a[104:107], v[24:27], v[88:91]
    v_rcp_f32 v67, v67
    v_mfma_f32_16x16x32_bf16 v[92:95], a[108:111], v[24:27], v[92:95]
    v_add_f32 v69, 1.0, v69
    s_waitcnt lgkmcnt(2)
    v_mfma_f32_16x16x32_bf16 v[80:83], a[112:115], v[28:31], v[80:83]
    ds_read_b128 v[24:27], v5 offset:14336
    v_mul_f32 v67, v67, v75
    v_mfma_f32_16x16x32_bf16 v[84:87], a[116:119], v[28:31], v[84:87]
    v_exp_f32 v70, v70
    v_mfma_f32_16x16x32_bf16 v[88:91], a[120:123], v[28:31], v[88:91]
    v_rcp_f32 v68, v68
    v_mfma_f32_16x16x32_bf16 v[92:95], a[124:127], v[28:31], v[92:95]
    v_add_f32 v70, 1.0, v70
    s_waitcnt lgkmcnt(2)
    v_mfma_f32_16x16x32_bf16 v[80:83], a[128:131], v[16:19], v[80:83]
    ds_read_b128 v[28:31], v5 offset:15360
    v_mul_f32 v68, v68, v76
    v_mfma_f32_16x16x32_bf16 v[84:87], a[132:135], v[16:19], v[84:87]
    v_exp_f32 v71, v71
    v_mfma_f32_16x16x32_bf16 v[88:91], a[136:139], v[16:19], v[88:91]
    v_rcp_f32 v69, v69
    v_mfma_f32_16x16x32_bf16 v[92:95], a[140:143], v[16:19], v[92:95]
    v_add_f32 v71, 1.0, v71
    s_waitcnt lgkmcnt(2)
    v_mfma_f32_16x16x32_bf16 v[80:83], a[144:147], v[20:23], v[80:83]
    s_waitcnt vmcnt(20)
    s_barrier
    ds_read_b128 v[16:19], v3 offset:0
    v_mfma_f32_16x16x32_bf16 v[84:87], a[148:151], v[20:23], v[84:87]
    v_rcp_f32 v70, v70
    v_mfma_f32_16x16x32_bf16 v[88:91], a[152:155], v[20:23], v[88:91]
    buffer_load_dword v52, v49, s[52:55], s13 offen offset:3584
    v_mfma_f32_16x16x32_bf16 v[92:95], a[156:159], v[20:23], v[92:95]
    v_mul_f32 v69, v69, v77
    s_waitcnt lgkmcnt(2)
    v_mfma_f32_16x16x32_bf16 v[80:83], a[160:163], v[24:27], v[80:83]
    ds_read_b128 v[20:23], v3 offset:1024
    v_mul_f32 v70, v70, v78
    v_mfma_f32_16x16x32_bf16 v[84:87], a[164:167], v[24:27], v[84:87]
    v_rcp_f32 v71, v71
    v_mfma_f32_16x16x32_bf16 v[88:91], a[168:171], v[24:27], v[88:91]
    s_add_u32 m0, s43, 86016
    s_add_u32 s17, s16, 282624
    buffer_load_dwordx4 v1, s[24:27], s17 offen offset:0 lds
    v_mfma_f32_16x16x32_bf16 v[92:95], a[172:175], v[24:27], v[92:95]
    v_mul_f32 v71, v71, v79
    s_waitcnt lgkmcnt(2)
    v_mfma_f32_16x16x32_bf16 v[80:83], a[176:179], v[28:31], v[80:83]
    ds_read_b128 v[24:27], v3 offset:2048
    v_cvt_pk_bf16_f32 v72, v64, v65
    v_mfma_f32_16x16x32_bf16 v[84:87], a[180:183], v[28:31], v[84:87]
    v_cvt_pk_bf16_f32 v73, v66, v67
    v_cvt_pk_bf16_f32 v74, v68, v69
    v_mfma_f32_16x16x32_bf16 v[88:91], a[184:187], v[28:31], v[88:91]
    buffer_load_dwordx4 v1, s[24:27], s17 offen offset:1024 lds
    v_mfma_f32_16x16x32_bf16 v[92:95], a[188:191], v[28:31], v[92:95]
    v_cvt_pk_bf16_f32 v75, v70, v71
    s_waitcnt lgkmcnt(2)
    v_mfma_f32_16x16x32_bf16 v[80:83], a[192:195], v[16:19], v[80:83]
    ds_read_b128 v[28:31], v3 offset:3072
    s_add_u32 s19, s14, 1327104
    v_mfma_f32_16x16x32_bf16 v[84:87], a[196:199], v[16:19], v[84:87]
    buffer_store_dwordx4 v[72:75], v1, s[28:31], s19 offen sc1
    v_mfma_f32_16x16x32_bf16 v[88:91], a[200:203], v[16:19], v[88:91]
    buffer_load_dwordx4 v1, s[24:27], s17 offen offset:2048 lds
    v_mfma_f32_16x16x32_bf16 v[92:95], a[204:207], v[16:19], v[92:95]
    s_waitcnt lgkmcnt(2)
    v_mfma_f32_16x16x32_bf16 v[80:83], a[208:211], v[20:23], v[80:83]
    ds_read_b128 v[16:19], v3 offset:4096
    v_mfma_f32_16x16x32_bf16 v[84:87], a[212:215], v[20:23], v[84:87]
    v_mfma_f32_16x16x32_bf16 v[88:91], a[216:219], v[20:23], v[88:91]
    s_add_u32 m0, s43, 98304
    s_add_u32 s17, s16, 294912
    buffer_load_dwordx4 v1, s[24:27], s17 offen offset:0 lds
    v_mfma_f32_16x16x32_bf16 v[92:95], a[220:223], v[20:23], v[92:95]
    s_waitcnt lgkmcnt(2)
    v_mfma_f32_16x16x32_bf16 v[80:83], a[224:227], v[24:27], v[80:83]
    ds_read_b128 v[20:23], v3 offset:5120
    v_mfma_f32_16x16x32_bf16 v[84:87], a[228:231], v[24:27], v[84:87]
    v_mfma_f32_16x16x32_bf16 v[88:91], a[232:235], v[24:27], v[88:91]
    buffer_load_dwordx4 v1, s[24:27], s17 offen offset:1024 lds
    v_mfma_f32_16x16x32_bf16 v[92:95], a[236:239], v[24:27], v[92:95]
    s_waitcnt lgkmcnt(2)
    v_mfma_f32_16x16x32_bf16 v[80:83], a[240:243], v[28:31], v[80:83]
    ds_read_b128 v[24:27], v3 offset:6144
    v_mfma_f32_16x16x32_bf16 v[84:87], a[244:247], v[28:31], v[84:87]
    v_mfma_f32_16x16x32_bf16 v[88:91], a[248:251], v[28:31], v[88:91]
    buffer_load_dwordx4 v1, s[24:27], s17 offen offset:2048 lds
    v_mfma_f32_16x16x32_bf16 v[92:95], a[252:255], v[28:31], v[92:95]
    s_waitcnt lgkmcnt(2)
    v_mfma_f32_16x16x32_bf16 v[80:83], v[224:227], v[16:19], v[80:83]
    ds_read_b128 v[28:31], v3 offset:7168
    v_mfma_f32_16x16x32_bf16 v[84:87], v[228:231], v[16:19], v[84:87]
    v_mfma_f32_16x16x32_bf16 v[88:91], v[232:235], v[16:19], v[88:91]
    v_mfma_f32_16x16x32_bf16 v[92:95], v[236:239], v[16:19], v[92:95]
    s_waitcnt lgkmcnt(2)
    v_mfma_f32_16x16x32_bf16 v[80:83], v[240:243], v[20:23], v[80:83]
    ds_read_b128 v[16:19], v3 offset:8192
    v_mfma_f32_16x16x32_bf16 v[84:87], v[244:247], v[20:23], v[84:87]
    v_mfma_f32_16x16x32_bf16 v[88:91], v[248:251], v[20:23], v[88:91]
    v_mfma_f32_16x16x32_bf16 v[92:95], v[252:255], v[20:23], v[92:95]
    s_waitcnt lgkmcnt(2)
    v_mfma_f32_16x16x32_bf16 v[96:99], a[0:3], v[24:27], 0
    ds_read_b128 v[20:23], v3 offset:9216
    v_mfma_f32_16x16x32_bf16 v[100:103], a[4:7], v[24:27], 0
    v_mfma_f32_16x16x32_bf16 v[104:107], a[8:11], v[24:27], 0
    v_mfma_f32_16x16x32_bf16 v[108:111], a[12:15], v[24:27], 0
    v_mul_f32 v80, s9, v80
    s_waitcnt lgkmcnt(2)
    v_mfma_f32_16x16x32_bf16 v[96:99], a[16:19], v[28:31], v[96:99]
    ds_read_b128 v[24:27], v3 offset:10240
    v_mul_f32 v81, s9, v81
    v_mfma_f32_16x16x32_bf16 v[100:103], a[20:23], v[28:31], v[100:103]
    v_exp_f32 v80, v80
    v_mfma_f32_16x16x32_bf16 v[104:107], a[24:27], v[28:31], v[104:107]
    v_mul_f32 v82, s9, v82
    v_add_f32 v80, 1.0, v80
    v_mfma_f32_16x16x32_bf16 v[108:111], a[28:31], v[28:31], v[108:111]
    v_mul_f32 v83, s9, v83
    s_waitcnt lgkmcnt(2)
    v_mfma_f32_16x16x32_bf16 v[96:99], a[32:35], v[16:19], v[96:99]
    ds_read_b128 v[28:31], v3 offset:11264
    v_mul_f32 v84, s9, v84
    v_mfma_f32_16x16x32_bf16 v[100:103], a[36:39], v[16:19], v[100:103]
    v_exp_f32 v81, v81
    v_mfma_f32_16x16x32_bf16 v[104:107], a[40:43], v[16:19], v[104:107]
    v_exp_f32 v82, v82
    v_mfma_f32_16x16x32_bf16 v[108:111], a[44:47], v[16:19], v[108:111]
    v_add_f32 v81, 1.0, v81
    s_waitcnt lgkmcnt(2)
    v_mfma_f32_16x16x32_bf16 v[96:99], a[48:51], v[20:23], v[96:99]
    ds_read_b128 v[16:19], v3 offset:12288
    v_add_f32 v82, 1.0, v82
    v_mfma_f32_16x16x32_bf16 v[100:103], a[52:55], v[20:23], v[100:103]
    v_rcp_f32 v80, v80
    v_mfma_f32_16x16x32_bf16 v[104:107], a[56:59], v[20:23], v[104:107]
    v_exp_f32 v83, v83
    v_mfma_f32_16x16x32_bf16 v[108:111], a[60:63], v[20:23], v[108:111]
    v_mul_f32 v80, v80, v88
    s_waitcnt lgkmcnt(2)
    v_mfma_f32_16x16x32_bf16 v[96:99], a[64:67], v[24:27], v[96:99]
    ds_read_b128 v[20:23], v3 offset:13312
    v_mul_f32 v85, s9, v85
    v_mfma_f32_16x16x32_bf16 v[100:103], a[68:71], v[24:27], v[100:103]
    v_rcp_f32 v81, v81
    v_mfma_f32_16x16x32_bf16 v[104:107], a[72:75], v[24:27], v[104:107]
    v_exp_f32 v84, v84
    v_mfma_f32_16x16x32_bf16 v[108:111], a[76:79], v[24:27], v[108:111]
    v_add_f32 v83, 1.0, v83
    s_waitcnt lgkmcnt(2)
    v_mfma_f32_16x16x32_bf16 v[96:99], a[80:83], v[28:31], v[96:99]
    ds_read_b128 v[24:27], v3 offset:14336
    v_mul_f32 v81, v81, v89
    v_mfma_f32_16x16x32_bf16 v[100:103], a[84:87], v[28:31], v[100:103]
    v_rcp_f32 v82, v82
    v_mfma_f32_16x16x32_bf16 v[104:107], a[88:91], v[28:31], v[104:107]
    v_mul_f32 v86, s9, v86
    v_add_f32 v84, 1.0, v84
    v_mfma_f32_16x16x32_bf16 v[108:111], a[92:95], v[28:31], v[108:111]
    v_mul_f32 v82, v82, v90
    s_waitcnt lgkmcnt(2)
    v_mfma_f32_16x16x32_bf16 v[96:99], a[96:99], v[16:19], v[96:99]
    ds_read_b128 v[28:31], v3 offset:15360
    v_mul_f32 v87, s9, v87
    v_mfma_f32_16x16x32_bf16 v[100:103], a[100:103], v[16:19], v[100:103]
    v_exp_f32 v85, v85
    v_mfma_f32_16x16x32_bf16 v[104:107], a[104:107], v[16:19], v[104:107]
    v_rcp_f32 v83, v83
    v_mfma_f32_16x16x32_bf16 v[108:111], a[108:111], v[16:19], v[108:111]
    v_add_f32 v85, 1.0, v85
    s_waitcnt lgkmcnt(2)
    v_mfma_f32_16x16x32_bf16 v[96:99], a[112:115], v[20:23], v[96:99]
    ds_read_b128 v[16:19], v3 offset:16384
    v_mul_f32 v83, v83, v91
    v_mfma_f32_16x16x32_bf16 v[100:103], a[116:119], v[20:23], v[100:103]
    v_exp_f32 v86, v86
    v_mfma_f32_16x16x32_bf16 v[104:107], a[120:123], v[20:23], v[104:107]
    v_rcp_f32 v84, v84
    v_mfma_f32_16x16x32_bf16 v[108:111], a[124:127], v[20:23], v[108:111]
    v_add_f32 v86, 1.0, v86
    s_waitcnt lgkmcnt(2)
    v_mfma_f32_16x16x32_bf16 v[96:99], a[128:131], v[24:27], v[96:99]
    ds_read_b128 v[20:23], v3 offset:17408
    v_mul_f32 v84, v84, v92
    v_mfma_f32_16x16x32_bf16 v[100:103], a[132:135], v[24:27], v[100:103]
    v_exp_f32 v87, v87
    v_mfma_f32_16x16x32_bf16 v[104:107], a[136:139], v[24:27], v[104:107]
    v_rcp_f32 v85, v85
    v_mfma_f32_16x16x32_bf16 v[108:111], a[140:143], v[24:27], v[108:111]
    v_add_f32 v87, 1.0, v87
    s_waitcnt lgkmcnt(2)
    v_mfma_f32_16x16x32_bf16 v[96:99], a[144:147], v[28:31], v[96:99]
    ds_read_b128 v[24:27], v3 offset:18432
    v_mul_f32 v85, v85, v93
    v_mfma_f32_16x16x32_bf16 v[100:103], a[148:151], v[28:31], v[100:103]
    v_rcp_f32 v86, v86
    v_mfma_f32_16x16x32_bf16 v[104:107], a[152:155], v[28:31], v[104:107]
    v_rcp_f32 v87, v87
    v_mfma_f32_16x16x32_bf16 v[108:111], a[156:159], v[28:31], v[108:111]
    v_mul_f32 v86, v86, v94
    s_waitcnt lgkmcnt(2)
    v_mfma_f32_16x16x32_bf16 v[96:99], a[160:163], v[16:19], v[96:99]
    ds_read_b128 v[28:31], v3 offset:19456
    v_mul_f32 v87, v87, v95
    v_mfma_f32_16x16x32_bf16 v[100:103], a[164:167], v[16:19], v[100:103]
    v_cvt_pk_bf16_f32 v88, v80, v81
    v_cvt_pk_bf16_f32 v89, v82, v83
    v_mfma_f32_16x16x32_bf16 v[104:107], a[168:171], v[16:19], v[104:107]
    v_cvt_pk_bf16_f32 v90, v84, v85
    v_cvt_pk_bf16_f32 v91, v86, v87
    v_mfma_f32_16x16x32_bf16 v[108:111], a[172:175], v[16:19], v[108:111]
    s_add_u32 s19, s14, 1474560
    s_waitcnt lgkmcnt(2)
    v_mfma_f32_16x16x32_bf16 v[96:99], a[176:179], v[20:23], v[96:99]
    ds_read_b128 v[16:19], v3 offset:20480
    v_mfma_f32_16x16x32_bf16 v[100:103], a[180:183], v[20:23], v[100:103]
    buffer_store_dwordx4 v[88:91], v1, s[28:31], s19 offen sc1
    v_mfma_f32_16x16x32_bf16 v[104:107], a[184:187], v[20:23], v[104:107]
    v_mfma_f32_16x16x32_bf16 v[108:111], a[188:191], v[20:23], v[108:111]
    s_waitcnt lgkmcnt(2)
    v_mfma_f32_16x16x32_bf16 v[96:99], a[192:195], v[24:27], v[96:99]
    ds_read_b128 v[20:23], v3 offset:21504
    v_mfma_f32_16x16x32_bf16 v[100:103], a[196:199], v[24:27], v[100:103]
    v_mfma_f32_16x16x32_bf16 v[104:107], a[200:203], v[24:27], v[104:107]
    v_mfma_f32_16x16x32_bf16 v[108:111], a[204:207], v[24:27], v[108:111]
    s_waitcnt lgkmcnt(2)
    v_mfma_f32_16x16x32_bf16 v[96:99], a[208:211], v[28:31], v[96:99]
    ds_read_b128 v[24:27], v3 offset:22528
    v_mfma_f32_16x16x32_bf16 v[100:103], a[212:215], v[28:31], v[100:103]
    v_mfma_f32_16x16x32_bf16 v[104:107], a[216:219], v[28:31], v[104:107]
    v_mfma_f32_16x16x32_bf16 v[108:111], a[220:223], v[28:31], v[108:111]
    s_waitcnt lgkmcnt(2)
    v_mfma_f32_16x16x32_bf16 v[96:99], a[224:227], v[16:19], v[96:99]
    ds_read_b128 v[28:31], v3 offset:23552
    v_mfma_f32_16x16x32_bf16 v[100:103], a[228:231], v[16:19], v[100:103]
    v_mfma_f32_16x16x32_bf16 v[104:107], a[232:235], v[16:19], v[104:107]
    v_mfma_f32_16x16x32_bf16 v[108:111], a[236:239], v[16:19], v[108:111]
    s_waitcnt lgkmcnt(2)
    v_mfma_f32_16x16x32_bf16 v[96:99], a[240:243], v[20:23], v[96:99]
    s_waitcnt vmcnt(21)
    s_barrier
    ds_read_b128 v[16:19], v3 offset:24576
    v_mfma_f32_16x16x32_bf16 v[100:103], a[244:247], v[20:23], v[100:103]
    v_mfma_f32_16x16x32_bf16 v[104:107], a[248:251], v[20:23], v[104:107]
    s_add_u32 m0, s43, 110592
    s_add_u32 s17, s16, 307200
    buffer_load_dwordx4 v1, s[24:27], s17 offen offset:0 lds
    v_mfma_f32_16x16x32_bf16 v[108:111], a[252:255], v[20:23], v[108:111]
    s_waitcnt lgkmcnt(2)
    v_mfma_f32_16x16x32_bf16 v[96:99], v[224:227], v[24:27], v[96:99]
    ds_read_b128 v[20:23], v3 offset:25600
    v_mfma_f32_16x16x32_bf16 v[100:103], v[228:231], v[24:27], v[100:103]
    v_mfma_f32_16x16x32_bf16 v[104:107], v[232:235], v[24:27], v[104:107]
    buffer_load_dwordx4 v1, s[24:27], s17 offen offset:1024 lds
    v_mfma_f32_16x16x32_bf16 v[108:111], v[236:239], v[24:27], v[108:111]
    s_waitcnt lgkmcnt(2)
    v_mfma_f32_16x16x32_bf16 v[96:99], v[240:243], v[28:31], v[96:99]
    ds_read_b128 v[24:27], v3 offset:26624
    v_mfma_f32_16x16x32_bf16 v[100:103], v[244:247], v[28:31], v[100:103]
    v_mfma_f32_16x16x32_bf16 v[104:107], v[248:251], v[28:31], v[104:107]
    buffer_load_dwordx4 v1, s[24:27], s17 offen offset:2048 lds
    v_mfma_f32_16x16x32_bf16 v[108:111], v[252:255], v[28:31], v[108:111]
    s_waitcnt lgkmcnt(2)
    v_mfma_f32_16x16x32_bf16 v[64:67], a[0:3], v[16:19], 0
    ds_read_b128 v[28:31], v3 offset:27648
    v_mfma_f32_16x16x32_bf16 v[68:71], a[4:7], v[16:19], 0
    v_mfma_f32_16x16x32_bf16 v[72:75], a[8:11], v[16:19], 0
    s_add_u32 m0, s43, 122880
    s_add_u32 s17, s16, 319488
    buffer_load_dwordx4 v1, s[24:27], s17 offen offset:0 lds
    v_mfma_f32_16x16x32_bf16 v[76:79], a[12:15], v[16:19], 0
    v_mul_f32 v96, s9, v96
    s_waitcnt lgkmcnt(2)
    v_mfma_f32_16x16x32_bf16 v[64:67], a[16:19], v[20:23], v[64:67]
    ds_read_b128 v[16:19], v3 offset:28672
    v_mul_f32 v97, s9, v97
    v_mfma_f32_16x16x32_bf16 v[68:71], a[20:23], v[20:23], v[68:71]
    v_exp_f32 v96, v96
    v_mfma_f32_16x16x32_bf16 v[72:75], a[24:27], v[20:23], v[72:75]
    buffer_load_dwordx4 v1, s[24:27], s17 offen offset:1024 lds
    v_mfma_f32_16x16x32_bf16 v[76:79], a[28:31], v[20:23], v[76:79]
    v_mul_f32 v98, s9, v98
    s_waitcnt lgkmcnt(2)
    v_mfma_f32_16x16x32_bf16 v[64:67], a[32:35], v[24:27], v[64:67]
    ds_read_b128 v[20:23], v3 offset:29696
    v_add_f32 v96, 1.0, v96
    v_mfma_f32_16x16x32_bf16 v[68:71], a[36:39], v[24:27], v[68:71]
    v_exp_f32 v97, v97
    v_mfma_f32_16x16x32_bf16 v[72:75], a[40:43], v[24:27], v[72:75]
    buffer_load_dwordx4 v1, s[24:27], s17 offen offset:2048 lds
    v_mfma_f32_16x16x32_bf16 v[76:79], a[44:47], v[24:27], v[76:79]
    v_mul_f32 v99, s9, v99
    s_waitcnt lgkmcnt(2)
    v_mfma_f32_16x16x32_bf16 v[64:67], a[48:51], v[28:31], v[64:67]
    ds_read_b128 v[24:27], v3 offset:30720
    v_add_f32 v97, 1.0, v97
    v_mfma_f32_16x16x32_bf16 v[68:71], a[52:55], v[28:31], v[68:71]
    v_exp_f32 v98, v98
    v_mfma_f32_16x16x32_bf16 v[72:75], a[56:59], v[28:31], v[72:75]
    v_rcp_f32 v96, v96
    v_mfma_f32_16x16x32_bf16 v[76:79], a[60:63], v[28:31], v[76:79]
    v_mul_f32 v100, s9, v100
    s_waitcnt lgkmcnt(2)
    v_mfma_f32_16x16x32_bf16 v[64:67], a[64:67], v[16:19], v[64:67]
    ds_read_b128 v[28:31], v3 offset:31744
    v_add_f32 v98, 1.0, v98
    v_mfma_f32_16x16x32_bf16 v[68:71], a[68:71], v[16:19], v[68:71]
    v_exp_f32 v99, v99
    v_mfma_f32_16x16x32_bf16 v[72:75], a[72:75], v[16:19], v[72:75]
    v_rcp_f32 v97, v97
    v_mfma_f32_16x16x32_bf16 v[76:79], a[76:79], v[16:19], v[76:79]
    v_mul_f32 v96, v96, v104
    s_waitcnt lgkmcnt(2)
    v_mfma_f32_16x16x32_bf16 v[64:67], a[80:83], v[20:23], v[64:67]
    ds_read_b128 v[16:19], v3 offset:32768
    v_mul_f32 v101, s9, v101
    v_mfma_f32_16x16x32_bf16 v[68:71], a[84:87], v[20:23], v[68:71]
    v_exp_f32 v100, v100
    v_mfma_f32_16x16x32_bf16 v[72:75], a[88:91], v[20:23], v[72:75]
    v_add_f32 v99, 1.0, v99
    v_mul_f32 v97, v97, v105
    v_mfma_f32_16x16x32_bf16 v[76:79], a[92:95], v[20:23], v[76:79]
    v_mul_f32 v102, s9, v102
    s_waitcnt lgkmcnt(2)
    v_mfma_f32_16x16x32_bf16 v[64:67], a[96:99], v[24:27], v[64:67]
    ds_read_b128 v[20:23], v3 offset:33792
    v_add_f32 v100, 1.0, v100
    v_mfma_f32_16x16x32_bf16 v[68:71], a[100:103], v[24:27], v[68:71]
    v_rcp_f32 v98, v98
    v_mfma_f32_16x16x32_bf16 v[72:75], a[104:107], v[24:27], v[72:75]
    v_exp_f32 v101, v101
    v_mfma_f32_16x16x32_bf16 v[76:79], a[108:111], v[24:27], v[76:79]
    v_mul_f32 v98, v98, v106
    s_waitcnt lgkmcnt(2)
    v_mfma_f32_16x16x32_bf16 v[64:67], a[112:115], v[28:31], v[64:67]
    ds_read_b128 v[24:27], v3 offset:34816
    v_mul_f32 v103, s9, v103
    v_mfma_f32_16x16x32_bf16 v[68:71], a[116:119], v[28:31], v[68:71]
    v_rcp_f32 v99, v99
    v_mfma_f32_16x16x32_bf16 v[72:75], a[120:123], v[28:31], v[72:75]
    v_exp_f32 v102, v102
    v_mfma_f32_16x16x32_bf16 v[76:79], a[124:127], v[28:31], v[76:79]
    v_add_f32 v101, 1.0, v101
    s_waitcnt lgkmcnt(2)
    v_mfma_f32_16x16x32_bf16 v[64:67], a[128:131], v[16:19], v[64:67]
    ds_read_b128 v[28:31], v3 offset:35840
    v_mul_f32 v99, v99, v107
    v_mfma_f32_16x16x32_bf16 v[68:71], a[132:135], v[16:19], v[68:71]
    v_rcp_f32 v100, v100
    v_mfma_f32_16x16x32_bf16 v[72:75], a[136:139], v[16:19], v[72:75]
    v_exp_f32 v103, v103
    v_mfma_f32_16x16x32_bf16 v[76:79], a[140:143], v[16:19], v[76:79]
    v_add_f32 v102, 1.0, v102
    s_waitcnt lgkmcnt(2)
    v_mfma_f32_16x16x32_bf16 v[64:67], a[144:147], v[20:23], v[64:67]
    ds_read_b128 v[16:19], v3 offset:36864
    v_mul_f32 v100, v100, v108
    v_mfma_f32_16x16x32_bf16 v[68:71], a[148:151], v[20:23], v[68:71]
    v_rcp_f32 v101, v101
    v_mfma_f32_16x16x32_bf16 v[72:75], a[152:155], v[20:23], v[72:75]
    v_add_f32 v103, 1.0, v103
    v_mul_f32 v101, v101, v109
    v_mfma_f32_16x16x32_bf16 v[76:79], a[156:159], v[20:23], v[76:79]
    v_cvt_pk_bf16_f32 v104, v96, v97
    s_waitcnt lgkmcnt(2)
    v_mfma_f32_16x16x32_bf16 v[64:67], a[160:163], v[24:27], v[64:67]
    ds_read_b128 v[20:23], v3 offset:37888
    v_cvt_pk_bf16_f32 v105, v98, v99
    v_mfma_f32_16x16x32_bf16 v[68:71], a[164:167], v[24:27], v[68:71]
    v_rcp_f32 v102, v102
    v_mfma_f32_16x16x32_bf16 v[72:75], a[168:171], v[24:27], v[72:75]
    v_rcp_f32 v103, v103
    v_mfma_f32_16x16x32_bf16 v[76:79], a[172:175], v[24:27], v[76:79]
    v_mul_f32 v102, v102, v110
    s_waitcnt lgkmcnt(2)
    v_mfma_f32_16x16x32_bf16 v[64:67], a[176:179], v[28:31], v[64:67]
    ds_read_b128 v[24:27], v3 offset:38912
    v_mul_f32 v103, v103, v111
    v_mfma_f32_16x16x32_bf16 v[68:71], a[180:183], v[28:31], v[68:71]
    v_cvt_pk_bf16_f32 v106, v100, v101
    v_cvt_pk_bf16_f32 v107, v102, v103
    v_mfma_f32_16x16x32_bf16 v[72:75], a[184:187], v[28:31], v[72:75]
    s_add_u32 s19, s14, 1622016
    v_mfma_f32_16x16x32_bf16 v[76:79], a[188:191], v[28:31], v[76:79]
    s_waitcnt lgkmcnt(2)
    v_mfma_f32_16x16x32_bf16 v[64:67], a[192:195], v[16:19], v[64:67]
    ds_read_b128 v[28:31], v3 offset:39936
    v_mfma_f32_16x16x32_bf16 v[68:71], a[196:199], v[16:19], v[68:71]
    buffer_store_dwordx4 v[104:107], v1, s[28:31], s19 offen sc1
    v_mfma_f32_16x16x32_bf16 v[72:75], a[200:203], v[16:19], v[72:75]
    v_mfma_f32_16x16x32_bf16 v[76:79], a[204:207], v[16:19], v[76:79]
    s_waitcnt lgkmcnt(2)
    v_mfma_f32_16x16x32_bf16 v[64:67], a[208:211], v[20:23], v[64:67]
    ds_read_b128 v[16:19], v3 offset:40960
    v_mfma_f32_16x16x32_bf16 v[68:71], a[212:215], v[20:23], v[68:71]
    v_mfma_f32_16x16x32_bf16 v[72:75], a[216:219], v[20:23], v[72:75]
    v_mfma_f32_16x16x32_bf16 v[76:79], a[220:223], v[20:23], v[76:79]
    s_waitcnt lgkmcnt(2)
    v_mfma_f32_16x16x32_bf16 v[64:67], a[224:227], v[24:27], v[64:67]
    ds_read_b128 v[20:23], v3 offset:41984
    v_mfma_f32_16x16x32_bf16 v[68:71], a[228:231], v[24:27], v[68:71]
    v_mfma_f32_16x16x32_bf16 v[72:75], a[232:235], v[24:27], v[72:75]
    v_mfma_f32_16x16x32_bf16 v[76:79], a[236:239], v[24:27], v[76:79]
    s_waitcnt lgkmcnt(2)
    v_mfma_f32_16x16x32_bf16 v[64:67], a[240:243], v[28:31], v[64:67]
    ds_read_b128 v[24:27], v3 offset:43008
    v_mfma_f32_16x16x32_bf16 v[68:71], a[244:247], v[28:31], v[68:71]
    v_mfma_f32_16x16x32_bf16 v[72:75], a[248:251], v[28:31], v[72:75]
    v_mfma_f32_16x16x32_bf16 v[76:79], a[252:255], v[28:31], v[76:79]
    s_waitcnt lgkmcnt(2)
    v_mfma_f32_16x16x32_bf16 v[64:67], v[224:227], v[16:19], v[64:67]
    ds_read_b128 v[28:31], v3 offset:44032
    v_mfma_f32_16x16x32_bf16 v[68:71], v[228:231], v[16:19], v[68:71]
    v_mfma_f32_16x16x32_bf16 v[72:75], v[232:235], v[16:19], v[72:75]
    v_mfma_f32_16x16x32_bf16 v[76:79], v[236:239], v[16:19], v[76:79]
    s_waitcnt lgkmcnt(2)
    v_mfma_f32_16x16x32_bf16 v[64:67], v[240:243], v[20:23], v[64:67]
    ds_read_b128 v[16:19], v3 offset:45056
    v_mfma_f32_16x16x32_bf16 v[68:71], v[244:247], v[20:23], v[68:71]
    v_mfma_f32_16x16x32_bf16 v[72:75], v[248:251], v[20:23], v[72:75]
    v_mfma_f32_16x16x32_bf16 v[76:79], v[252:255], v[20:23], v[76:79]
    s_waitcnt lgkmcnt(2)
    v_mfma_f32_16x16x32_bf16 v[80:83], a[0:3], v[24:27], 0
    ds_read_b128 v[20:23], v3 offset:46080
    v_mfma_f32_16x16x32_bf16 v[84:87], a[4:7], v[24:27], 0
    v_mfma_f32_16x16x32_bf16 v[88:91], a[8:11], v[24:27], 0
    v_mfma_f32_16x16x32_bf16 v[92:95], a[12:15], v[24:27], 0
    v_mul_f32 v64, s9, v64
    s_waitcnt lgkmcnt(2)
    v_mfma_f32_16x16x32_bf16 v[80:83], a[16:19], v[28:31], v[80:83]
    ds_read_b128 v[24:27], v3 offset:47104
    v_mul_f32 v65, s9, v65
    v_mfma_f32_16x16x32_bf16 v[84:87], a[20:23], v[28:31], v[84:87]
    v_exp_f32 v64, v64
    v_mfma_f32_16x16x32_bf16 v[88:91], a[24:27], v[28:31], v[88:91]
    v_mul_f32 v66, s9, v66
    v_add_f32 v64, 1.0, v64
    v_mfma_f32_16x16x32_bf16 v[92:95], a[28:31], v[28:31], v[92:95]
    v_mul_f32 v67, s9, v67
    s_waitcnt lgkmcnt(2)
    v_mfma_f32_16x16x32_bf16 v[80:83], a[32:35], v[16:19], v[80:83]
    ds_read_b128 v[28:31], v3 offset:48128
    v_mul_f32 v68, s9, v68
    v_mfma_f32_16x16x32_bf16 v[84:87], a[36:39], v[16:19], v[84:87]
    v_exp_f32 v65, v65
    v_mfma_f32_16x16x32_bf16 v[88:91], a[40:43], v[16:19], v[88:91]
    v_exp_f32 v66, v66
    v_mfma_f32_16x16x32_bf16 v[92:95], a[44:47], v[16:19], v[92:95]
    v_add_f32 v65, 1.0, v65
    s_waitcnt lgkmcnt(2)
    v_mfma_f32_16x16x32_bf16 v[80:83], a[48:51], v[20:23], v[80:83]
    s_waitcnt vmcnt(20)
    s_barrier
    ds_read_b128 v[16:19], v3 offset:49152
    v_mfma_f32_16x16x32_bf16 v[84:87], a[52:55], v[20:23], v[84:87]
    v_rcp_f32 v64, v64
    v_mfma_f32_16x16x32_bf16 v[88:91], a[56:59], v[20:23], v[88:91]
    s_add_u32 m0, s43, 135168
    s_add_u32 s17, s16, 331776
    buffer_load_dwordx4 v1, s[24:27], s17 offen offset:0 lds
    v_mfma_f32_16x16x32_bf16 v[92:95], a[60:63], v[20:23], v[92:95]
    v_add_f32 v66, 1.0, v66
    s_waitcnt lgkmcnt(2)
    v_mfma_f32_16x16x32_bf16 v[80:83], a[64:67], v[24:27], v[80:83]
    ds_read_b128 v[20:23], v3 offset:50176
    v_mul_f32 v64, v64, v72
    v_mfma_f32_16x16x32_bf16 v[84:87], a[68:71], v[24:27], v[84:87]
    v_exp_f32 v67, v67
    v_mfma_f32_16x16x32_bf16 v[88:91], a[72:75], v[24:27], v[88:91]
    buffer_load_dwordx4 v1, s[24:27], s17 offen offset:1024 lds
    v_mfma_f32_16x16x32_bf16 v[92:95], a[76:79], v[24:27], v[92:95]
    v_mul_f32 v69, s9, v69
    s_waitcnt lgkmcnt(2)
    v_mfma_f32_16x16x32_bf16 v[80:83], a[80:83], v[28:31], v[80:83]
    ds_read_b128 v[24:27], v3 offset:51200
    v_add_f32 v67, 1.0, v67
    v_mfma_f32_16x16x32_bf16 v[84:87], a[84:87], v[28:31], v[84:87]
    v_rcp_f32 v65, v65
    v_mfma_f32_16x16x32_bf16 v[88:91], a[88:91], v[28:31], v[88:91]
    buffer_load_dwordx4 v1, s[24:27], s17 offen offset:2048 lds
    v_mfma_f32_16x16x32_bf16 v[92:95], a[92:95], v[28:31], v[92:95]
    v_mul_f32 v65, v65, v73
    s_waitcnt lgkmcnt(2)
    v_mfma_f32_16x16x32_bf16 v[80:83], a[96:99], v[16:19], v[80:83]
    ds_read_b128 v[28:31], v3 offset:52224
    v_mul_f32 v70, s9, v70
    v_mfma_f32_16x16x32_bf16 v[84:87], a[100:103], v[16:19], v[84:87]
    v_exp_f32 v68, v68
    v_mfma_f32_16x16x32_bf16 v[88:91], a[104:107], v[16:19], v[88:91]
    s_add_u32 m0, s43, 147456
    s_add_u32 s17, s16, 344064
    buffer_load_dwordx4 v1, s[24:27], s17 offen offset:0 lds
    v_mfma_f32_16x16x32_bf16 v[92:95], a[108:111], v[16:19], v[92:95]
    v_add_f32 v68, 1.0, v68
    s_waitcnt lgkmcnt(2)
    v_mfma_f32_16x16x32_bf16 v[80:83], a[112:115], v[20:23], v[80:83]
    ds_read_b128 v[16:19], v3 offset:53248
    v_mul_f32 v71, s9, v71
    v_mfma_f32_16x16x32_bf16 v[84:87], a[116:119], v[20:23], v[84:87]
    v_rcp_f32 v66, v66
    v_mfma_f32_16x16x32_bf16 v[88:91], a[120:123], v[20:23], v[88:91]
    buffer_load_dwordx4 v1, s[24:27], s17 offen offset:1024 lds
    v_mfma_f32_16x16x32_bf16 v[92:95], a[124:127], v[20:23], v[92:95]
    v_mul_f32 v66, v66, v74
    s_waitcnt lgkmcnt(2)
    v_mfma_f32_16x16x32_bf16 v[80:83], a[128:131], v[24:27], v[80:83]
    ds_read_b128 v[20:23], v3 offset:54272
    v_mfma_f32_16x16x32_bf16 v[84:87], a[132:135], v[24:27], v[84:87]
    v_exp_f32 v69, v69
    v_mfma_f32_16x16x32_bf16 v[88:91], a[136:139], v[24:27], v[88:91]
    buffer_load_dwordx4 v1, s[24:27], s17 offen offset:2048 lds
    v_mfma_f32_16x16x32_bf16 v[92:95], a[140:143], v[24:27], v[92:95]
    v_add_f32 v69, 1.0, v69
    s_waitcnt lgkmcnt(2)
    v_mfma_f32_16x16x32_bf16 v[80:83], a[144:147], v[28:31], v[80:83]
    ds_read_b128 v[24:27], v3 offset:55296
    v_mfma_f32_16x16x32_bf16 v[84:87], a[148:151], v[28:31], v[84:87]
    v_rcp_f32 v67, v67
    v_mfma_f32_16x16x32_bf16 v[88:91], a[152:155], v[28:31], v[88:91]
    s_add_u32 m0, s62, 0
    s_add_u32 s63, s60, 0
    buffer_load_dwordx4 v40, s[52:55], s63 offen offset:0 lds
    v_mfma_f32_16x16x32_bf16 v[92:95], a[156:159], v[28:31], v[92:95]
    v_mul_f32 v67, v67, v75
    s_waitcnt lgkmcnt(2)
    v_mfma_f32_16x16x32_bf16 v[80:83], a[160:163], v[16:19], v[80:83]
    ds_read_b128 v[28:31], v3 offset:56320
    v_mfma_f32_16x16x32_bf16 v[84:87], a[164:167], v[16:19], v[84:87]
    v_exp_f32 v70, v70
    v_mfma_f32_16x16x32_bf16 v[88:91], a[168:171], v[16:19], v[88:91]
    buffer_load_dwordx4 v41, s[52:55], s63 offen offset:1024 lds
    v_mfma_f32_16x16x32_bf16 v[92:95], a[172:175], v[16:19], v[92:95]
    v_add_f32 v70, 1.0, v70
    s_waitcnt lgkmcnt(2)
    v_mfma_f32_16x16x32_bf16 v[80:83], a[176:179], v[20:23], v[80:83]
    ds_read_b128 v[16:19], v3 offset:57344
    v_cvt_pk_bf16_f32 v72, v64, v65
    v_mfma_f32_16x16x32_bf16 v[84:87], a[180:183], v[20:23], v[84:87]
    v_rcp_f32 v68, v68
    v_mfma_f32_16x16x32_bf16 v[88:91], a[184:187], v[20:23], v[88:91]
    buffer_load_dwordx4 v42, s[52:55], s63 offen offset:2048 lds
    v_mfma_f32_16x16x32_bf16 v[92:95], a[188:191], v[20:23], v[92:95]
    v_mul_f32 v68, v68, v76
    s_waitcnt lgkmcnt(2)
    v_mfma_f32_16x16x32_bf16 v[80:83], a[192:195], v[24:27], v[80:83]
    ds_read_b128 v[20:23], v3 offset:58368
    v_cvt_pk_bf16_f32 v73, v66, v67
    v_mfma_f32_16x16x32_bf16 v[84:87], a[196:199], v[24:27], v[84:87]
    v_exp_f32 v71, v71
    v_mfma_f32_16x16x32_bf16 v[88:91], a[200:203], v[24:27], v[88:91]
    buffer_load_dwordx4 v43, s[52:55], s63 offen offset:3072 lds
    v_mfma_f32_16x16x32_bf16 v[92:95], a[204:207], v[24:27], v[92:95]
    v_add_f32 v71, 1.0, v71
    s_waitcnt lgkmcnt(2)
    v_mfma_f32_16x16x32_bf16 v[80:83], a[208:211], v[28:31], v[80:83]
    ds_read_b128 v[24:27], v3 offset:59392
    s_add_u32 s19, s14, 1769472
    v_mfma_f32_16x16x32_bf16 v[84:87], a[212:215], v[28:31], v[84:87]
    v_rcp_f32 v69, v69
    v_mfma_f32_16x16x32_bf16 v[88:91], a[216:219], v[28:31], v[88:91]
    s_add_u32 m0, s62, 4096
    s_nop 0
    buffer_load_dwordx4 v44, s[52:55], s63 offen offset:0 lds
    v_mfma_f32_16x16x32_bf16 v[92:95], a[220:223], v[28:31], v[92:95]
    v_mul_f32 v69, v69, v77
    s_waitcnt lgkmcnt(2)
    v_mfma_f32_16x16x32_bf16 v[80:83], a[224:227], v[16:19], v[80:83]
    ds_read_b128 v[28:31], v3 offset:60416
    v_cvt_pk_bf16_f32 v74, v68, v69
    v_mfma_f32_16x16x32_bf16 v[84:87], a[228:231], v[16:19], v[84:87]
    v_rcp_f32 v70, v70
    v_mfma_f32_16x16x32_bf16 v[88:91], a[232:235], v[16:19], v[88:91]
    buffer_load_dwordx4 v45, s[52:55], s63 offen offset:1024 lds
    v_mfma_f32_16x16x32_bf16 v[92:95], a[236:239], v[16:19], v[92:95]
    v_mul_f32 v70, v70, v78
    s_waitcnt lgkmcnt(2)
    v_mfma_f32_16x16x32_bf16 v[80:83], a[240:243], v[20:23], v[80:83]
    ds_read_b128 v[16:19], v3 offset:61440
    v_mfma_f32_16x16x32_bf16 v[84:87], a[244:247], v[20:23], v[84:87]
    v_rcp_f32 v71, v71
    v_mfma_f32_16x16x32_bf16 v[88:91], a[248:251], v[20:23], v[88:91]
    buffer_load_dwordx4 v46, s[52:55], s63 offen offset:2048 lds
    v_mfma_f32_16x16x32_bf16 v[92:95], a[252:255], v[20:23], v[92:95]
    v_mul_f32 v71, v71, v79
    s_waitcnt lgkmcnt(2)
    v_mfma_f32_16x16x32_bf16 v[80:83], v[224:227], v[24:27], v[80:83]
    ds_read_b128 v[20:23], v3 offset:62464
    v_cvt_pk_bf16_f32 v75, v70, v71
    v_mfma_f32_16x16x32_bf16 v[84:87], v[228:231], v[24:27], v[84:87]
    buffer_store_dwordx4 v[72:75], v1, s[28:31], s19 offen sc1
    v_mfma_f32_16x16x32_bf16 v[88:91], v[232:235], v[24:27], v[88:91]
    buffer_load_dwordx4 v47, s[52:55], s63 offen offset:3072 lds
    v_mfma_f32_16x16x32_bf16 v[92:95], v[236:239], v[24:27], v[92:95]
    s_waitcnt lgkmcnt(2)
    v_mfma_f32_16x16x32_bf16 v[80:83], v[240:243], v[28:31], v[80:83]
    ds_read_b128 v[24:27], v3 offset:63488
    v_mfma_f32_16x16x32_bf16 v[84:87], v[244:247], v[28:31], v[84:87]
    v_mfma_f32_16x16x32_bf16 v[88:91], v[248:251], v[28:31], v[88:91]
    s_add_u32 m0, s62, 8192
    s_nop 0
    buffer_load_dwordx4 v48, s[52:55], s63 offen offset:0 lds
    v_mfma_f32_16x16x32_bf16 v[92:95], v[252:255], v[28:31], v[92:95]
    s_waitcnt lgkmcnt(2)
    v_mfma_f32_16x16x32_bf16 v[96:99], a[0:3], v[16:19], 0
    ds_read_b128 v[28:31], v3 offset:64512
    v_mfma_f32_16x16x32_bf16 v[100:103], a[4:7], v[16:19], 0
    v_mfma_f32_16x16x32_bf16 v[104:107], a[8:11], v[16:19], 0
    v_mfma_f32_16x16x32_bf16 v[108:111], a[12:15], v[16:19], 0
    v_mul_f32 v80, s9, v80
    s_waitcnt lgkmcnt(2)
    v_mfma_f32_16x16x32_bf16 v[96:99], a[16:19], v[20:23], v[96:99]
    ds_read_b128 v[16:19], v4 offset:0
    v_mul_f32 v81, s9, v81
    v_mfma_f32_16x16x32_bf16 v[100:103], a[20:23], v[20:23], v[100:103]
    v_exp_f32 v80, v80
    v_mfma_f32_16x16x32_bf16 v[104:107], a[24:27], v[20:23], v[104:107]
    v_mul_f32 v82, s9, v82
    v_add_f32 v80, 1.0, v80
    v_mfma_f32_16x16x32_bf16 v[108:111], a[28:31], v[20:23], v[108:111]
    v_mul_f32 v83, s9, v83
    s_waitcnt lgkmcnt(2)
    v_mfma_f32_16x16x32_bf16 v[96:99], a[32:35], v[24:27], v[96:99]
    ds_read_b128 v[20:23], v4 offset:1024
    v_mul_f32 v84, s9, v84
    v_mfma_f32_16x16x32_bf16 v[100:103], a[36:39], v[24:27], v[100:103]
    v_exp_f32 v81, v81
    v_mfma_f32_16x16x32_bf16 v[104:107], a[40:43], v[24:27], v[104:107]
    v_exp_f32 v82, v82
    v_mfma_f32_16x16x32_bf16 v[108:111], a[44:47], v[24:27], v[108:111]
    v_add_f32 v81, 1.0, v81
    s_waitcnt lgkmcnt(2)
    v_mfma_f32_16x16x32_bf16 v[96:99], a[48:51], v[28:31], v[96:99]
    ds_read_b128 v[24:27], v4 offset:2048
    v_add_f32 v82, 1.0, v82
    v_mfma_f32_16x16x32_bf16 v[100:103], a[52:55], v[28:31], v[100:103]
    v_rcp_f32 v80, v80
    v_mfma_f32_16x16x32_bf16 v[104:107], a[56:59], v[28:31], v[104:107]
    v_exp_f32 v83, v83
    v_mfma_f32_16x16x32_bf16 v[108:111], a[60:63], v[28:31], v[108:111]
    v_mul_f32 v80, v80, v88
    s_waitcnt lgkmcnt(2)
    v_mfma_f32_16x16x32_bf16 v[96:99], a[64:67], v[16:19], v[96:99]
    ds_read_b128 v[28:31], v4 offset:3072
    v_mul_f32 v85, s9, v85
    v_mfma_f32_16x16x32_bf16 v[100:103], a[68:71], v[16:19], v[100:103]
    v_rcp_f32 v81, v81
    v_mfma_f32_16x16x32_bf16 v[104:107], a[72:75], v[16:19], v[104:107]
    v_exp_f32 v84, v84
    v_mfma_f32_16x16x32_bf16 v[108:111], a[76:79], v[16:19], v[108:111]
    v_add_f32 v83, 1.0, v83
    s_waitcnt lgkmcnt(2)
    v_mfma_f32_16x16x32_bf16 v[96:99], a[80:83], v[20:23], v[96:99]
    ds_read_b128 v[16:19], v4 offset:4096
    v_mul_f32 v81, v81, v89
    v_mfma_f32_16x16x32_bf16 v[100:103], a[84:87], v[20:23], v[100:103]
    v_rcp_f32 v82, v82
    v_mfma_f32_16x16x32_bf16 v[104:107], a[88:91], v[20:23], v[104:107]
    v_mul_f32 v86, s9, v86
    v_add_f32 v84, 1.0, v84
    v_mfma_f32_16x16x32_bf16 v[108:111], a[92:95], v[20:23], v[108:111]
    v_mul_f32 v82, v82, v90
    s_waitcnt lgkmcnt(2)
    v_mfma_f32_16x16x32_bf16 v[96:99], a[96:99], v[24:27], v[96:99]
    ds_read_b128 v[20:23], v4 offset:5120
    v_mul_f32 v87, s9, v87
    v_mfma_f32_16x16x32_bf16 v[100:103], a[100:103], v[24:27], v[100:103]
    v_exp_f32 v85, v85
    v_mfma_f32_16x16x32_bf16 v[104:107], a[104:107], v[24:27], v[104:107]
    v_rcp_f32 v83, v83
    v_mfma_f32_16x16x32_bf16 v[108:111], a[108:111], v[24:27], v[108:111]
    v_add_f32 v85, 1.0, v85
    s_waitcnt lgkmcnt(2)
    v_mfma_f32_16x16x32_bf16 v[96:99], a[112:115], v[28:31], v[96:99]
    ds_read_b128 v[24:27], v4 offset:6144
    v_mul_f32 v83, v83, v91
    v_mfma_f32_16x16x32_bf16 v[100:103], a[116:119], v[28:31], v[100:103]
    v_exp_f32 v86, v86
    v_mfma_f32_16x16x32_bf16 v[104:107], a[120:123], v[28:31], v[104:107]
    v_rcp_f32 v84, v84
    v_mfma_f32_16x16x32_bf16 v[108:111], a[124:127], v[28:31], v[108:111]
    v_add_f32 v86, 1.0, v86
    s_waitcnt lgkmcnt(2)
    v_mfma_f32_16x16x32_bf16 v[96:99], a[128:131], v[16:19], v[96:99]
    ds_read_b128 v[28:31], v4 offset:7168
    v_mul_f32 v84, v84, v92
    v_mfma_f32_16x16x32_bf16 v[100:103], a[132:135], v[16:19], v[100:103]
    v_exp_f32 v87, v87
    v_mfma_f32_16x16x32_bf16 v[104:107], a[136:139], v[16:19], v[104:107]
    v_rcp_f32 v85, v85
    v_mfma_f32_16x16x32_bf16 v[108:111], a[140:143], v[16:19], v[108:111]
    v_add_f32 v87, 1.0, v87
    s_waitcnt lgkmcnt(2)
    v_mfma_f32_16x16x32_bf16 v[96:99], a[144:147], v[20:23], v[96:99]
    s_waitcnt vmcnt(27)
    s_barrier
    ds_read_b128 v[16:19], v4 offset:8192
    v_mfma_f32_16x16x32_bf16 v[100:103], a[148:151], v[20:23], v[100:103]
    v_rcp_f32 v86, v86
    v_mfma_f32_16x16x32_bf16 v[104:107], a[152:155], v[20:23], v[104:107]
    buffer_load_dword v52, v49, s[32:35], s36 offen
    v_mfma_f32_16x16x32_bf16 v[108:111], a[156:159], v[20:23], v[108:111]
    v_mul_f32 v85, v85, v93
    s_waitcnt lgkmcnt(2)
    v_mfma_f32_16x16x32_bf16 v[96:99], a[160:163], v[24:27], v[96:99]
    ds_read_b128 v[20:23], v4 offset:9216
    v_mul_f32 v86, v86, v94
    v_mfma_f32_16x16x32_bf16 v[100:103], a[164:167], v[24:27], v[100:103]
    v_rcp_f32 v87, v87
    v_mfma_f32_16x16x32_bf16 v[104:107], a[168:171], v[24:27], v[104:107]
    v_mul_f32 v87, v87, v95
    v_cvt_pk_bf16_f32 v88, v80, v81
    v_mfma_f32_16x16x32_bf16 v[108:111], a[172:175], v[24:27], v[108:111]
    v_cvt_pk_bf16_f32 v89, v82, v83
    s_waitcnt lgkmcnt(2)
    v_mfma_f32_16x16x32_bf16 v[96:99], a[176:179], v[28:31], v[96:99]
    ds_read_b128 v[24:27], v4 offset:10240
    v_cvt_pk_bf16_f32 v90, v84, v85
    v_mfma_f32_16x16x32_bf16 v[100:103], a[180:183], v[28:31], v[100:103]
    v_cvt_pk_bf16_f32 v91, v86, v87
    s_add_u32 s19, s14, 1916928
    v_mfma_f32_16x16x32_bf16 v[104:107], a[184:187], v[28:31], v[104:107]
    buffer_store_dwordx4 v[88:91], v1, s[28:31], s19 offen sc1
    v_mfma_f32_16x16x32_bf16 v[108:111], a[188:191], v[28:31], v[108:111]
    s_waitcnt lgkmcnt(2)
    v_mfma_f32_16x16x32_bf16 v[96:99], a[192:195], v[16:19], v[96:99]
    ds_read_b128 v[28:31], v4 offset:11264
    v_mfma_f32_16x16x32_bf16 v[100:103], a[196:199], v[16:19], v[100:103]
    v_mfma_f32_16x16x32_bf16 v[104:107], a[200:203], v[16:19], v[104:107]
    v_mfma_f32_16x16x32_bf16 v[108:111], a[204:207], v[16:19], v[108:111]
    s_waitcnt lgkmcnt(2)
    v_mfma_f32_16x16x32_bf16 v[96:99], a[208:211], v[20:23], v[96:99]
    ds_read_b128 v[16:19], v4 offset:12288
    v_mfma_f32_16x16x32_bf16 v[100:103], a[212:215], v[20:23], v[100:103]
    v_mfma_f32_16x16x32_bf16 v[104:107], a[216:219], v[20:23], v[104:107]
    v_mfma_f32_16x16x32_bf16 v[108:111], a[220:223], v[20:23], v[108:111]
    s_waitcnt lgkmcnt(2)
    v_mfma_f32_16x16x32_bf16 v[96:99], a[224:227], v[24:27], v[96:99]
    ds_read_b128 v[20:23], v4 offset:13312
    v_mfma_f32_16x16x32_bf16 v[100:103], a[228:231], v[24:27], v[100:103]
    v_mfma_f32_16x16x32_bf16 v[104:107], a[232:235], v[24:27], v[104:107]
    v_mfma_f32_16x16x32_bf16 v[108:111], a[236:239], v[24:27], v[108:111]
    s_waitcnt lgkmcnt(2)
    v_mfma_f32_16x16x32_bf16 v[96:99], a[240:243], v[28:31], v[96:99]
    ds_read_b128 v[24:27], v4 offset:14336
    v_mfma_f32_16x16x32_bf16 v[100:103], a[244:247], v[28:31], v[100:103]
    v_mfma_f32_16x16x32_bf16 v[104:107], a[248:251], v[28:31], v[104:107]
    v_mfma_f32_16x16x32_bf16 v[108:111], a[252:255], v[28:31], v[108:111]
    s_waitcnt lgkmcnt(2)
    v_mfma_f32_16x16x32_bf16 v[96:99], v[224:227], v[16:19], v[96:99]
    ds_read_b128 v[28:31], v4 offset:15360
    v_mfma_f32_16x16x32_bf16 v[100:103], v[228:231], v[16:19], v[100:103]
    v_mfma_f32_16x16x32_bf16 v[104:107], v[232:235], v[16:19], v[104:107]
    v_mfma_f32_16x16x32_bf16 v[108:111], v[236:239], v[16:19], v[108:111]
    s_waitcnt lgkmcnt(2)
    v_mfma_f32_16x16x32_bf16 v[96:99], v[240:243], v[20:23], v[96:99]
    ds_read_b128 v[16:19], v4 offset:16384
    v_mfma_f32_16x16x32_bf16 v[100:103], v[244:247], v[20:23], v[100:103]
    v_mfma_f32_16x16x32_bf16 v[104:107], v[248:251], v[20:23], v[104:107]
    v_mfma_f32_16x16x32_bf16 v[108:111], v[252:255], v[20:23], v[108:111]
    s_waitcnt lgkmcnt(2)
    v_mfma_f32_16x16x32_bf16 v[64:67], a[0:3], v[24:27], 0
    ds_read_b128 v[20:23], v4 offset:17408
    v_mfma_f32_16x16x32_bf16 v[68:71], a[4:7], v[24:27], 0
    v_mfma_f32_16x16x32_bf16 v[72:75], a[8:11], v[24:27], 0
    v_mfma_f32_16x16x32_bf16 v[76:79], a[12:15], v[24:27], 0
    v_mul_f32 v96, s9, v96
    s_waitcnt lgkmcnt(2)
    v_mfma_f32_16x16x32_bf16 v[64:67], a[16:19], v[28:31], v[64:67]
    ds_read_b128 v[24:27], v4 offset:18432
    v_mul_f32 v97, s9, v97
    v_mfma_f32_16x16x32_bf16 v[68:71], a[20:23], v[28:31], v[68:71]
    v_exp_f32 v96, v96
    v_mfma_f32_16x16x32_bf16 v[72:75], a[24:27], v[28:31], v[72:75]
    v_mul_f32 v98, s9, v98
    v_add_f32 v96, 1.0, v96
    v_mfma_f32_16x16x32_bf16 v[76:79], a[28:31], v[28:31], v[76:79]
    v_mul_f32 v99, s9, v99
    s_waitcnt lgkmcnt(2)
    v_mfma_f32_16x16x32_bf16 v[64:67], a[32:35], v[16:19], v[64:67]
    ds_read_b128 v[28:31], v4 offset:19456
    v_mul_f32 v100, s9, v100
    v_mfma_f32_16x16x32_bf16 v[68:71], a[36:39], v[16:19], v[68:71]
    v_exp_f32 v97, v97
    v_mfma_f32_16x16x32_bf16 v[72:75], a[40:43], v[16:19], v[72:75]
    v_exp_f32 v98, v98
    v_mfma_f32_16x16x32_bf16 v[76:79], a[44:47], v[16:19], v[76:79]
    v_add_f32 v97, 1.0, v97
    s_waitcnt lgkmcnt(2)
    v_mfma_f32_16x16x32_bf16 v[64:67], a[48:51], v[20:23], v[64:67]
    ds_read_b128 v[16:19], v4 offset:20480
    v_add_f32 v98, 1.0, v98
    v_mfma_f32_16x16x32_bf16 v[68:71], a[52:55], v[20:23], v[68:71]
    v_rcp_f32 v96, v96
    v_mfma_f32_16x16x32_bf16 v[72:75], a[56:59], v[20:23], v[72:75]
    v_exp_f32 v99, v99
    v_mfma_f32_16x16x32_bf16 v[76:79], a[60:63], v[20:23], v[76:79]
    v_mul_f32 v96, v96, v104
    s_waitcnt lgkmcnt(2)
    v_mfma_f32_16x16x32_bf16 v[64:67], a[64:67], v[24:27], v[64:67]
    ds_read_b128 v[20:23], v4 offset:21504
    v_mul_f32 v101, s9, v101
    v_mfma_f32_16x16x32_bf16 v[68:71], a[68:71], v[24:27], v[68:71]
    v_rcp_f32 v97, v97
    v_mfma_f32_16x16x32_bf16 v[72:75], a[72:75], v[24:27], v[72:75]
    v_exp_f32 v100, v100
    v_mfma_f32_16x16x32_bf16 v[76:79], a[76:79], v[24:27], v[76:79]
    v_add_f32 v99, 1.0, v99
    s_waitcnt lgkmcnt(2)
    v_mfma_f32_16x16x32_bf16 v[64:67], a[80:83], v[28:31], v[64:67]
    ds_read_b128 v[24:27], v4 offset:22528
    v_mul_f32 v97, v97, v105
    v_mfma_f32_16x16x32_bf16 v[68:71], a[84:87], v[28:31], v[68:71]
    v_rcp_f32 v98, v98
    v_mfma_f32_16x16x32_bf16 v[72:75], a[88:91], v[28:31], v[72:75]
    v_mul_f32 v102, s9, v102
    v_add_f32 v100, 1.0, v100
    v_mfma_f32_16x16x32_bf16 v[76:79], a[92:95], v[28:31], v[76:79]
    v_mul_f32 v98, v98, v106
    s_waitcnt lgkmcnt(2)
    v_mfma_f32_16x16x32_bf16 v[64:67], a[96:99], v[16:19], v[64:67]
    ds_read_b128 v[28:31], v4 offset:23552
    v_mul_f32 v103, s9, v103
    v_mfma_f32_16x16x32_bf16 v[68:71], a[100:103], v[16:19], v[68:71]
    v_exp_f32 v101, v101
    v_mfma_f32_16x16x32_bf16 v[72:75], a[104:107], v[16:19], v[72:75]
    v_rcp_f32 v99, v99
    v_mfma_f32_16x16x32_bf16 v[76:79], a[108:111], v[16:19], v[76:79]
    v_add_f32 v101, 1.0, v101
    s_waitcnt lgkmcnt(2)
    v_mfma_f32_16x16x32_bf16 v[64:67], a[112:115], v[20:23], v[64:67]
    ds_read_b128 v[16:19], v4 offset:24576
    v_mul_f32 v99, v99, v107
    v_mfma_f32_16x16x32_bf16 v[68:71], a[116:119], v[20:23], v[68:71]
    v_exp_f32 v102, v102
    v_mfma_f32_16x16x32_bf16 v[72:75], a[120:123], v[20:23], v[72:75]
    v_rcp_f32 v100, v100
    v_mfma_f32_16x16x32_bf16 v[76:79], a[124:127], v[20:23], v[76:79]
    v_add_f32 v102, 1.0, v102
    s_waitcnt lgkmcnt(2)
    v_mfma_f32_16x16x32_bf16 v[64:67], a[128:131], v[24:27], v[64:67]
    ds_read_b128 v[20:23], v4 offset:25600
    v_mul_f32 v100, v100, v108
    v_mfma_f32_16x16x32_bf16 v[68:71], a[132:135], v[24:27], v[68:71]
    v_exp_f32 v103, v103
    v_mfma_f32_16x16x32_bf16 v[72:75], a[136:139], v[24:27], v[72:75]
    v_rcp_f32 v101, v101
    v_mfma_f32_16x16x32_bf16 v[76:79], a[140:143], v[24:27], v[76:79]
    v_add_f32 v103, 1.0, v103
    s_waitcnt lgkmcnt(2)
    v_mfma_f32_16x16x32_bf16 v[64:67], a[144:147], v[28:31], v[64:67]
    ds_read_b128 v[24:27], v4 offset:26624
    v_mul_f32 v101, v101, v109
    v_mfma_f32_16x16x32_bf16 v[68:71], a[148:151], v[28:31], v[68:71]
    v_rcp_f32 v102, v102
    v_mfma_f32_16x16x32_bf16 v[72:75], a[152:155], v[28:31], v[72:75]
    v_rcp_f32 v103, v103
    v_mfma_f32_16x16x32_bf16 v[76:79], a[156:159], v[28:31], v[76:79]
    v_mul_f32 v102, v102, v110
    s_waitcnt lgkmcnt(2)
    v_mfma_f32_16x16x32_bf16 v[64:67], a[160:163], v[16:19], v[64:67]
    ds_read_b128 v[28:31], v4 offset:27648
    v_mul_f32 v103, v103, v111
    v_mfma_f32_16x16x32_bf16 v[68:71], a[164:167], v[16:19], v[68:71]
    v_cvt_pk_bf16_f32 v104, v96, v97
    v_cvt_pk_bf16_f32 v105, v98, v99
    v_mfma_f32_16x16x32_bf16 v[72:75], a[168:171], v[16:19], v[72:75]
    v_cvt_pk_bf16_f32 v106, v100, v101
    v_cvt_pk_bf16_f32 v107, v102, v103
    v_mfma_f32_16x16x32_bf16 v[76:79], a[172:175], v[16:19], v[76:79]
    s_add_u32 s19, s14, 2064384
    s_waitcnt lgkmcnt(2)
    v_mfma_f32_16x16x32_bf16 v[64:67], a[176:179], v[20:23], v[64:67]
    ds_read_b128 v[16:19], v4 offset:28672
    v_mfma_f32_16x16x32_bf16 v[68:71], a[180:183], v[20:23], v[68:71]
    buffer_store_dwordx4 v[104:107], v1, s[28:31], s19 offen sc1
    v_mfma_f32_16x16x32_bf16 v[72:75], a[184:187], v[20:23], v[72:75]
    v_mfma_f32_16x16x32_bf16 v[76:79], a[188:191], v[20:23], v[76:79]
    s_waitcnt lgkmcnt(2)
    v_mfma_f32_16x16x32_bf16 v[64:67], a[192:195], v[24:27], v[64:67]
    ds_read_b128 v[20:23], v4 offset:29696
    v_mfma_f32_16x16x32_bf16 v[68:71], a[196:199], v[24:27], v[68:71]
    v_mfma_f32_16x16x32_bf16 v[72:75], a[200:203], v[24:27], v[72:75]
    v_mfma_f32_16x16x32_bf16 v[76:79], a[204:207], v[24:27], v[76:79]
    s_waitcnt lgkmcnt(2)
    v_mfma_f32_16x16x32_bf16 v[64:67], a[208:211], v[28:31], v[64:67]
    ds_read_b128 v[24:27], v4 offset:30720
    v_mfma_f32_16x16x32_bf16 v[68:71], a[212:215], v[28:31], v[68:71]
    v_mfma_f32_16x16x32_bf16 v[72:75], a[216:219], v[28:31], v[72:75]
    v_mfma_f32_16x16x32_bf16 v[76:79], a[220:223], v[28:31], v[76:79]
    s_waitcnt lgkmcnt(2)
    v_mfma_f32_16x16x32_bf16 v[64:67], a[224:227], v[16:19], v[64:67]
    ds_read_b128 v[28:31], v4 offset:31744
    v_mfma_f32_16x16x32_bf16 v[68:71], a[228:231], v[16:19], v[68:71]
    v_mfma_f32_16x16x32_bf16 v[72:75], a[232:235], v[16:19], v[72:75]
    v_mfma_f32_16x16x32_bf16 v[76:79], a[236:239], v[16:19], v[76:79]
    s_waitcnt lgkmcnt(2)
    v_mfma_f32_16x16x32_bf16 v[64:67], a[240:243], v[20:23], v[64:67]
    s_waitcnt vmcnt(23)
    s_barrier
    ds_read_b128 v[16:19], v4 offset:32768
    v_mfma_f32_16x16x32_bf16 v[68:71], a[244:247], v[20:23], v[68:71]
    v_mfma_f32_16x16x32_bf16 v[72:75], a[248:251], v[20:23], v[72:75]
    s_add_u32 m0, s62, 36864
    s_add_u32 s63, s60, 147456
    buffer_load_dwordx4 v40, s[52:55], s63 offen offset:0 lds
    v_mfma_f32_16x16x32_bf16 v[76:79], a[252:255], v[20:23], v[76:79]
    s_waitcnt lgkmcnt(2)
    v_mfma_f32_16x16x32_bf16 v[64:67], v[224:227], v[24:27], v[64:67]
    ds_read_b128 v[20:23], v4 offset:33792
    v_mfma_f32_16x16x32_bf16 v[68:71], v[228:231], v[24:27], v[68:71]
    v_mfma_f32_16x16x32_bf16 v[72:75], v[232:235], v[24:27], v[72:75]
    buffer_load_dwordx4 v41, s[52:55], s63 offen offset:1024 lds
    v_mfma_f32_16x16x32_bf16 v[76:79], v[236:239], v[24:27], v[76:79]
    s_waitcnt lgkmcnt(2)
    v_mfma_f32_16x16x32_bf16 v[64:67], v[240:243], v[28:31], v[64:67]
    ds_read_b128 v[24:27], v4 offset:34816
    v_mfma_f32_16x16x32_bf16 v[68:71], v[244:247], v[28:31], v[68:71]
    v_mfma_f32_16x16x32_bf16 v[72:75], v[248:251], v[28:31], v[72:75]
    buffer_load_dwordx4 v42, s[52:55], s63 offen offset:2048 lds
    v_mfma_f32_16x16x32_bf16 v[76:79], v[252:255], v[28:31], v[76:79]
    s_waitcnt lgkmcnt(2)
    v_mfma_f32_16x16x32_bf16 v[80:83], a[0:3], v[16:19], 0
    ds_read_b128 v[28:31], v4 offset:35840
    v_mfma_f32_16x16x32_bf16 v[84:87], a[4:7], v[16:19], 0
    v_mfma_f32_16x16x32_bf16 v[88:91], a[8:11], v[16:19], 0
    buffer_load_dwordx4 v43, s[52:55], s63 offen offset:3072 lds
    v_mfma_f32_16x16x32_bf16 v[92:95], a[12:15], v[16:19], 0
    v_mul_f32 v64, s9, v64
    s_waitcnt lgkmcnt(2)
    v_mfma_f32_16x16x32_bf16 v[80:83], a[16:19], v[20:23], v[80:83]
    ds_read_b128 v[16:19], v4 offset:36864
    v_mul_f32 v65, s9, v65
    v_mfma_f32_16x16x32_bf16 v[84:87], a[20:23], v[20:23], v[84:87]
    v_exp_f32 v64, v64
    v_mfma_f32_16x16x32_bf16 v[88:91], a[24:27], v[20:23], v[88:91]
    s_add_u32 m0, s62, 40960
    s_nop 0
    buffer_load_dwordx4 v44, s[52:55], s63 offen offset:0 lds
    v_mfma_f32_16x16x32_bf16 v[92:95], a[28:31], v[20:23], v[92:95]
    v_mul_f32 v66, s9, v66
    s_waitcnt lgkmcnt(2)
    v_mfma_f32_16x16x32_bf16 v[80:83], a[32:35], v[24:27], v[80:83]
    ds_read_b128 v[20:23], v4 offset:37888
    v_add_f32 v64, 1.0, v64
    v_mfma_f32_16x16x32_bf16 v[84:87], a[36:39], v[24:27], v[84:87]
    v_exp_f32 v65, v65
    v_mfma_f32_16x16x32_bf16 v[88:91], a[40:43], v[24:27], v[88:91]
    buffer_load_dwordx4 v45, s[52:55], s63 offen offset:1024 lds
    v_mfma_f32_16x16x32_bf16 v[92:95], a[44:47], v[24:27], v[92:95]
    v_mul_f32 v67, s9, v67
    s_waitcnt lgkmcnt(2)
    v_mfma_f32_16x16x32_bf16 v[80:83], a[48:51], v[28:31], v[80:83]
    ds_read_b128 v[24:27], v4 offset:38912
    v_add_f32 v65, 1.0, v65
    v_mfma_f32_16x16x32_bf16 v[84:87], a[52:55], v[28:31], v[84:87]
    v_exp_f32 v66, v66
    v_mfma_f32_16x16x32_bf16 v[88:91], a[56:59], v[28:31], v[88:91]
    buffer_load_dwordx4 v46, s[52:55], s63 offen offset:2048 lds
    v_mfma_f32_16x16x32_bf16 v[92:95], a[60:63], v[28:31], v[92:95]
    v_mul_f32 v68, s9, v68
    s_waitcnt lgkmcnt(2)
    v_mfma_f32_16x16x32_bf16 v[80:83], a[64:67], v[16:19], v[80:83]
    ds_read_b128 v[28:31], v4 offset:39936
    v_add_f32 v66, 1.0, v66
    v_mfma_f32_16x16x32_bf16 v[84:87], a[68:71], v[16:19], v[84:87]
    v_rcp_f32 v64, v64
    v_mfma_f32_16x16x32_bf16 v[88:91], a[72:75], v[16:19], v[88:91]
    buffer_load_dwordx4 v47, s[52:55], s63 offen offset:3072 lds
    v_mfma_f32_16x16x32_bf16 v[92:95], a[76:79], v[16:19], v[92:95]
    v_mul_f32 v64, v64, v72
    s_waitcnt lgkmcnt(2)
    v_mfma_f32_16x16x32_bf16 v[80:83], a[80:83], v[20:23], v[80:83]
    ds_read_b128 v[16:19], v4 offset:40960
    v_mul_f32 v69, s9, v69
    v_mfma_f32_16x16x32_bf16 v[84:87], a[84:87], v[20:23], v[84:87]
    v_exp_f32 v67, v67
    v_mfma_f32_16x16x32_bf16 v[88:91], a[88:91], v[20:23], v[88:91]
    s_add_u32 m0, s62, 45056
    s_nop 0
    buffer_load_dwordx4 v48, s[52:55], s63 offen offset:0 lds
    v_mfma_f32_16x16x32_bf16 v[92:95], a[92:95], v[20:23], v[92:95]
    v_add_f32 v67, 1.0, v67
    s_waitcnt lgkmcnt(2)
    v_mfma_f32_16x16x32_bf16 v[80:83], a[96:99], v[24:27], v[80:83]
    ds_read_b128 v[20:23], v4 offset:41984
    v_mul_f32 v70, s9, v70
    v_mfma_f32_16x16x32_bf16 v[84:87], a[100:103], v[24:27], v[84:87]
    v_rcp_f32 v65, v65
    v_mfma_f32_16x16x32_bf16 v[88:91], a[104:107], v[24:27], v[88:91]
    v_exp_f32 v68, v68
    v_mfma_f32_16x16x32_bf16 v[92:95], a[108:111], v[24:27], v[92:95]
    v_mul_f32 v65, v65, v73
    s_waitcnt lgkmcnt(2)
    v_mfma_f32_16x16x32_bf16 v[80:83], a[112:115], v[28:31], v[80:83]
    ds_read_b128 v[24:27], v4 offset:43008
    v_add_f32 v68, 1.0, v68
    v_mfma_f32_16x16x32_bf16 v[84:87], a[116:119], v[28:31], v[84:87]
    v_rcp_f32 v66, v66
    v_mfma_f32_16x16x32_bf16 v[88:91], a[120:123], v[28:31], v[88:91]
    v_exp_f32 v69, v69
    v_mfma_f32_16x16x32_bf16 v[92:95], a[124:127], v[28:31], v[92:95]
    v_mul_f32 v66, v66, v74
    s_waitcnt lgkmcnt(2)
    v_mfma_f32_16x16x32_bf16 v[80:83], a[128:131], v[16:19], v[80:83]
    ds_read_b128 v[28:31], v4 offset:44032
    v_mul_f32 v71, s9, v71
    v_mfma_f32_16x16x32_bf16 v[84:87], a[132:135], v[16:19], v[84:87]
    v_rcp_f32 v67, v67
    v_mfma_f32_16x16x32_bf16 v[88:91], a[136:139], v[16:19], v[88:91]
    v_exp_f32 v70, v70
    v_mfma_f32_16x16x32_bf16 v[92:95], a[140:143], v[16:19], v[92:95]
    v_add_f32 v69, 1.0, v69
    s_waitcnt lgkmcnt(2)
    v_mfma_f32_16x16x32_bf16 v[80:83], a[144:147], v[20:23], v[80:83]
    ds_read_b128 v[16:19], v4 offset:45056
    v_mul_f32 v67, v67, v75
    v_mfma_f32_16x16x32_bf16 v[84:87], a[148:151], v[20:23], v[84:87]
    v_rcp_f32 v68, v68
    v_mfma_f32_16x16x32_bf16 v[88:91], a[152:155], v[20:23], v[88:91]
    v_exp_f32 v71, v71
    v_mfma_f32_16x16x32_bf16 v[92:95], a[156:159], v[20:23], v[92:95]
    v_add_f32 v70, 1.0, v70
    s_waitcnt lgkmcnt(2)
    v_mfma_f32_16x16x32_bf16 v[80:83], a[160:163], v[24:27], v[80:83]
    ds_read_b128 v[20:23], v4 offset:46080
    v_mul_f32 v68, v68, v76
    v_mfma_f32_16x16x32_bf16 v[84:87], a[164:167], v[24:27], v[84:87]
    v_rcp_f32 v69, v69
    v_mfma_f32_16x16x32_bf16 v[88:91], a[168:171], v[24:27], v[88:91]
    v_add_f32 v71, 1.0, v71
    v_mul_f32 v69, v69, v77
    v_mfma_f32_16x16x32_bf16 v[92:95], a[172:175], v[24:27], v[92:95]
    v_cvt_pk_bf16_f32 v72, v64, v65
    s_waitcnt lgkmcnt(2)
    v_mfma_f32_16x16x32_bf16 v[80:83], a[176:179], v[28:31], v[80:83]
    ds_read_b128 v[24:27], v4 offset:47104
    v_cvt_pk_bf16_f32 v73, v66, v67
    v_mfma_f32_16x16x32_bf16 v[84:87], a[180:183], v[28:31], v[84:87]
    v_rcp_f32 v70, v70
    v_mfma_f32_16x16x32_bf16 v[88:91], a[184:187], v[28:31], v[88:91]
    v_rcp_f32 v71, v71
    v_mfma_f32_16x16x32_bf16 v[92:95], a[188:191], v[28:31], v[92:95]
    v_mul_f32 v70, v70, v78
    s_waitcnt lgkmcnt(2)
    v_mfma_f32_16x16x32_bf16 v[80:83], a[192:195], v[16:19], v[80:83]
    ds_read_b128 v[28:31], v4 offset:48128
    v_mul_f32 v71, v71, v79
    v_mfma_f32_16x16x32_bf16 v[84:87], a[196:199], v[16:19], v[84:87]
    v_cvt_pk_bf16_f32 v74, v68, v69
    v_cvt_pk_bf16_f32 v75, v70, v71
    v_mfma_f32_16x16x32_bf16 v[88:91], a[200:203], v[16:19], v[88:91]
    s_add_u32 s19, s14, 2211840
    v_mfma_f32_16x16x32_bf16 v[92:95], a[204:207], v[16:19], v[92:95]
    s_waitcnt lgkmcnt(2)
    v_mfma_f32_16x16x32_bf16 v[80:83], a[208:211], v[20:23], v[80:83]
    ds_read_b128 v[16:19], v4 offset:49152
    v_mfma_f32_16x16x32_bf16 v[84:87], a[212:215], v[20:23], v[84:87]
    buffer_store_dwordx4 v[72:75], v1, s[28:31], s19 offen sc1
    v_mfma_f32_16x16x32_bf16 v[88:91], a[216:219], v[20:23], v[88:91]
    v_mfma_f32_16x16x32_bf16 v[92:95], a[220:223], v[20:23], v[92:95]
    s_waitcnt lgkmcnt(2)
    v_mfma_f32_16x16x32_bf16 v[80:83], a[224:227], v[24:27], v[80:83]
    ds_read_b128 v[20:23], v4 offset:50176
    v_mfma_f32_16x16x32_bf16 v[84:87], a[228:231], v[24:27], v[84:87]
    v_mfma_f32_16x16x32_bf16 v[88:91], a[232:235], v[24:27], v[88:91]
    v_mfma_f32_16x16x32_bf16 v[92:95], a[236:239], v[24:27], v[92:95]
    s_waitcnt lgkmcnt(2)
    v_mfma_f32_16x16x32_bf16 v[80:83], a[240:243], v[28:31], v[80:83]
    ds_read_b128 v[24:27], v4 offset:51200
    v_mfma_f32_16x16x32_bf16 v[84:87], a[244:247], v[28:31], v[84:87]
    v_mfma_f32_16x16x32_bf16 v[88:91], a[248:251], v[28:31], v[88:91]
    v_mfma_f32_16x16x32_bf16 v[92:95], a[252:255], v[28:31], v[92:95]
    s_waitcnt lgkmcnt(2)
    v_mfma_f32_16x16x32_bf16 v[80:83], v[224:227], v[16:19], v[80:83]
    ds_read_b128 v[28:31], v4 offset:52224
    v_mfma_f32_16x16x32_bf16 v[84:87], v[228:231], v[16:19], v[84:87]
    v_mfma_f32_16x16x32_bf16 v[88:91], v[232:235], v[16:19], v[88:91]
    v_mfma_f32_16x16x32_bf16 v[92:95], v[236:239], v[16:19], v[92:95]
    s_waitcnt lgkmcnt(2)
    v_mfma_f32_16x16x32_bf16 v[80:83], v[240:243], v[20:23], v[80:83]
    ds_read_b128 v[16:19], v4 offset:53248
    v_mfma_f32_16x16x32_bf16 v[84:87], v[244:247], v[20:23], v[84:87]
    v_mfma_f32_16x16x32_bf16 v[88:91], v[248:251], v[20:23], v[88:91]
    v_mfma_f32_16x16x32_bf16 v[92:95], v[252:255], v[20:23], v[92:95]
    s_waitcnt lgkmcnt(2)
    v_mfma_f32_16x16x32_bf16 v[96:99], a[0:3], v[24:27], 0
    ds_read_b128 v[20:23], v4 offset:54272
    v_mfma_f32_16x16x32_bf16 v[100:103], a[4:7], v[24:27], 0
    v_mfma_f32_16x16x32_bf16 v[104:107], a[8:11], v[24:27], 0
    v_mfma_f32_16x16x32_bf16 v[108:111], a[12:15], v[24:27], 0
    v_mul_f32 v80, s9, v80
    s_waitcnt lgkmcnt(2)
    v_mfma_f32_16x16x32_bf16 v[96:99], a[16:19], v[28:31], v[96:99]
    ds_read_b128 v[24:27], v4 offset:55296
    v_mul_f32 v81, s9, v81
    v_mfma_f32_16x16x32_bf16 v[100:103], a[20:23], v[28:31], v[100:103]
    v_exp_f32 v80, v80
    v_mfma_f32_16x16x32_bf16 v[104:107], a[24:27], v[28:31], v[104:107]
    v_mul_f32 v82, s9, v82
    v_add_f32 v80, 1.0, v80
    v_mfma_f32_16x16x32_bf16 v[108:111], a[28:31], v[28:31], v[108:111]
    v_mul_f32 v83, s9, v83
    s_waitcnt lgkmcnt(2)
    v_mfma_f32_16x16x32_bf16 v[96:99], a[32:35], v[16:19], v[96:99]
    ds_read_b128 v[28:31], v4 offset:56320
    v_mul_f32 v84, s9, v84
    v_mfma_f32_16x16x32_bf16 v[100:103], a[36:39], v[16:19], v[100:103]
    v_exp_f32 v81, v81
    v_mfma_f32_16x16x32_bf16 v[104:107], a[40:43], v[16:19], v[104:107]
    v_exp_f32 v82, v82
    v_mfma_f32_16x16x32_bf16 v[108:111], a[44:47], v[16:19], v[108:111]
    v_add_f32 v81, 1.0, v81
    s_waitcnt lgkmcnt(2)
    v_mfma_f32_16x16x32_bf16 v[96:99], a[48:51], v[20:23], v[96:99]
    s_waitcnt vmcnt(26)
    s_barrier
    ds_read_b128 v[16:19], v4 offset:57344
    v_mfma_f32_16x16x32_bf16 v[100:103], a[52:55], v[20:23], v[100:103]
    v_rcp_f32 v80, v80
    v_mfma_f32_16x16x32_bf16 v[104:107], a[56:59], v[20:23], v[104:107]
    s_add_u32 m0, s62, 73728
    s_add_u32 s63, s60, 294912
    buffer_load_dwordx4 v40, s[52:55], s63 offen offset:0 lds
    v_mfma_f32_16x16x32_bf16 v[108:111], a[60:63], v[20:23], v[108:111]
    v_add_f32 v82, 1.0, v82
    s_waitcnt lgkmcnt(2)
    v_mfma_f32_16x16x32_bf16 v[96:99], a[64:67], v[24:27], v[96:99]
    ds_read_b128 v[20:23], v4 offset:58368
    v_mul_f32 v80, v80, v88
    v_mfma_f32_16x16x32_bf16 v[100:103], a[68:71], v[24:27], v[100:103]
    v_exp_f32 v83, v83
    v_mfma_f32_16x16x32_bf16 v[104:107], a[72:75], v[24:27], v[104:107]
    buffer_load_dwordx4 v41, s[52:55], s63 offen offset:1024 lds
    v_mfma_f32_16x16x32_bf16 v[108:111], a[76:79], v[24:27], v[108:111]
    v_mul_f32 v85, s9, v85
    s_waitcnt lgkmcnt(2)
    v_mfma_f32_16x16x32_bf16 v[96:99], a[80:83], v[28:31], v[96:99]
    ds_read_b128 v[24:27], v4 offset:59392
    v_add_f32 v83, 1.0, v83
    v_mfma_f32_16x16x32_bf16 v[100:103], a[84:87], v[28:31], v[100:103]
    v_rcp_f32 v81, v81
    v_mfma_f32_16x16x32_bf16 v[104:107], a[88:91], v[28:31], v[104:107]
    buffer_load_dwordx4 v42, s[52:55], s63 offen offset:2048 lds
    v_mfma_f32_16x16x32_bf16 v[108:111], a[92:95], v[28:31], v[108:111]
    v_mul_f32 v81, v81, v89
    s_waitcnt lgkmcnt(2)
    v_mfma_f32_16x16x32_bf16 v[96:99], a[96:99], v[16:19], v[96:99]
    ds_read_b128 v[28:31], v4 offset:60416
    v_mul_f32 v86, s9, v86
    v_mfma_f32_16x16x32_bf16 v[100:103], a[100:103], v[16:19], v[100:103]
    v_exp_f32 v84, v84
    v_mfma_f32_16x16x32_bf16 v[104:107], a[104:107], v[16:19], v[104:107]
    buffer_load_dwordx4 v43, s[52:55], s63 offen offset:3072 lds
    v_mfma_f32_16x16x32_bf16 v[108:111], a[108:111], v[16:19], v[108:111]
    v_add_f32 v84, 1.0, v84
    s_waitcnt lgkmcnt(2)
    v_mfma_f32_16x16x32_bf16 v[96:99], a[112:115], v[20:23], v[96:99]
    ds_read_b128 v[16:19], v4 offset:61440
    v_mul_f32 v87, s9, v87
    v_mfma_f32_16x16x32_bf16 v[100:103], a[116:119], v[20:23], v[100:103]
    v_rcp_f32 v82, v82
    v_mfma_f32_16x16x32_bf16 v[104:107], a[120:123], v[20:23], v[104:107]
    s_add_u32 m0, s62, 77824
    s_nop 0
    buffer_load_dwordx4 v44, s[52:55], s63 offen offset:0 lds
    v_mfma_f32_16x16x32_bf16 v[108:111], a[124:127], v[20:23], v[108:111]
    v_mul_f32 v82, v82, v90
    s_waitcnt lgkmcnt(2)
    v_mfma_f32_16x16x32_bf16 v[96:99], a[128:131], v[24:27], v[96:99]
    ds_read_b128 v[20:23], v4 offset:62464
    v_mfma_f32_16x16x32_bf16 v[100:103], a[132:135], v[24:27], v[100:103]
    v_exp_f32 v85, v85
    v_mfma_f32_16x16x32_bf16 v[104:107], a[136:139], v[24:27], v[104:107]
    buffer_load_dwordx4 v45, s[52:55], s63 offen offset:1024 lds
    v_mfma_f32_16x16x32_bf16 v[108:111], a[140:143], v[24:27], v[108:111]
    v_add_f32 v85, 1.0, v85
    s_waitcnt lgkmcnt(2)
    v_mfma_f32_16x16x32_bf16 v[96:99], a[144:147], v[28:31], v[96:99]
    ds_read_b128 v[24:27], v4 offset:63488
    v_mfma_f32_16x16x32_bf16 v[100:103], a[148:151], v[28:31], v[100:103]
    v_rcp_f32 v83, v83
    v_mfma_f32_16x16x32_bf16 v[104:107], a[152:155], v[28:31], v[104:107]
    buffer_load_dwordx4 v46, s[52:55], s63 offen offset:2048 lds
    v_mfma_f32_16x16x32_bf16 v[108:111], a[156:159], v[28:31], v[108:111]
    v_mul_f32 v83, v83, v91
    s_waitcnt lgkmcnt(2)
    v_mfma_f32_16x16x32_bf16 v[96:99], a[160:163], v[16:19], v[96:99]
    ds_read_b128 v[28:31], v4 offset:64512
    v_mfma_f32_16x16x32_bf16 v[100:103], a[164:167], v[16:19], v[100:103]
    v_exp_f32 v86, v86
    v_mfma_f32_16x16x32_bf16 v[104:107], a[168:171], v[16:19], v[104:107]
    buffer_load_dwordx4 v47, s[52:55], s63 offen offset:3072 lds
    v_mfma_f32_16x16x32_bf16 v[108:111], a[172:175], v[16:19], v[108:111]
    v_add_f32 v86, 1.0, v86
    s_waitcnt lgkmcnt(2)
    v_mfma_f32_16x16x32_bf16 v[96:99], a[176:179], v[20:23], v[96:99]
    ds_read_b128 v[16:19], v5 offset:0
    v_cvt_pk_bf16_f32 v88, v80, v81
    v_mfma_f32_16x16x32_bf16 v[100:103], a[180:183], v[20:23], v[100:103]
    v_rcp_f32 v84, v84
    v_mfma_f32_16x16x32_bf16 v[104:107], a[184:187], v[20:23], v[104:107]
    s_add_u32 m0, s62, 81920
    s_nop 0
    buffer_load_dwordx4 v48, s[52:55], s63 offen offset:0 lds
    v_mfma_f32_16x16x32_bf16 v[108:111], a[188:191], v[20:23], v[108:111]
    v_mul_f32 v84, v84, v92
    s_waitcnt lgkmcnt(2)
    v_mfma_f32_16x16x32_bf16 v[96:99], a[192:195], v[24:27], v[96:99]
    ds_read_b128 v[20:23], v5 offset:1024
    v_cvt_pk_bf16_f32 v89, v82, v83
    v_mfma_f32_16x16x32_bf16 v[100:103], a[196:199], v[24:27], v[100:103]
    v_exp_f32 v87, v87
    v_mfma_f32_16x16x32_bf16 v[104:107], a[200:203], v[24:27], v[104:107]
    v_rcp_f32 v85, v85
    v_mfma_f32_16x16x32_bf16 v[108:111], a[204:207], v[24:27], v[108:111]
    v_add_f32 v87, 1.0, v87
    s_waitcnt lgkmcnt(2)
    v_mfma_f32_16x16x32_bf16 v[96:99], a[208:211], v[28:31], v[96:99]
    ds_read_b128 v[24:27], v5 offset:2048
    v_mul_f32 v85, v85, v93
    v_mfma_f32_16x16x32_bf16 v[100:103], a[212:215], v[28:31], v[100:103]
    v_rcp_f32 v86, v86
    v_mfma_f32_16x16x32_bf16 v[104:107], a[216:219], v[28:31], v[104:107]
    v_rcp_f32 v87, v87
    v_mfma_f32_16x16x32_bf16 v[108:111], a[220:223], v[28:31], v[108:111]
    v_mul_f32 v86, v86, v94
    s_waitcnt lgkmcnt(2)
    v_mfma_f32_16x16x32_bf16 v[96:99], a[224:227], v[16:19], v[96:99]
    ds_read_b128 v[28:31], v5 offset:3072
    v_mul_f32 v87, v87, v95
    v_mfma_f32_16x16x32_bf16 v[100:103], a[228:231], v[16:19], v[100:103]
    v_cvt_pk_bf16_f32 v90, v84, v85
    v_cvt_pk_bf16_f32 v91, v86, v87
    v_mfma_f32_16x16x32_bf16 v[104:107], a[232:235], v[16:19], v[104:107]
    s_add_u32 s19, s14, 2359296
    v_mfma_f32_16x16x32_bf16 v[108:111], a[236:239], v[16:19], v[108:111]
    s_waitcnt lgkmcnt(2)
    v_mfma_f32_16x16x32_bf16 v[96:99], a[240:243], v[20:23], v[96:99]
    ds_read_b128 v[16:19], v5 offset:4096
    v_mfma_f32_16x16x32_bf16 v[100:103], a[244:247], v[20:23], v[100:103]
    buffer_store_dwordx4 v[88:91], v1, s[28:31], s19 offen sc1
    v_mfma_f32_16x16x32_bf16 v[104:107], a[248:251], v[20:23], v[104:107]
    v_mfma_f32_16x16x32_bf16 v[108:111], a[252:255], v[20:23], v[108:111]
    s_waitcnt lgkmcnt(2)
    v_mfma_f32_16x16x32_bf16 v[96:99], v[224:227], v[24:27], v[96:99]
    ds_read_b128 v[20:23], v5 offset:5120
    v_mfma_f32_16x16x32_bf16 v[100:103], v[228:231], v[24:27], v[100:103]
    v_mfma_f32_16x16x32_bf16 v[104:107], v[232:235], v[24:27], v[104:107]
    v_mfma_f32_16x16x32_bf16 v[108:111], v[236:239], v[24:27], v[108:111]
    s_waitcnt lgkmcnt(2)
    v_mfma_f32_16x16x32_bf16 v[96:99], v[240:243], v[28:31], v[96:99]
    ds_read_b128 v[24:27], v5 offset:6144
    v_mfma_f32_16x16x32_bf16 v[100:103], v[244:247], v[28:31], v[100:103]
    v_mfma_f32_16x16x32_bf16 v[104:107], v[248:251], v[28:31], v[104:107]
    v_mfma_f32_16x16x32_bf16 v[108:111], v[252:255], v[28:31], v[108:111]
    s_waitcnt lgkmcnt(2)
    v_mfma_f32_16x16x32_bf16 v[64:67], a[0:3], v[16:19], 0
    ds_read_b128 v[28:31], v5 offset:7168
    v_mfma_f32_16x16x32_bf16 v[68:71], a[4:7], v[16:19], 0
    v_mfma_f32_16x16x32_bf16 v[72:75], a[8:11], v[16:19], 0
    v_mfma_f32_16x16x32_bf16 v[76:79], a[12:15], v[16:19], 0
    v_mul_f32 v96, s9, v96
    s_waitcnt lgkmcnt(2)
    v_mfma_f32_16x16x32_bf16 v[64:67], a[16:19], v[20:23], v[64:67]
    ds_read_b128 v[16:19], v5 offset:8192
    v_mul_f32 v97, s9, v97
    v_mfma_f32_16x16x32_bf16 v[68:71], a[20:23], v[20:23], v[68:71]
    v_exp_f32 v96, v96
    v_mfma_f32_16x16x32_bf16 v[72:75], a[24:27], v[20:23], v[72:75]
    v_mul_f32 v98, s9, v98
    v_add_f32 v96, 1.0, v96
    v_mfma_f32_16x16x32_bf16 v[76:79], a[28:31], v[20:23], v[76:79]
    v_mul_f32 v99, s9, v99
    s_waitcnt lgkmcnt(2)
    v_mfma_f32_16x16x32_bf16 v[64:67], a[32:35], v[24:27], v[64:67]
    ds_read_b128 v[20:23], v5 offset:9216
    v_mul_f32 v100, s9, v100
    v_mfma_f32_16x16x32_bf16 v[68:71], a[36:39], v[24:27], v[68:71]
    v_exp_f32 v97, v97
    v_mfma_f32_16x16x32_bf16 v[72:75], a[40:43], v[24:27], v[72:75]
    v_exp_f32 v98, v98
    v_mfma_f32_16x16x32_bf16 v[76:79], a[44:47], v[24:27], v[76:79]
    v_add_f32 v97, 1.0, v97
    s_waitcnt lgkmcnt(2)
    v_mfma_f32_16x16x32_bf16 v[64:67], a[48:51], v[28:31], v[64:67]
    ds_read_b128 v[24:27], v5 offset:10240
    v_add_f32 v98, 1.0, v98
    v_mfma_f32_16x16x32_bf16 v[68:71], a[52:55], v[28:31], v[68:71]
    v_rcp_f32 v96, v96
    v_mfma_f32_16x16x32_bf16 v[72:75], a[56:59], v[28:31], v[72:75]
    v_exp_f32 v99, v99
    v_mfma_f32_16x16x32_bf16 v[76:79], a[60:63], v[28:31], v[76:79]
    v_mul_f32 v96, v96, v104
    s_waitcnt lgkmcnt(2)
    v_mfma_f32_16x16x32_bf16 v[64:67], a[64:67], v[16:19], v[64:67]
    ds_read_b128 v[28:31], v5 offset:11264
    v_mul_f32 v101, s9, v101
    v_mfma_f32_16x16x32_bf16 v[68:71], a[68:71], v[16:19], v[68:71]
    v_rcp_f32 v97, v97
    v_mfma_f32_16x16x32_bf16 v[72:75], a[72:75], v[16:19], v[72:75]
    v_exp_f32 v100, v100
    v_mfma_f32_16x16x32_bf16 v[76:79], a[76:79], v[16:19], v[76:79]
    v_add_f32 v99, 1.0, v99
    s_waitcnt lgkmcnt(2)
    v_mfma_f32_16x16x32_bf16 v[64:67], a[80:83], v[20:23], v[64:67]
    ds_read_b128 v[16:19], v5 offset:12288
    v_mul_f32 v97, v97, v105
    v_mfma_f32_16x16x32_bf16 v[68:71], a[84:87], v[20:23], v[68:71]
    v_rcp_f32 v98, v98
    v_mfma_f32_16x16x32_bf16 v[72:75], a[88:91], v[20:23], v[72:75]
    v_mul_f32 v102, s9, v102
    v_add_f32 v100, 1.0, v100
    v_mfma_f32_16x16x32_bf16 v[76:79], a[92:95], v[20:23], v[76:79]
    v_mul_f32 v98, v98, v106
    s_waitcnt lgkmcnt(2)
    v_mfma_f32_16x16x32_bf16 v[64:67], a[96:99], v[24:27], v[64:67]
    ds_read_b128 v[20:23], v5 offset:13312
    v_mul_f32 v103, s9, v103
    v_mfma_f32_16x16x32_bf16 v[68:71], a[100:103], v[24:27], v[68:71]
    v_exp_f32 v101, v101
    v_mfma_f32_16x16x32_bf16 v[72:75], a[104:107], v[24:27], v[72:75]
    v_rcp_f32 v99, v99
    v_mfma_f32_16x16x32_bf16 v[76:79], a[108:111], v[24:27], v[76:79]
    v_add_f32 v101, 1.0, v101
    s_waitcnt lgkmcnt(2)
    v_mfma_f32_16x16x32_bf16 v[64:67], a[112:115], v[28:31], v[64:67]
    ds_read_b128 v[24:27], v5 offset:14336
    v_mul_f32 v99, v99, v107
    v_mfma_f32_16x16x32_bf16 v[68:71], a[116:119], v[28:31], v[68:71]
    v_exp_f32 v102, v102
    v_mfma_f32_16x16x32_bf16 v[72:75], a[120:123], v[28:31], v[72:75]
    v_rcp_f32 v100, v100
    v_mfma_f32_16x16x32_bf16 v[76:79], a[124:127], v[28:31], v[76:79]
    v_add_f32 v102, 1.0, v102
    s_waitcnt lgkmcnt(2)
    v_mfma_f32_16x16x32_bf16 v[64:67], a[128:131], v[16:19], v[64:67]
    ds_read_b128 v[28:31], v5 offset:15360
    v_mul_f32 v100, v100, v108
    v_mfma_f32_16x16x32_bf16 v[68:71], a[132:135], v[16:19], v[68:71]
    v_exp_f32 v103, v103
    v_mfma_f32_16x16x32_bf16 v[72:75], a[136:139], v[16:19], v[72:75]
    v_rcp_f32 v101, v101
    v_mfma_f32_16x16x32_bf16 v[76:79], a[140:143], v[16:19], v[76:79]
    v_add_f32 v103, 1.0, v103
    s_waitcnt lgkmcnt(2)
    v_mfma_f32_16x16x32_bf16 v[64:67], a[144:147], v[20:23], v[64:67]
    s_waitcnt vmcnt(33)
    s_barrier
    ds_read_b128 v[16:19], v5 offset:16384
    v_mfma_f32_16x16x32_bf16 v[68:71], a[148:151], v[20:23], v[68:71]
    v_rcp_f32 v102, v102
    v_mfma_f32_16x16x32_bf16 v[72:75], a[152:155], v[20:23], v[72:75]
    v_mul_f32 v101, v101, v109
    v_mul_f32 v102, v102, v110
    v_mfma_f32_16x16x32_bf16 v[76:79], a[156:159], v[20:23], v[76:79]
    v_cvt_pk_bf16_f32 v104, v96, v97
    s_waitcnt lgkmcnt(2)
    v_mfma_f32_16x16x32_bf16 v[64:67], a[160:163], v[24:27], v[64:67]
    ds_read_b128 v[20:23], v5 offset:17408
    v_cvt_pk_bf16_f32 v105, v98, v99
    v_mfma_f32_16x16x32_bf16 v[68:71], a[164:167], v[24:27], v[68:71]
    v_rcp_f32 v103, v103
    v_mfma_f32_16x16x32_bf16 v[72:75], a[168:171], v[24:27], v[72:75]
    v_mul_f32 v103, v103, v111
    v_cvt_pk_bf16_f32 v106, v100, v101
    v_mfma_f32_16x16x32_bf16 v[76:79], a[172:175], v[24:27], v[76:79]
    v_cvt_pk_bf16_f32 v107, v102, v103
    s_waitcnt lgkmcnt(2)
    v_mfma_f32_16x16x32_bf16 v[64:67], a[176:179], v[28:31], v[64:67]
    ds_read_b128 v[24:27], v5 offset:18432
    s_add_u32 s19, s14, 2506752
    v_mfma_f32_16x16x32_bf16 v[68:71], a[180:183], v[28:31], v[68:71]
    buffer_store_dwordx4 v[104:107], v1, s[28:31], s19 offen sc1
    v_mfma_f32_16x16x32_bf16 v[72:75], a[184:187], v[28:31], v[72:75]
    v_mfma_f32_16x16x32_bf16 v[76:79], a[188:191], v[28:31], v[76:79]
    s_waitcnt lgkmcnt(2)
    v_mfma_f32_16x16x32_bf16 v[64:67], a[192:195], v[16:19], v[64:67]
    ds_read_b128 v[28:31], v5 offset:19456
    v_mfma_f32_16x16x32_bf16 v[68:71], a[196:199], v[16:19], v[68:71]
    v_mfma_f32_16x16x32_bf16 v[72:75], a[200:203], v[16:19], v[72:75]
    v_mfma_f32_16x16x32_bf16 v[76:79], a[204:207], v[16:19], v[76:79]
    s_waitcnt lgkmcnt(2)
    v_mfma_f32_16x16x32_bf16 v[64:67], a[208:211], v[20:23], v[64:67]
    ds_read_b128 v[16:19], v5 offset:20480
    v_mfma_f32_16x16x32_bf16 v[68:71], a[212:215], v[20:23], v[68:71]
    v_mfma_f32_16x16x32_bf16 v[72:75], a[216:219], v[20:23], v[72:75]
    v_mfma_f32_16x16x32_bf16 v[76:79], a[220:223], v[20:23], v[76:79]
    s_waitcnt lgkmcnt(2)
    v_mfma_f32_16x16x32_bf16 v[64:67], a[224:227], v[24:27], v[64:67]
    ds_read_b128 v[20:23], v5 offset:21504
    v_mfma_f32_16x16x32_bf16 v[68:71], a[228:231], v[24:27], v[68:71]
    v_mfma_f32_16x16x32_bf16 v[72:75], a[232:235], v[24:27], v[72:75]
    v_mfma_f32_16x16x32_bf16 v[76:79], a[236:239], v[24:27], v[76:79]
    s_waitcnt lgkmcnt(2)
    v_mfma_f32_16x16x32_bf16 v[64:67], a[240:243], v[28:31], v[64:67]
    v_mfma_f32_16x16x32_bf16 v[68:71], a[244:247], v[28:31], v[68:71]
    v_mfma_f32_16x16x32_bf16 v[72:75], a[248:251], v[28:31], v[72:75]
    v_mfma_f32_16x16x32_bf16 v[76:79], a[252:255], v[28:31], v[76:79]
    s_waitcnt lgkmcnt(1)
    v_mfma_f32_16x16x32_bf16 v[64:67], v[224:227], v[16:19], v[64:67]
    v_mfma_f32_16x16x32_bf16 v[68:71], v[228:231], v[16:19], v[68:71]
    v_mfma_f32_16x16x32_bf16 v[72:75], v[232:235], v[16:19], v[72:75]
    v_mfma_f32_16x16x32_bf16 v[76:79], v[236:239], v[16:19], v[76:79]
    s_waitcnt lgkmcnt(0)
    v_mfma_f32_16x16x32_bf16 v[64:67], v[240:243], v[20:23], v[64:67]
    v_mfma_f32_16x16x32_bf16 v[68:71], v[244:247], v[20:23], v[68:71]
    v_mfma_f32_16x16x32_bf16 v[72:75], v[248:251], v[20:23], v[72:75]
    v_mfma_f32_16x16x32_bf16 v[76:79], v[252:255], v[20:23], v[76:79]
    s_nop 4
    v_mul_f32 v64, s9, v64
    v_mul_f32 v65, s9, v65
    v_exp_f32 v64, v64
    v_mul_f32 v66, s9, v66
    v_exp_f32 v65, v65
    v_add_f32 v64, 1.0, v64
    v_mul_f32 v67, s9, v67
    v_exp_f32 v66, v66
    v_add_f32 v65, 1.0, v65
    v_rcp_f32 v64, v64
    v_mul_f32 v68, s9, v68
    v_exp_f32 v67, v67
    v_add_f32 v66, 1.0, v66
    v_rcp_f32 v65, v65
    v_mul_f32 v64, v64, v72
    v_mul_f32 v69, s9, v69
    v_exp_f32 v68, v68
    v_add_f32 v67, 1.0, v67
    v_rcp_f32 v66, v66
    v_mul_f32 v65, v65, v73
    v_mul_f32 v70, s9, v70
    v_exp_f32 v69, v69
    v_add_f32 v68, 1.0, v68
    v_rcp_f32 v67, v67
    v_mul_f32 v66, v66, v74
    v_mul_f32 v71, s9, v71
    v_exp_f32 v70, v70
    v_add_f32 v69, 1.0, v69
    v_rcp_f32 v68, v68
    v_mul_f32 v67, v67, v75
    v_exp_f32 v71, v71
    v_add_f32 v70, 1.0, v70
    v_rcp_f32 v69, v69
    v_mul_f32 v68, v68, v76
    v_add_f32 v71, 1.0, v71
    v_rcp_f32 v70, v70
    v_mul_f32 v69, v69, v77
    v_rcp_f32 v71, v71
    v_mul_f32 v70, v70, v78
    v_mul_f32 v71, v71, v79
    v_cvt_pk_bf16_f32 v72, v64, v65
    v_cvt_pk_bf16_f32 v73, v66, v67
    v_cvt_pk_bf16_f32 v74, v68, v69
    v_cvt_pk_bf16_f32 v75, v70, v71
    s_add_u32 s19, s14, 2654208
    buffer_store_dwordx4 v[72:75], v1, s[28:31], s19 offen sc1
    s_mul_i32 s15, s47, 36
    s_add_u32 s15, s15, s5
    s_lshl_b32 s15, s15, 7
    s_add_u32 s15, s15, 32768
    s_cmp_lg_u32 s3, 0
    s_cselect_b32 s15, 720896, s15
    s_waitcnt vmcnt(0) lgkmcnt(0)
    s_barrier
    buffer_store_dwordx4 v[216:219], v220, s[56:59], s15 offen sc1
    s_branch KB_G2
KB_IDLE:
    s_lshr_b32 s60, s4, 6
    s_mul_i32 s60, s60, 36
    s_add_u32 s60, s60, s3
    s_mul_i32 s60, s60, 36864
    s_and_b32 s62, s4, 3
    s_mul_i32 s62, s62, 288
    s_add_u32 s60, s60, s62
    s_mul_i32 s62, s3, 9216
    s_mov_b32 s54, 5308416
    s_mov_b32 s55, 0x00020000
    s_and_b32 s12, s4, 31
    s_lshl_b32 s12, s12, 2
    s_add_u32 s12, s12, s3
    s_mul_i32 s12, s12, 84*128
    s_lshr_b32 s13, s4, 6
    s_mul_i32 s13, s13, 1327104
    s_add_u32 s12, s12, s13
    s_add_u32 s13, s12, 42*128
    s_mov_b32 s34, TEXT_END-KB_G2
    s_mov_b32 s35, 0x00020000
    s_and_b32 s36, s4, 31
    s_lshl_b32 s36, s36, 2
    s_add_u32 s36, s36, s3
    s_mul_i32 s36, s36, 14*128
    v_cmp_gt_u32 vcc, 14, v8
    v_lshlrev_b32 v49, 7, v8
    s_nop 0
    v_cndmask_b32 v49, 2.0, v49, vcc
    v_add_u32 v50, 0, v8
    v_mul_u32_u24 v51, 3641, v50
    v_lshrrev_b32 v51, 16, v51
    v_mul_u32_u24 v51, 864, v51
    v_lshl_add_u32 v40, v50, 4, v51
    v_add_u32 v50, 64, v8
    v_mul_u32_u24 v51, 3641, v50
    v_lshrrev_b32 v51, 16, v51
    v_mul_u32_u24 v51, 864, v51
    v_lshl_add_u32 v41, v50, 4, v51
    v_subrev_u32 v41, 1024, v41
    v_add_u32 v50, 128, v8
    v_mul_u32_u24 v51, 3641, v50
    v_lshrrev_b32 v51, 16, v51
    v_mul_u32_u24 v51, 864, v51
    v_lshl_add_u32 v42, v50, 4, v51
    v_subrev_u32 v42, 2048, v42
    v_add_u32 v50, 192, v8
    v_mul_u32_u24 v51, 3641, v50
    v_lshrrev_b32 v51, 16, v51
    v_mul_u32_u24 v51, 864, v51
    v_lshl_add_u32 v43, v50, 4, v51
    v_subrev_u32 v43, 3072, v43
    v_add_u32 v50, 256, v8
    v_mul_u32_u24 v51, 3641, v50
    v_lshrrev_b32 v51, 16, v51
    v_mul_u32_u24 v51, 864, v51
    v_lshl_add_u32 v44, v50, 4, v51
    v_add_u32 v50, 320, v8
    v_mul_u32_u24 v51, 3641, v50
    v_lshrrev_b32 v51, 16, v51
    v_mul_u32_u24 v51, 864, v51
    v_lshl_add_u32 v45, v50, 4, v51
    v_subrev_u32 v45, 1024, v45
    v_add_u32 v50, 384, v8
    v_mul_u32_u24 v51, 3641, v50
    v_lshrrev_b32 v51, 16, v51
    v_mul_u32_u24 v51, 864, v51
    v_lshl_add_u32 v46, v50, 4, v51
    v_subrev_u32 v46, 2048, v46
    v_add_u32 v50, 448, v8
    v_mul_u32_u24 v51, 3641, v50
    v_lshrrev_b32 v51, 16, v51
    v_mul_u32_u24 v51, 864, v51
    v_lshl_add_u32 v47, v50, 4, v51
    v_subrev_u32 v47, 3072, v47
    v_add_u32 v50, 512, v8
    v_mul_u32_u24 v51, 3641, v50
    v_lshrrev_b32 v51, 16, v51
    v_mul_u32_u24 v51, 864, v51
    v_lshl_add_u32 v48, v50, 4, v51
    s_add_u32 m0, s62, 0
    s_add_u32 s63, s60, 0
    buffer_load_dwordx4 v40, s[52:55], s63 offen offset:0 lds
    buffer_load_dwordx4 v41, s[52:55], s63 offen offset:1024 lds
    buffer_load_dwordx4 v42, s[52:55], s63 offen offset:2048 lds
    buffer_load_dwordx4 v43, s[52:55], s63 offen offset:3072 lds
    s_add_u32 m0, s62, 4096
    s_nop 0
    buffer_load_dwordx4 v44, s[52:55], s63 offen offset:0 lds
    buffer_load_dwordx4 v45, s[52:55], s63 offen offset:1024 lds
    buffer_load_dwordx4 v46, s[52:55], s63 offen offset:2048 lds
    buffer_load_dwordx4 v47, s[52:55], s63 offen offset:3072 lds
    s_add_u32 m0, s62, 8192
    s_nop 0
    buffer_load_dwordx4 v48, s[52:55], s63 offen offset:0 lds
    s_add_u32 m0, s62, 36864
    s_add_u32 s63, s60, 147456
    buffer_load_dwordx4 v40, s[52:55], s63 offen offset:0 lds
    buffer_load_dwordx4 v41, s[52:55], s63 offen offset:1024 lds
    buffer_load_dwordx4 v42, s[52:55], s63 offen offset:2048 lds
    buffer_load_dwordx4 v43, s[52:55], s63 offen offset:3072 lds
    s_add_u32 m0, s62, 40960
    s_nop 0
    buffer_load_dwordx4 v44, s[52:55], s63 offen offset:0 lds
    buffer_load_dwordx4 v45, s[52:55], s63 offen offset:1024 lds
    buffer_load_dwordx4 v46, s[52:55], s63 offen offset:2048 lds
    buffer_load_dwordx4 v47, s[52:55], s63 offen offset:3072 lds
    s_add_u32 m0, s62, 45056
    s_nop 0
    buffer_load_dwordx4 v48, s[52:55], s63 offen offset:0 lds
    s_add_u32 m0, s62, 73728
    s_add_u32 s63, s60, 294912
    buffer_load_dwordx4 v40, s[52:55], s63 offen offset:0 lds
    buffer_load_dwordx4 v41, s[52:55], s63 offen offset:1024 lds
    buffer_load_dwordx4 v42, s[52:55], s63 offen offset:2048 lds
    buffer_load_dwordx4 v43, s[52:55], s63 offen offset:3072 lds
    s_add_u32 m0, s62, 77824
    s_nop 0
    buffer_load_dwordx4 v44, s[52:55], s63 offen offset:0 lds
    buffer_load_dwordx4 v45, s[52:55], s63 offen offset:1024 lds
    buffer_load_dwordx4 v46, s[52:55], s63 offen offset:2048 lds
    buffer_load_dwordx4 v47, s[52:55], s63 offen offset:3072 lds
    s_add_u32 m0, s62, 81920
    s_nop 0
    buffer_load_dwordx4 v48, s[52:55], s63 offen offset:0 lds
KB_G2:
    s_add_u32 m0, s62, 110592
    s_add_u32 s63, s60, 442368
    buffer_load_dwordx4 v40, s[52:55], s63 offen offset:0 lds
    buffer_load_dwordx4 v41, s[52:55], s63 offen offset:1024 lds
    buffer_load_dwordx4 v42, s[52:55], s63 offen offset:2048 lds
    buffer_load_dwordx4 v43, s[52:55], s63 offen offset:3072 lds
    s_add_u32 m0, s62, 114688
    s_nop 0
    buffer_load_dwordx4 v44, s[52:55], s63 offen offset:0 lds
    buffer_load_dwordx4 v45, s[52:55], s63 offen offset:1024 lds
    buffer_load_dwordx4 v46, s[52:55], s63 offen offset:2048 lds
    buffer_load_dwordx4 v47, s[52:55], s63 offen offset:3072 lds
    s_add_u32 m0, s62, 118784
    s_nop 0
    buffer_load_dwordx4 v48, s[52:55], s63 offen offset:0 lds
    s_load_dwordx2 s[44:45], s[0:1], 96
    s_lshr_b32 s5, s4, 6
    s_bfe_u32 s6, s4, 0x40002
    s_and_b32 s7, s4, 3
    s_lshl_b32 s13, s6, 3
    s_lshl_b32 s14, s3, 1
    s_add_u32 s13, s13, s14
    s_mul_i32 s14, s13, 147456
    s_mul_i32 s8, s5, 36864
    s_add_u32 s14, s14, s8
    s_lshl_b32 s8, s4, 2
    s_add_u32 s8, s8, s3
    s_mul_i32 s8, s8, 9216
    v_add_u32 v2, 147456, v1
    s_mul_i32 s12, s6, 56
    s_add_u32 s15, s12, 6
    s_lshr_b32 s15, s15, 7
    s_add_u32 s12, s12, 55
    s_lshr_b32 s12, s12, 7
    s_sub_u32 s12, s12, s15
    s_mul_i32 s12, s12, 36*128
    s_lshl_b32 s15, s15, 2
    s_add_u32 s15, s15, s5
    s_mul_i32 s15, s15, 9*128
    s_add_u32 s15, s15, 32768
    v_and_b32 v6, 15, v8
    v_lshrrev_b32 v7, 4, v8
    v_cmp_gt_u32 vcc, 9, v6
    v_lshlrev_b32 v6, 7, v6
    v_mad_u32_u24 v6, v7, s12, v6
    v_cndmask_b32 v6, 2.0, v6, vcc
    v_cmp_gt_u32 vcc, 32, v8
    v_lshrrev_b32 v3, 2, v8
    v_mul_u32_u24 v3, 288, v3
    v_cndmask_b32 v6, 2.0, v6, vcc
    v_and_b32 v4, 3, v8
    v_lshl_add_u32 v3, v4, 3, v3
    v_add_u32 v4, 55296, v3
    v_add_u32 v5, 110592, v3
    s_add_u32 s24, s10, 0x1c00000
    s_addc_u32 s25, s11, 0
    s_mov_b32 s26, 0x1200000
    s_mov_b32 s27, 0x00020000
    s_add_u32 s28, s10, 0x2e00000
    s_addc_u32 s29, s11, 0
    s_mov_b32 s30, 0x900000
    s_mov_b32 s31, 0x00020000
    s_lshl_b32 s41, s6, 7
    s_lshl_b32 s42, s5, 5
    s_add_u32 s41, s41, s42
    s_mul_i32 s41, s41, 1152
    s_mul_i32 s42, s7, 288
    s_add_u32 s41, s41, s42
    s_lshl_b32 s39, s3, 6
    s_add_u32 s36, s39, s41
    s_add_u32 s37, s36, 18432
    s_add_u32 s38, s41, 256
    s_add_u32 s39, s39, s42
    s_add_u32 s40, s42, 256
    v_bfe_u32 v12, v8, 4, 1
    v_bfe_u32 v13, v8, 5, 1
    v_and_b32 v14, 15, v8
    v_mul_u32_u24 v14, 1152, v14
    v_lshl_add_u32 v14, v13, 4, v14
    v_lshl_add_u32 v9, v12, 5, v14
    v_mul_u32_u24 v10, 18432, v12
    v_add_u32 v10, v10, v14
    v_lshlrev_b32 v13, 4, v13
    v_lshl_add_u32 v12, v12, 5, v13
    s_add_u32 s20, s10, 0x720000
    s_addc_u32 s21, s11, 0
    s_mov_b32 s22, 0x240000
    s_mov_b32 s23, 0x00020000
    s_add_u32 s32, s10, 0x4b1680
    s_addc_u32 s33, s11, 0
    s_mov_b32 s34, 0x480
    s_mov_b32 s35, 0x00020000
    s_cmp_eq_u32 s3, s5
    s_cselect_b32 s46, 2.0, s8
    s_mov_b32 s49, 147456
    s_cselect_b32 s49, s49, 36864
    s_add_u32 s47, s46, 4096
    s_add_u32 s48, s46, 8192
    v_add_u32 v15, s49, v1
    s_waitcnt lgkmcnt(0)
    s_cmp_lg_u32 s3, 0
    s_cbranch_scc1 KB_P2_X
    s_mov_b32 s19, 0
KB_P2:
    buffer_load_dword v16, v6, s[56:59], s15 offen sc1
    s_add_u32 s19, s19, 1
    s_waitcnt vmcnt(0)
    v_cmp_eq_u32 vcc, s51, v16
    s_cmp_gt_u32 s19, 0x40000
    s_cbranch_scc1 KB_P2_X
    s_bcnt1_i32_b64 s61, vcc
    s_cmp_lt_u32 s61, 18
    s_cbranch_scc1 KB_P2
KB_P2_X:
    s_waitcnt vmcnt(0)
    s_barrier
    s_add_u32 s18, s14, 0
    buffer_load_dwordx4 a[0:3], v1, s[24:27], s18 offen offset:0
    buffer_load_dwordx4 a[4:7], v2, s[24:27], s18 offen offset:0
    buffer_load_dwordx4 a[8:11], v1, s[24:27], s18 offen offset:1024
    buffer_load_dwordx4 a[12:15], v2, s[24:27], s18 offen offset:1024
    buffer_load_dwordx4 a[16:19], v1, s[24:27], s18 offen offset:2048
    buffer_load_dwordx4 a[20:23], v2, s[24:27], s18 offen offset:2048
    buffer_load_dwordx4 a[24:27], v1, s[24:27], s18 offen offset:3072
    buffer_load_dwordx4 a[28:31], v2, s[24:27], s18 offen offset:3072
    s_add_u32 s18, s14, 4096
    buffer_load_dwordx4 a[32:35], v1, s[24:27], s18 offen offset:0
    buffer_load_dwordx4 a[36:39], v2, s[24:27], s18 offen offset:0
    buffer_load_dwordx4 a[40:43], v1, s[24:27], s18 offen offset:1024
    buffer_load_dwordx4 a[44:47], v2, s[24:27], s18 offen offset:1024
    buffer_load_dwordx4 a[48:51], v1, s[24:27], s18 offen offset:2048
    buffer_load_dwordx4 a[52:55], v2, s[24:27], s18 offen offset:2048
    buffer_load_dwordx4 a[56:59], v1, s[24:27], s18 offen offset:3072
    buffer_load_dwordx4 a[60:63], v2, s[24:27], s18 offen offset:3072
    ds_read_b64_tr_b16 v[16:17], v3 offset:0
    ds_read_b64_tr_b16 v[18:19], v3 offset:4608
    ds_read_b64_tr_b16 v[20:21], v3 offset:32
    ds_read_b64_tr_b16 v[22:23], v3 offset:4640
    ds_read_b64_tr_b16 v[24:25], v3 offset:64
    ds_read_b64_tr_b16 v[26:27], v3 offset:4672
    ds_read_b64_tr_b16 v[28:29], v3 offset:96
    ds_read_b64_tr_b16 v[30:31], v3 offset:4704
    ds_read_b64_tr_b16 v[32:33], v3 offset:128
    ds_read_b64_tr_b16 v[34:35], v3 offset:4736
    s_waitcnt vmcnt(14) lgkmcnt(6)
    v_mfma_f32_16x16x32_bf16 v[124:127], v[16:19], a[0:3], 0
    ds_read_b64_tr_b16 v[36:37], v3 offset:160
    v_mfma_f32_16x16x32_bf16 v[160:163], v[16:19], a[4:7], 0
    ds_read_b64_tr_b16 v[38:39], v3 offset:4768
    v_mfma_f32_16x16x32_bf16 v[128:131], v[20:23], a[0:3], 0
    ds_read_b64_tr_b16 v[16:17], v3 offset:192
    v_mfma_f32_16x16x32_bf16 v[164:167], v[20:23], a[4:7], 0
    ds_read_b64_tr_b16 v[18:19], v3 offset:4800
    s_waitcnt lgkmcnt(6)
    v_mfma_f32_16x16x32_bf16 v[132:135], v[24:27], a[0:3], 0
    ds_read_b64_tr_b16 v[20:21], v3 offset:224
    ds_read_b64_tr_b16 v[22:23], v3 offset:4832
    v_mfma_f32_16x16x32_bf16 v[168:171], v[24:27], a[4:7], 0
    s_add_u32 s18, s14, 8192
    buffer_load_dwordx4 a[64:67], v1, s[24:27], s18 offen offset:0
    v_mfma_f32_16x16x32_bf16 v[136:139], v[28:31], a[0:3], 0
    ds_read_b64_tr_b16 v[24:25], v3 offset:256
    v_mfma_f32_16x16x32_bf16 v[172:175], v[28:31], a[4:7], 0
    ds_read_b64_tr_b16 v[26:27], v3 offset:4864
    s_waitcnt lgkmcnt(6)
    v_mfma_f32_16x16x32_bf16 v[140:143], v[32:35], a[0:3], 0
    ds_read_b64_tr_b16 v[28:29], v3 offset:9216
    v_mfma_f32_16x16x32_bf16 v[176:179], v[32:35], a[4:7], 0
    ds_read_b64_tr_b16 v[30:31], v3 offset:13824
    v_mfma_f32_16x16x32_bf16 v[144:147], v[36:39], a[0:3], 0
    ds_read_b64_tr_b16 v[32:33], v3 offset:9248
    v_mfma_f32_16x16x32_bf16 v[180:183], v[36:39], a[4:7], 0
    ds_read_b64_tr_b16 v[34:35], v3 offset:13856
    s_waitcnt lgkmcnt(6)
    v_mfma_f32_16x16x32_bf16 v[148:151], v[16:19], a[0:3], 0
    ds_read_b64_tr_b16 v[36:37], v3 offset:9280
    ds_read_b64_tr_b16 v[38:39], v3 offset:13888
    v_mfma_f32_16x16x32_bf16 v[184:187], v[16:19], a[4:7], 0
    buffer_load_dwordx4 a[68:71], v2, s[24:27], s18 offen offset:0
    v_mfma_f32_16x16x32_bf16 v[152:155], v[20:23], a[0:3], 0
    ds_read_b64_tr_b16 v[16:17], v3 offset:9312
    v_mfma_f32_16x16x32_bf16 v[188:191], v[20:23], a[4:7], 0
    ds_read_b64_tr_b16 v[18:19], v3 offset:13920
    s_waitcnt vmcnt(14) lgkmcnt(6)
    v_mfma_f32_16x16x32_bf16 v[156:159], v[24:27], a[0:3], 0
    ds_read_b64_tr_b16 v[20:21], v3 offset:9344
    ds_read_b64_tr_b16 v[22:23], v3 offset:13952
    v_mfma_f32_16x16x32_bf16 v[192:195], v[24:27], a[4:7], 0
    buffer_load_dwordx4 a[72:75], v1, s[24:27], s18 offen offset:1024
    v_mfma_f32_16x16x32_bf16 v[124:127], v[28:31], a[8:11], v[124:127]
    ds_read_b64_tr_b16 v[24:25], v3 offset:9376
    v_mfma_f32_16x16x32_bf16 v[160:163], v[28:31], a[12:15], v[160:163]
    ds_read_b64_tr_b16 v[26:27], v3 offset:13984
    s_waitcnt lgkmcnt(6)
    v_mfma_f32_16x16x32_bf16 v[128:131], v[32:35], a[8:11], v[128:131]
    ds_read_b64_tr_b16 v[28:29], v3 offset:9408
    ds_read_b64_tr_b16 v[30:31], v3 offset:14016
    v_mfma_f32_16x16x32_bf16 v[164:167], v[32:35], a[12:15], v[164:167]
    buffer_load_dwordx4 a[76:79], v2, s[24:27], s18 offen offset:1024
    v_mfma_f32_16x16x32_bf16 v[132:135], v[36:39], a[8:11], v[132:135]
    ds_read_b64_tr_b16 v[32:33], v3 offset:9440
    v_mfma_f32_16x16x32_bf16 v[168:171], v[36:39], a[12:15], v[168:171]
    ds_read_b64_tr_b16 v[34:35], v3 offset:14048
    s_waitcnt lgkmcnt(6)
    v_mfma_f32_16x16x32_bf16 v[136:139], v[16:19], a[8:11], v[136:139]
    ds_read_b64_tr_b16 v[36:37], v3 offset:9472
    v_mfma_f32_16x16x32_bf16 v[172:175], v[16:19], a[12:15], v[172:175]
    ds_read_b64_tr_b16 v[38:39], v3 offset:14080
    v_mfma_f32_16x16x32_bf16 v[140:143], v[20:23], a[8:11], v[140:143]
    ds_read_b64_tr_b16 v[16:17], v3 offset:18432
    v_mfma_f32_16x16x32_bf16 v[176:179], v[20:23], a[12:15], v[176:179]
    ds_read_b64_tr_b16 v[18:19], v3 offset:23040
    s_waitcnt lgkmcnt(6)
    v_mfma_f32_16x16x32_bf16 v[144:147], v[24:27], a[8:11], v[144:147]
    ds_read_b64_tr_b16 v[20:21], v3 offset:18464
    ds_read_b64_tr_b16 v[22:23], v3 offset:23072
    v_mfma_f32_16x16x32_bf16 v[180:183], v[24:27], a[12:15], v[180:183]
    buffer_load_dwordx4 a[80:83], v1, s[24:27], s18 offen offset:2048
    v_mfma_f32_16x16x32_bf16 v[148:151], v[28:31], a[8:11], v[148:151]
    ds_read_b64_tr_b16 v[24:25], v3 offset:18496
    v_mfma_f32_16x16x32_bf16 v[184:187], v[28:31], a[12:15], v[184:187]
    ds_read_b64_tr_b16 v[26:27], v3 offset:23104
    s_waitcnt lgkmcnt(6)
    v_mfma_f32_16x16x32_bf16 v[152:155], v[32:35], a[8:11], v[152:155]
    ds_read_b64_tr_b16 v[28:29], v3 offset:18528
    ds_read_b64_tr_b16 v[30:31], v3 offset:23136
    v_mfma_f32_16x16x32_bf16 v[188:191], v[32:35], a[12:15], v[188:191]
    buffer_load_dwordx4 a[84:87], v2, s[24:27], s18 offen offset:2048
    v_mfma_f32_16x16x32_bf16 v[156:159], v[36:39], a[8:11], v[156:159]
    ds_read_b64_tr_b16 v[32:33], v3 offset:18560
    v_mfma_f32_16x16x32_bf16 v[192:195], v[36:39], a[12:15], v[192:195]
    ds_read_b64_tr_b16 v[34:35], v3 offset:23168
    s_waitcnt vmcnt(16) lgkmcnt(6)
    v_mfma_f32_16x16x32_bf16 v[124:127], v[16:19], a[16:19], v[124:127]
    ds_read_b64_tr_b16 v[36:37], v3 offset:18592
    v_mfma_f32_16x16x32_bf16 v[160:163], v[16:19], a[20:23], v[160:163]
    ds_read_b64_tr_b16 v[38:39], v3 offset:23200
    v_mfma_f32_16x16x32_bf16 v[128:131], v[20:23], a[16:19], v[128:131]
    ds_read_b64_tr_b16 v[16:17], v3 offset:18624
    v_mfma_f32_16x16x32_bf16 v[164:167], v[20:23], a[20:23], v[164:167]
    ds_read_b64_tr_b16 v[18:19], v3 offset:23232
    s_waitcnt lgkmcnt(6)
    v_mfma_f32_16x16x32_bf16 v[132:135], v[24:27], a[16:19], v[132:135]
    ds_read_b64_tr_b16 v[20:21], v3 offset:18656
    ds_read_b64_tr_b16 v[22:23], v3 offset:23264
    v_mfma_f32_16x16x32_bf16 v[168:171], v[24:27], a[20:23], v[168:171]
    buffer_load_dwordx4 a[88:91], v1, s[24:27], s18 offen offset:3072
    v_mfma_f32_16x16x32_bf16 v[136:139], v[28:31], a[16:19], v[136:139]
    ds_read_b64_tr_b16 v[24:25], v3 offset:18688
    v_mfma_f32_16x16x32_bf16 v[172:175], v[28:31], a[20:23], v[172:175]
    ds_read_b64_tr_b16 v[26:27], v3 offset:23296
    s_waitcnt lgkmcnt(6)
    v_mfma_f32_16x16x32_bf16 v[140:143], v[32:35], a[16:19], v[140:143]
    ds_read_b64_tr_b16 v[28:29], v3 offset:27648
    ds_read_b64_tr_b16 v[30:31], v3 offset:32256
    v_mfma_f32_16x16x32_bf16 v[176:179], v[32:35], a[20:23], v[176:179]
    buffer_load_dwordx4 a[92:95], v2, s[24:27], s18 offen offset:3072
    v_mfma_f32_16x16x32_bf16 v[144:147], v[36:39], a[16:19], v[144:147]
    ds_read_b64_tr_b16 v[32:33], v3 offset:27680
    v_mfma_f32_16x16x32_bf16 v[180:183], v[36:39], a[20:23], v[180:183]
    ds_read_b64_tr_b16 v[34:35], v3 offset:32288
    s_waitcnt lgkmcnt(6)
    v_mfma_f32_16x16x32_bf16 v[148:151], v[16:19], a[16:19], v[148:151]
    ds_read_b64_tr_b16 v[36:37], v3 offset:27712
    ds_read_b64_tr_b16 v[38:39], v3 offset:32320
    v_mfma_f32_16x16x32_bf16 v[184:187], v[16:19], a[20:23], v[184:187]
    s_add_u32 s18, s14, 12288
    buffer_load_dwordx4 a[96:99], v1, s[24:27], s18 offen offset:0
    v_mfma_f32_16x16x32_bf16 v[152:155], v[20:23], a[16:19], v[152:155]
    ds_read_b64_tr_b16 v[16:17], v3 offset:27744
    v_mfma_f32_16x16x32_bf16 v[188:191], v[20:23], a[20:23], v[188:191]
    ds_read_b64_tr_b16 v[18:19], v3 offset:32352
    s_waitcnt vmcnt(17) lgkmcnt(6)
    v_mfma_f32_16x16x32_bf16 v[156:159], v[24:27], a[16:19], v[156:159]
    ds_read_b64_tr_b16 v[20:21], v3 offset:27776
    v_mfma_f32_16x16x32_bf16 v[192:195], v[24:27], a[20:23], v[192:195]
    ds_read_b64_tr_b16 v[22:23], v3 offset:32384
    v_mfma_f32_16x16x32_bf16 v[124:127], v[28:31], a[24:27], v[124:127]
    ds_read_b64_tr_b16 v[24:25], v3 offset:27808
    v_mfma_f32_16x16x32_bf16 v[160:163], v[28:31], a[28:31], v[160:163]
    ds_read_b64_tr_b16 v[26:27], v3 offset:32416
    s_waitcnt lgkmcnt(6)
    v_mfma_f32_16x16x32_bf16 v[128:131], v[32:35], a[24:27], v[128:131]
    ds_read_b64_tr_b16 v[28:29], v3 offset:27840
    ds_read_b64_tr_b16 v[30:31], v3 offset:32448
    v_mfma_f32_16x16x32_bf16 v[164:167], v[32:35], a[28:31], v[164:167]
    buffer_load_dwordx4 a[100:103], v2, s[24:27], s18 offen offset:0
    v_mfma_f32_16x16x32_bf16 v[132:135], v[36:39], a[24:27], v[132:135]
    ds_read_b64_tr_b16 v[32:33], v3 offset:27872
    v_mfma_f32_16x16x32_bf16 v[168:171], v[36:39], a[28:31], v[168:171]
    ds_read_b64_tr_b16 v[34:35], v3 offset:32480
    s_waitcnt lgkmcnt(6)
    v_mfma_f32_16x16x32_bf16 v[136:139], v[16:19], a[24:27], v[136:139]
    ds_read_b64_tr_b16 v[36:37], v3 offset:27904
    ds_read_b64_tr_b16 v[38:39], v3 offset:32512
    v_mfma_f32_16x16x32_bf16 v[172:175], v[16:19], a[28:31], v[172:175]
    buffer_load_dwordx4 a[104:107], v1, s[24:27], s18 offen offset:1024
    v_mfma_f32_16x16x32_bf16 v[140:143], v[20:23], a[24:27], v[140:143]
    ds_read_b64_tr_b16 v[16:17], v3 offset:36864
    v_mfma_f32_16x16x32_bf16 v[176:179], v[20:23], a[28:31], v[176:179]
    ds_read_b64_tr_b16 v[18:19], v3 offset:41472
    s_waitcnt lgkmcnt(6)
    v_mfma_f32_16x16x32_bf16 v[144:147], v[24:27], a[24:27], v[144:147]
    ds_read_b64_tr_b16 v[20:21], v3 offset:36896
    ds_read_b64_tr_b16 v[22:23], v3 offset:41504
    v_mfma_f32_16x16x32_bf16 v[180:183], v[24:27], a[28:31], v[180:183]
    buffer_load_dwordx4 a[108:111], v2, s[24:27], s18 offen offset:1024
    v_mfma_f32_16x16x32_bf16 v[148:151], v[28:31], a[24:27], v[148:151]
    ds_read_b64_tr_b16 v[24:25], v3 offset:36928
    v_mfma_f32_16x16x32_bf16 v[184:187], v[28:31], a[28:31], v[184:187]
    ds_read_b64_tr_b16 v[26:27], v3 offset:41536
    s_waitcnt lgkmcnt(6)
    v_mfma_f32_16x16x32_bf16 v[152:155], v[32:35], a[24:27], v[152:155]
    ds_read_b64_tr_b16 v[28:29], v3 offset:36960
    v_mfma_f32_16x16x32_bf16 v[188:191], v[32:35], a[28:31], v[188:191]
    ds_read_b64_tr_b16 v[30:31], v3 offset:41568
    v_mfma_f32_16x16x32_bf16 v[156:159], v[36:39], a[24:27], v[156:159]
    ds_read_b64_tr_b16 v[32:33], v3 offset:36992
    v_mfma_f32_16x16x32_bf16 v[192:195], v[36:39], a[28:31], v[192:195]
    ds_read_b64_tr_b16 v[34:35], v3 offset:41600
    s_waitcnt vmcnt(18) lgkmcnt(6)
    v_mfma_f32_16x16x32_bf16 v[124:127], v[16:19], a[32:35], v[124:127]
    ds_read_b64_tr_b16 v[36:37], v3 offset:37024
    ds_read_b64_tr_b16 v[38:39], v3 offset:41632
    v_mfma_f32_16x16x32_bf16 v[160:163], v[16:19], a[36:39], v[160:163]
    buffer_load_dwordx4 a[112:115], v1, s[24:27], s18 offen offset:2048
    v_mfma_f32_16x16x32_bf16 v[128:131], v[20:23], a[32:35], v[128:131]
    ds_read_b64_tr_b16 v[16:17], v3 offset:37056
    v_mfma_f32_16x16x32_bf16 v[164:167], v[20:23], a[36:39], v[164:167]
    ds_read_b64_tr_b16 v[18:19], v3 offset:41664
    s_waitcnt lgkmcnt(6)
    v_mfma_f32_16x16x32_bf16 v[132:135], v[24:27], a[32:35], v[132:135]
    ds_read_b64_tr_b16 v[20:21], v3 offset:37088
    ds_read_b64_tr_b16 v[22:23], v3 offset:41696
    v_mfma_f32_16x16x32_bf16 v[168:171], v[24:27], a[36:39], v[168:171]
    buffer_load_dwordx4 a[116:119], v2, s[24:27], s18 offen offset:2048
    v_mfma_f32_16x16x32_bf16 v[136:139], v[28:31], a[32:35], v[136:139]
    ds_read_b64_tr_b16 v[24:25], v3 offset:37120
    v_mfma_f32_16x16x32_bf16 v[172:175], v[28:31], a[36:39], v[172:175]
    ds_read_b64_tr_b16 v[26:27], v3 offset:41728
    s_waitcnt lgkmcnt(6)
    v_mfma_f32_16x16x32_bf16 v[140:143], v[32:35], a[32:35], v[140:143]
    ds_read_b64_tr_b16 v[28:29], v3 offset:46080
    ds_read_b64_tr_b16 v[30:31], v3 offset:50688
    v_mfma_f32_16x16x32_bf16 v[176:179], v[32:35], a[36:39], v[176:179]
    buffer_load_dwordx4 a[120:123], v1, s[24:27], s18 offen offset:3072
    v_mfma_f32_16x16x32_bf16 v[144:147], v[36:39], a[32:35], v[144:147]
    ds_read_b64_tr_b16 v[32:33], v3 offset:46112
    v_mfma_f32_16x16x32_bf16 v[180:183], v[36:39], a[36:39], v[180:183]
    ds_read_b64_tr_b16 v[34:35], v3 offset:50720
    s_waitcnt lgkmcnt(6)
    v_mfma_f32_16x16x32_bf16 v[148:151], v[16:19], a[32:35], v[148:151]
    ds_read_b64_tr_b16 v[36:37], v3 offset:46144
    v_mfma_f32_16x16x32_bf16 v[184:187], v[16:19], a[36:39], v[184:187]
    ds_read_b64_tr_b16 v[38:39], v3 offset:50752
    v_mfma_f32_16x16x32_bf16 v[152:155], v[20:23], a[32:35], v[152:155]
    ds_read_b64_tr_b16 v[16:17], v3 offset:46176
    v_mfma_f32_16x16x32_bf16 v[188:191], v[20:23], a[36:39], v[188:191]
    ds_read_b64_tr_b16 v[18:19], v3 offset:50784
    s_waitcnt vmcnt(19) lgkmcnt(6)
    v_mfma_f32_16x16x32_bf16 v[156:159], v[24:27], a[32:35], v[156:159]
    ds_read_b64_tr_b16 v[20:21], v3 offset:46208
    ds_read_b64_tr_b16 v[22:23], v3 offset:50816
    v_mfma_f32_16x16x32_bf16 v[192:195], v[24:27], a[36:39], v[192:195]
    buffer_load_dwordx4 a[124:127], v2, s[24:27], s18 offen offset:3072
    v_mfma_f32_16x16x32_bf16 v[124:127], v[28:31], a[40:43], v[124:127]
    ds_read_b64_tr_b16 v[24:25], v3 offset:46240
    v_mfma_f32_16x16x32_bf16 v[160:163], v[28:31], a[44:47], v[160:163]
    ds_read_b64_tr_b16 v[26:27], v3 offset:50848
    s_waitcnt lgkmcnt(6)
    v_mfma_f32_16x16x32_bf16 v[128:131], v[32:35], a[40:43], v[128:131]
    ds_read_b64_tr_b16 v[28:29], v3 offset:46272
    ds_read_b64_tr_b16 v[30:31], v3 offset:50880
    v_mfma_f32_16x16x32_bf16 v[164:167], v[32:35], a[44:47], v[164:167]
    s_add_u32 s18, s14, 16384
    buffer_load_dwordx4 a[128:131], v1, s[24:27], s18 offen offset:0
    v_mfma_f32_16x16x32_bf16 v[132:135], v[36:39], a[40:43], v[132:135]
    ds_read_b64_tr_b16 v[32:33], v3 offset:46304
    v_mfma_f32_16x16x32_bf16 v[168:171], v[36:39], a[44:47], v[168:171]
    ds_read_b64_tr_b16 v[34:35], v3 offset:50912
    s_waitcnt lgkmcnt(6)
    v_mfma_f32_16x16x32_bf16 v[136:139], v[16:19], a[40:43], v[136:139]
    ds_read_b64_tr_b16 v[36:37], v3 offset:46336
    v_mfma_f32_16x16x32_bf16 v[172:175], v[16:19], a[44:47], v[172:175]
    ds_read_b64_tr_b16 v[38:39], v3 offset:50944
    v_mfma_f32_16x16x32_bf16 v[140:143], v[20:23], a[40:43], v[140:143]
    ds_read_b64_tr_b16 v[16:17], v4 offset:0
    v_mfma_f32_16x16x32_bf16 v[176:179], v[20:23], a[44:47], v[176:179]
    ds_read_b64_tr_b16 v[18:19], v4 offset:4608
    s_waitcnt lgkmcnt(6)
    v_mfma_f32_16x16x32_bf16 v[144:147], v[24:27], a[40:43], v[144:147]
    ds_read_b64_tr_b16 v[20:21], v4 offset:32
    ds_read_b64_tr_b16 v[22:23], v4 offset:4640
    v_mfma_f32_16x16x32_bf16 v[180:183], v[24:27], a[44:47], v[180:183]
    buffer_load_dwordx4 a[132:135], v2, s[24:27], s18 offen offset:0
    v_mfma_f32_16x16x32_bf16 v[148:151], v[28:31], a[40:43], v[148:151]
    ds_read_b64_tr_b16 v[24:25], v4 offset:64
    v_mfma_f32_16x16x32_bf16 v[184:187], v[28:31], a[44:47], v[184:187]
    ds_read_b64_tr_b16 v[26:27], v4 offset:4672
    s_waitcnt lgkmcnt(6)
    v_mfma_f32_16x16x32_bf16 v[152:155], v[32:35], a[40:43], v[152:155]
    ds_read_b64_tr_b16 v[28:29], v4 offset:96
    ds_read_b64_tr_b16 v[30:31], v4 offset:4704
    v_mfma_f32_16x16x32_bf16 v[188:191], v[32:35], a[44:47], v[188:191]
    buffer_load_dwordx4 a[136:139], v1, s[24:27], s18 offen offset:1024
    v_mfma_f32_16x16x32_bf16 v[156:159], v[36:39], a[40:43], v[156:159]
    ds_read_b64_tr_b16 v[32:33], v4 offset:128
    v_mfma_f32_16x16x32_bf16 v[192:195], v[36:39], a[44:47], v[192:195]
    ds_read_b64_tr_b16 v[34:35], v4 offset:4736
    s_waitcnt vmcnt(21) lgkmcnt(6)
    v_mfma_f32_16x16x32_bf16 v[124:127], v[16:19], a[48:51], v[124:127]
    ds_read_b64_tr_b16 v[36:37], v4 offset:160
    ds_read_b64_tr_b16 v[38:39], v4 offset:4768
    v_mfma_f32_16x16x32_bf16 v[160:163], v[16:19], a[52:55], v[160:163]
    buffer_load_dwordx4 a[140:143], v2, s[24:27], s18 offen offset:1024
    v_mfma_f32_16x16x32_bf16 v[128:131], v[20:23], a[48:51], v[128:131]
    ds_read_b64_tr_b16 v[16:17], v4 offset:192
    v_mfma_f32_16x16x32_bf16 v[164:167], v[20:23], a[52:55], v[164:167]
    ds_read_b64_tr_b16 v[18:19], v4 offset:4800
    s_waitcnt lgkmcnt(6)
    v_mfma_f32_16x16x32_bf16 v[132:135], v[24:27], a[48:51], v[132:135]
    ds_read_b64_tr_b16 v[20:21], v4 offset:224
    v_mfma_f32_16x16x32_bf16 v[168:171], v[24:27], a[52:55], v[168:171]
    ds_read_b64_tr_b16 v[22:23], v4 offset:4832
    v_mfma_f32_16x16x32_bf16 v[136:139], v[28:31], a[48:51], v[136:139]
    ds_read_b64_tr_b16 v[24:25], v4 offset:256
    v_mfma_f32_16x16x32_bf16 v[172:175], v[28:31], a[52:55], v[172:175]
    ds_read_b64_tr_b16 v[26:27], v4 offset:4864
    s_waitcnt lgkmcnt(6)
    v_mfma_f32_16x16x32_bf16 v[140:143], v[32:35], a[48:51], v[140:143]
    ds_read_b64_tr_b16 v[28:29], v4 offset:9216
    ds_read_b64_tr_b16 v[30:31], v4 offset:13824
    v_mfma_f32_16x16x32_bf16 v[176:179], v[32:35], a[52:55], v[176:179]
    buffer_load_dwordx4 a[144:147], v1, s[24:27], s18 offen offset:2048
    v_mfma_f32_16x16x32_bf16 v[144:147], v[36:39], a[48:51], v[144:147]
    ds_read_b64_tr_b16 v[32:33], v4 offset:9248
    v_mfma_f32_16x16x32_bf16 v[180:183], v[36:39], a[52:55], v[180:183]
    ds_read_b64_tr_b16 v[34:35], v4 offset:13856
    s_waitcnt lgkmcnt(6)
    v_mfma_f32_16x16x32_bf16 v[148:151], v[16:19], a[48:51], v[148:151]
    ds_read_b64_tr_b16 v[36:37], v4 offset:9280
    ds_read_b64_tr_b16 v[38:39], v4 offset:13888
    v_mfma_f32_16x16x32_bf16 v[184:187], v[16:19], a[52:55], v[184:187]
    buffer_load_dwordx4 a[148:151], v2, s[24:27], s18 offen offset:2048
    v_mfma_f32_16x16x32_bf16 v[152:155], v[20:23], a[48:51], v[152:155]
    ds_read_b64_tr_b16 v[16:17], v4 offset:9312
    v_mfma_f32_16x16x32_bf16 v[188:191], v[20:23], a[52:55], v[188:191]
    ds_read_b64_tr_b16 v[18:19], v4 offset:13920
    s_waitcnt vmcnt(22) lgkmcnt(6)
    v_mfma_f32_16x16x32_bf16 v[156:159], v[24:27], a[48:51], v[156:159]
    ds_read_b64_tr_b16 v[20:21], v4 offset:9344
    ds_read_b64_tr_b16 v[22:23], v4 offset:13952
    v_mfma_f32_16x16x32_bf16 v[192:195], v[24:27], a[52:55], v[192:195]
    buffer_load_dwordx4 a[152:155], v1, s[24:27], s18 offen offset:3072
    v_mfma_f32_16x16x32_bf16 v[124:127], v[28:31], a[56:59], v[124:127]
    ds_read_b64_tr_b16 v[24:25], v4 offset:9376
    v_mfma_f32_16x16x32_bf16 v[160:163], v[28:31], a[60:63], v[160:163]
    ds_read_b64_tr_b16 v[26:27], v4 offset:13984
    s_waitcnt lgkmcnt(6)
    v_mfma_f32_16x16x32_bf16 v[128:131], v[32:35], a[56:59], v[128:131]
    ds_read_b64_tr_b16 v[28:29], v4 offset:9408
    v_mfma_f32_16x16x32_bf16 v[164:167], v[32:35], a[60:63], v[164:167]
    ds_read_b64_tr_b16 v[30:31], v4 offset:14016
    v_mfma_f32_16x16x32_bf16 v[132:135], v[36:39], a[56:59], v[132:135]
    ds_read_b64_tr_b16 v[32:33], v4 offset:9440
    v_mfma_f32_16x16x32_bf16 v[168:171], v[36:39], a[60:63], v[168:171]
    ds_read_b64_tr_b16 v[34:35], v4 offset:14048
    s_waitcnt lgkmcnt(6)
    v_mfma_f32_16x16x32_bf16 v[136:139], v[16:19], a[56:59], v[136:139]
    ds_read_b64_tr_b16 v[36:37], v4 offset:9472
    ds_read_b64_tr_b16 v[38:39], v4 offset:14080
    v_mfma_f32_16x16x32_bf16 v[172:175], v[16:19], a[60:63], v[172:175]
    buffer_load_dwordx4 a[156:159], v2, s[24:27], s18 offen offset:3072
    v_mfma_f32_16x16x32_bf16 v[140:143], v[20:23], a[56:59], v[140:143]
    s_barrier
    ds_read_b64_tr_b16 v[16:17], v4 offset:18432
    v_mfma_f32_16x16x32_bf16 v[176:179], v[20:23], a[60:63], v[176:179]
    ds_read_b64_tr_b16 v[18:19], v4 offset:23040
    s_waitcnt lgkmcnt(6)
    v_mfma_f32_16x16x32_bf16 v[144:147], v[24:27], a[56:59], v[144:147]
    ds_read_b64_tr_b16 v[20:21], v4 offset:18464
    ds_read_b64_tr_b16 v[22:23], v4 offset:23072
    v_mfma_f32_16x16x32_bf16 v[180:183], v[24:27], a[60:63], v[180:183]
    s_add_u32 m0, s62, 0
    s_add_u32 s63, s60, 589824
    buffer_load_dwordx4 v40, s[52:55], s63 offen offset:0 lds
    v_mfma_f32_16x16x32_bf16 v[148:151], v[28:31], a[56:59], v[148:151]
    ds_read_b64_tr_b16 v[24:25], v4 offset:18496
    v_mfma_f32_16x16x32_bf16 v[184:187], v[28:31], a[60:63], v[184:187]
    ds_read_b64_tr_b16 v[26:27], v4 offset:23104
    s_waitcnt lgkmcnt(6)
    v_mfma_f32_16x16x32_bf16 v[152:155], v[32:35], a[56:59], v[152:155]
    ds_read_b64_tr_b16 v[28:29], v4 offset:18528
    ds_read_b64_tr_b16 v[30:31], v4 offset:23136
    v_mfma_f32_16x16x32_bf16 v[188:191], v[32:35], a[60:63], v[188:191]
    buffer_load_dwordx4 v41, s[52:55], s63 offen offset:1024 lds
    v_mfma_f32_16x16x32_bf16 v[156:159], v[36:39], a[56:59], v[156:159]
    ds_read_b64_tr_b16 v[32:33], v4 offset:18560
    v_mfma_f32_16x16x32_bf16 v[192:195], v[36:39], a[60:63], v[192:195]
    ds_read_b64_tr_b16 v[34:35], v4 offset:23168
    s_waitcnt vmcnt(24) lgkmcnt(6)
    v_mfma_f32_16x16x32_bf16 v[124:127], v[16:19], a[64:67], v[124:127]
    ds_read_b64_tr_b16 v[36:37], v4 offset:18592
    v_mfma_f32_16x16x32_bf16 v[160:163], v[16:19], a[68:71], v[160:163]
    ds_read_b64_tr_b16 v[38:39], v4 offset:23200
    v_mfma_f32_16x16x32_bf16 v[128:131], v[20:23], a[64:67], v[128:131]
    ds_read_b64_tr_b16 v[16:17], v4 offset:18624
    v_mfma_f32_16x16x32_bf16 v[164:167], v[20:23], a[68:71], v[164:167]
    ds_read_b64_tr_b16 v[18:19], v4 offset:23232
    s_waitcnt lgkmcnt(6)
    v_mfma_f32_16x16x32_bf16 v[132:135], v[24:27], a[64:67], v[132:135]
    ds_read_b64_tr_b16 v[20:21], v4 offset:18656
    ds_read_b64_tr_b16 v[22:23], v4 offset:23264
    v_mfma_f32_16x16x32_bf16 v[168:171], v[24:27], a[68:71], v[168:171]
    s_add_u32 s18, s14, 20480
    buffer_load_dwordx4 a[160:163], v1, s[24:27], s18 offen offset:0
    v_mfma_f32_16x16x32_bf16 v[136:139], v[28:31], a[64:67], v[136:139]
    ds_read_b64_tr_b16 v[24:25], v4 offset:18688
    v_mfma_f32_16x16x32_bf16 v[172:175], v[28:31], a[68:71], v[172:175]
    ds_read_b64_tr_b16 v[26:27], v4 offset:23296
    s_waitcnt lgkmcnt(6)
    v_mfma_f32_16x16x32_bf16 v[140:143], v[32:35], a[64:67], v[140:143]
    ds_read_b64_tr_b16 v[28:29], v4 offset:27648
    ds_read_b64_tr_b16 v[30:31], v4 offset:32256
    v_mfma_f32_16x16x32_bf16 v[176:179], v[32:35], a[68:71], v[176:179]
    buffer_load_dwordx4 v42, s[52:55], s63 offen offset:2048 lds
    v_mfma_f32_16x16x32_bf16 v[144:147], v[36:39], a[64:67], v[144:147]
    ds_read_b64_tr_b16 v[32:33], v4 offset:27680
    v_mfma_f32_16x16x32_bf16 v[180:183], v[36:39], a[68:71], v[180:183]
    ds_read_b64_tr_b16 v[34:35], v4 offset:32288
    s_waitcnt lgkmcnt(6)
    v_mfma_f32_16x16x32_bf16 v[148:151], v[16:19], a[64:67], v[148:151]
    ds_read_b64_tr_b16 v[36:37], v4 offset:27712
    v_mfma_f32_16x16x32_bf16 v[184:187], v[16:19], a[68:71], v[184:187]
    ds_read_b64_tr_b16 v[38:39], v4 offset:32320
    v_mfma_f32_16x16x32_bf16 v[152:155], v[20:23], a[64:67], v[152:155]
    ds_read_b64_tr_b16 v[16:17], v4 offset:27744
    v_mfma_f32_16x16x32_bf16 v[188:191], v[20:23], a[68:71], v[188:191]
    ds_read_b64_tr_b16 v[18:19], v4 offset:32352
    s_waitcnt vmcnt(24) lgkmcnt(6)
    v_mfma_f32_16x16x32_bf16 v[156:159], v[24:27], a[64:67], v[156:159]
    ds_read_b64_tr_b16 v[20:21], v4 offset:27776
    ds_read_b64_tr_b16 v[22:23], v4 offset:32384
    v_mfma_f32_16x16x32_bf16 v[192:195], v[24:27], a[68:71], v[192:195]
    buffer_load_dwordx4 v43, s[52:55], s63 offen offset:3072 lds
    v_mfma_f32_16x16x32_bf16 v[124:127], v[28:31], a[72:75], v[124:127]
    ds_read_b64_tr_b16 v[24:25], v4 offset:27808
    v_mfma_f32_16x16x32_bf16 v[160:163], v[28:31], a[76:79], v[160:163]
    ds_read_b64_tr_b16 v[26:27], v4 offset:32416
    s_waitcnt lgkmcnt(6)
    v_mfma_f32_16x16x32_bf16 v[128:131], v[32:35], a[72:75], v[128:131]
    ds_read_b64_tr_b16 v[28:29], v4 offset:27840
    ds_read_b64_tr_b16 v[30:31], v4 offset:32448
    v_mfma_f32_16x16x32_bf16 v[164:167], v[32:35], a[76:79], v[164:167]
    buffer_load_dwordx4 a[164:167], v2, s[24:27], s18 offen offset:0
    v_mfma_f32_16x16x32_bf16 v[132:135], v[36:39], a[72:75], v[132:135]
    ds_read_b64_tr_b16 v[32:33], v4 offset:27872
    v_mfma_f32_16x16x32_bf16 v[168:171], v[36:39], a[76:79], v[168:171]
    ds_read_b64_tr_b16 v[34:35], v4 offset:32480
    s_waitcnt lgkmcnt(6)
    v_mfma_f32_16x16x32_bf16 v[136:139], v[16:19], a[72:75], v[136:139]
    ds_read_b64_tr_b16 v[36:37], v4 offset:27904
    ds_read_b64_tr_b16 v[38:39], v4 offset:32512
    v_mfma_f32_16x16x32_bf16 v[172:175], v[16:19], a[76:79], v[172:175]
    s_add_u32 m0, s62, 4096
    s_nop 0
    buffer_load_dwordx4 v44, s[52:55], s63 offen offset:0 lds
    v_mfma_f32_16x16x32_bf16 v[140:143], v[20:23], a[72:75], v[140:143]
    ds_read_b64_tr_b16 v[16:17], v4 offset:36864
    v_mfma_f32_16x16x32_bf16 v[176:179], v[20:23], a[76:79], v[176:179]
    ds_read_b64_tr_b16 v[18:19], v4 offset:41472
    s_waitcnt lgkmcnt(6)
    v_mfma_f32_16x16x32_bf16 v[144:147], v[24:27], a[72:75], v[144:147]
    ds_read_b64_tr_b16 v[20:21], v4 offset:36896
    v_mfma_f32_16x16x32_bf16 v[180:183], v[24:27], a[76:79], v[180:183]
    ds_read_b64_tr_b16 v[22:23], v4 offset:41504
    v_mfma_f32_16x16x32_bf16 v[148:151], v[28:31], a[72:75], v[148:151]
    ds_read_b64_tr_b16 v[24:25], v4 offset:36928
    v_mfma_f32_16x16x32_bf16 v[184:187], v[28:31], a[76:79], v[184:187]
    ds_read_b64_tr_b16 v[26:27], v4 offset:41536
    s_waitcnt lgkmcnt(6)
    v_mfma_f32_16x16x32_bf16 v[152:155], v[32:35], a[72:75], v[152:155]
    ds_read_b64_tr_b16 v[28:29], v4 offset:36960
    ds_read_b64_tr_b16 v[30:31], v4 offset:41568
    v_mfma_f32_16x16x32_bf16 v[188:191], v[32:35], a[76:79], v[188:191]
    buffer_load_dwordx4 v45, s[52:55], s63 offen offset:1024 lds
    v_mfma_f32_16x16x32_bf16 v[156:159], v[36:39], a[72:75], v[156:159]
    ds_read_b64_tr_b16 v[32:33], v4 offset:36992
    v_mfma_f32_16x16x32_bf16 v[192:195], v[36:39], a[76:79], v[192:195]
    ds_read_b64_tr_b16 v[34:35], v4 offset:41600
    s_waitcnt vmcnt(26) lgkmcnt(6)
    v_mfma_f32_16x16x32_bf16 v[124:127], v[16:19], a[80:83], v[124:127]
    ds_read_b64_tr_b16 v[36:37], v4 offset:37024
    ds_read_b64_tr_b16 v[38:39], v4 offset:41632
    v_mfma_f32_16x16x32_bf16 v[160:163], v[16:19], a[84:87], v[160:163]
    buffer_load_dwordx4 a[168:171], v1, s[24:27], s18 offen offset:1024
    v_mfma_f32_16x16x32_bf16 v[128:131], v[20:23], a[80:83], v[128:131]
    ds_read_b64_tr_b16 v[16:17], v4 offset:37056
    v_mfma_f32_16x16x32_bf16 v[164:167], v[20:23], a[84:87], v[164:167]
    ds_read_b64_tr_b16 v[18:19], v4 offset:41664
    s_waitcnt lgkmcnt(6)
    v_mfma_f32_16x16x32_bf16 v[132:135], v[24:27], a[80:83], v[132:135]
    ds_read_b64_tr_b16 v[20:21], v4 offset:37088
    ds_read_b64_tr_b16 v[22:23], v4 offset:41696
    v_mfma_f32_16x16x32_bf16 v[168:171], v[24:27], a[84:87], v[168:171]
    buffer_load_dwordx4 v46, s[52:55], s63 offen offset:2048 lds
    v_mfma_f32_16x16x32_bf16 v[136:139], v[28:31], a[80:83], v[136:139]
    ds_read_b64_tr_b16 v[24:25], v4 offset:37120
    v_mfma_f32_16x16x32_bf16 v[172:175], v[28:31], a[84:87], v[172:175]
    ds_read_b64_tr_b16 v[26:27], v4 offset:41728
    s_waitcnt lgkmcnt(6)
    v_mfma_f32_16x16x32_bf16 v[140:143], v[32:35], a[80:83], v[140:143]
    ds_read_b64_tr_b16 v[28:29], v4 offset:46080
    v_mfma_f32_16x16x32_bf16 v[176:179], v[32:35], a[84:87], v[176:179]
    ds_read_b64_tr_b16 v[30:31], v4 offset:50688
    v_mfma_f32_16x16x32_bf16 v[144:147], v[36:39], a[80:83], v[144:147]
    ds_read_b64_tr_b16 v[32:33], v4 offset:46112
    v_mfma_f32_16x16x32_bf16 v[180:183], v[36:39], a[84:87], v[180:183]
    ds_read_b64_tr_b16 v[34:35], v4 offset:50720
    s_waitcnt lgkmcnt(6)
    v_mfma_f32_16x16x32_bf16 v[148:151], v[16:19], a[80:83], v[148:151]
    ds_read_b64_tr_b16 v[36:37], v4 offset:46144
    ds_read_b64_tr_b16 v[38:39], v4 offset:50752
    v_mfma_f32_16x16x32_bf16 v[184:187], v[16:19], a[84:87], v[184:187]
    buffer_load_dwordx4 v47, s[52:55], s63 offen offset:3072 lds
    v_mfma_f32_16x16x32_bf16 v[152:155], v[20:23], a[80:83], v[152:155]
    ds_read_b64_tr_b16 v[16:17], v4 offset:46176
    v_mfma_f32_16x16x32_bf16 v[188:191], v[20:23], a[84:87], v[188:191]
    ds_read_b64_tr_b16 v[18:19], v4 offset:50784
    s_waitcnt vmcnt(27) lgkmcnt(6)
    v_mfma_f32_16x16x32_bf16 v[156:159], v[24:27], a[80:83], v[156:159]
    ds_read_b64_tr_b16 v[20:21], v4 offset:46208
    ds_read_b64_tr_b16 v[22:23], v4 offset:50816
    v_mfma_f32_16x16x32_bf16 v[192:195], v[24:27], a[84:87], v[192:195]
    buffer_load_dwordx4 a[172:175], v2, s[24:27], s18 offen offset:1024
    v_mfma_f32_16x16x32_bf16 v[124:127], v[28:31], a[88:91], v[124:127]
    ds_read_b64_tr_b16 v[24:25], v4 offset:46240
    v_mfma_f32_16x16x32_bf16 v[160:163], v[28:31], a[92:95], v[160:163]
    ds_read_b64_tr_b16 v[26:27], v4 offset:50848
    s_waitcnt lgkmcnt(6)
    v_mfma_f32_16x16x32_bf16 v[128:131], v[32:35], a[88:91], v[128:131]
    ds_read_b64_tr_b16 v[28:29], v4 offset:46272
    ds_read_b64_tr_b16 v[30:31], v4 offset:50880
    v_mfma_f32_16x16x32_bf16 v[164:167], v[32:35], a[92:95], v[164:167]
    s_add_u32 m0, s62, 8192
    s_nop 0
    buffer_load_dwordx4 v48, s[52:55], s63 offen offset:0 lds
    v_mfma_f32_16x16x32_bf16 v[132:135], v[36:39], a[88:91], v[132:135]
    ds_read_b64_tr_b16 v[32:33], v4 offset:46304
    v_mfma_f32_16x16x32_bf16 v[168:171], v[36:39], a[92:95], v[168:171]
    ds_read_b64_tr_b16 v[34:35], v4 offset:50912
    s_waitcnt lgkmcnt(6)
    v_mfma_f32_16x16x32_bf16 v[136:139], v[16:19], a[88:91], v[136:139]
    ds_read_b64_tr_b16 v[36:37], v4 offset:46336
    v_mfma_f32_16x16x32_bf16 v[172:175], v[16:19], a[92:95], v[172:175]
    ds_read_b64_tr_b16 v[38:39], v4 offset:50944
    v_mfma_f32_16x16x32_bf16 v[140:143], v[20:23], a[88:91], v[140:143]
    s_barrier
    ds_read_b64_tr_b16 v[16:17], v5 offset:0
    v_mfma_f32_16x16x32_bf16 v[176:179], v[20:23], a[92:95], v[176:179]
    ds_read_b64_tr_b16 v[18:19], v5 offset:4608
    s_waitcnt lgkmcnt(6)
    v_mfma_f32_16x16x32_bf16 v[144:147], v[24:27], a[88:91], v[144:147]
    ds_read_b64_tr_b16 v[20:21], v5 offset:32
    ds_read_b64_tr_b16 v[22:23], v5 offset:4640
    v_mfma_f32_16x16x32_bf16 v[180:183], v[24:27], a[92:95], v[180:183]
    s_add_u32 m0, s62, 36864
    s_add_u32 s63, s60, 737280
    buffer_load_dwordx4 v40, s[52:55], s63 offen offset:0 lds
    v_mfma_f32_16x16x32_bf16 v[148:151], v[28:31], a[88:91], v[148:151]
    ds_read_b64_tr_b16 v[24:25], v5 offset:64
    v_mfma_f32_16x16x32_bf16 v[184:187], v[28:31], a[92:95], v[184:187]
    ds_read_b64_tr_b16 v[26:27], v5 offset:4672
    s_waitcnt lgkmcnt(6)
    v_mfma_f32_16x16x32_bf16 v[152:155], v[32:35], a[88:91], v[152:155]
    ds_read_b64_tr_b16 v[28:29], v5 offset:96
    ds_read_b64_tr_b16 v[30:31], v5 offset:4704
    v_mfma_f32_16x16x32_bf16 v[188:191], v[32:35], a[92:95], v[188:191]
    buffer_load_dwordx4 a[176:179], v1, s[24:27], s18 offen offset:2048
    v_mfma_f32_16x16x32_bf16 v[156:159], v[36:39], a[88:91], v[156:159]
    ds_read_b64_tr_b16 v[32:33], v5 offset:128
    v_mfma_f32_16x16x32_bf16 v[192:195], v[36:39], a[92:95], v[192:195]
    ds_read_b64_tr_b16 v[34:35], v5 offset:4736
    s_waitcnt vmcnt(29) lgkmcnt(6)
    v_mfma_f32_16x16x32_bf16 v[124:127], v[16:19], a[96:99], v[124:127]
    ds_read_b64_tr_b16 v[36:37], v5 offset:160
    v_mfma_f32_16x16x32_bf16 v[160:163], v[16:19], a[100:103], v[160:163]
    ds_read_b64_tr_b16 v[38:39], v5 offset:4768
    v_mfma_f32_16x16x32_bf16 v[128:131], v[20:23], a[96:99], v[128:131]
    ds_read_b64_tr_b16 v[16:17], v5 offset:192
    v_mfma_f32_16x16x32_bf16 v[164:167], v[20:23], a[100:103], v[164:167]
    ds_read_b64_tr_b16 v[18:19], v5 offset:4800
    s_waitcnt lgkmcnt(6)
    v_mfma_f32_16x16x32_bf16 v[132:135], v[24:27], a[96:99], v[132:135]
    ds_read_b64_tr_b16 v[20:21], v5 offset:224
    ds_read_b64_tr_b16 v[22:23], v5 offset:4832
    v_mfma_f32_16x16x32_bf16 v[168:171], v[24:27], a[100:103], v[168:171]
    buffer_load_dwordx4 v41, s[52:55], s63 offen offset:1024 lds
    v_mfma_f32_16x16x32_bf16 v[136:139], v[28:31], a[96:99], v[136:139]
    ds_read_b64_tr_b16 v[24:25], v5 offset:256
    v_mfma_f32_16x16x32_bf16 v[172:175], v[28:31], a[100:103], v[172:175]
    ds_read_b64_tr_b16 v[26:27], v5 offset:4864
    s_waitcnt lgkmcnt(6)
    v_mfma_f32_16x16x32_bf16 v[140:143], v[32:35], a[96:99], v[140:143]
    ds_read_b64_tr_b16 v[28:29], v5 offset:9216
    ds_read_b64_tr_b16 v[30:31], v5 offset:13824
    v_mfma_f32_16x16x32_bf16 v[176:179], v[32:35], a[100:103], v[176:179]
    buffer_load_dwordx4 v42, s[52:55], s63 offen offset:2048 lds
    v_mfma_f32_16x16x32_bf16 v[144:147], v[36:39], a[96:99], v[144:147]
    ds_read_b64_tr_b16 v[32:33], v5 offset:9248
    v_mfma_f32_16x16x32_bf16 v[180:183], v[36:39], a[100:103], v[180:183]
    ds_read_b64_tr_b16 v[34:35], v5 offset:13856
    s_waitcnt lgkmcnt(6)
    v_mfma_f32_16x16x32_bf16 v[148:151], v[16:19], a[96:99], v[148:151]
    ds_read_b64_tr_b16 v[36:37], v5 offset:9280
    ds_read_b64_tr_b16 v[38:39], v5 offset:13888
    v_mfma_f32_16x16x32_bf16 v[184:187], v[16:19], a[100:103], v[184:187]
    buffer_load_dwordx4 a[180:183], v2, s[24:27], s18 offen offset:2048
    v_mfma_f32_16x16x32_bf16 v[152:155], v[20:23], a[96:99], v[152:155]
    ds_read_b64_tr_b16 v[16:17], v5 offset:9312
    v_mfma_f32_16x16x32_bf16 v[188:191], v[20:23], a[100:103], v[188:191]
    ds_read_b64_tr_b16 v[18:19], v5 offset:13920
    s_waitcnt vmcnt(30) lgkmcnt(6)
    v_mfma_f32_16x16x32_bf16 v[156:159], v[24:27], a[96:99], v[156:159]
    ds_read_b64_tr_b16 v[20:21], v5 offset:9344
    v_mfma_f32_16x16x32_bf16 v[192:195], v[24:27], a[100:103], v[192:195]
    ds_read_b64_tr_b16 v[22:23], v5 offset:13952
    v_mfma_f32_16x16x32_bf16 v[124:127], v[28:31], a[104:107], v[124:127]
    ds_read_b64_tr_b16 v[24:25], v5 offset:9376
    v_mfma_f32_16x16x32_bf16 v[160:163], v[28:31], a[108:111], v[160:163]
    ds_read_b64_tr_b16 v[26:27], v5 offset:13984
    s_waitcnt lgkmcnt(6)
    v_mfma_f32_16x16x32_bf16 v[128:131], v[32:35], a[104:107], v[128:131]
    ds_read_b64_tr_b16 v[28:29], v5 offset:9408
    ds_read_b64_tr_b16 v[30:31], v5 offset:14016
    v_mfma_f32_16x16x32_bf16 v[164:167], v[32:35], a[108:111], v[164:167]
    buffer_load_dwordx4 v43, s[52:55], s63 offen offset:3072 lds
    v_mfma_f32_16x16x32_bf16 v[132:135], v[36:39], a[104:107], v[132:135]
    ds_read_b64_tr_b16 v[32:33], v5 offset:9440
    v_mfma_f32_16x16x32_bf16 v[168:171], v[36:39], a[108:111], v[168:171]
    ds_read_b64_tr_b16 v[34:35], v5 offset:14048
    s_waitcnt lgkmcnt(6)
    v_mfma_f32_16x16x32_bf16 v[136:139], v[16:19], a[104:107], v[136:139]
    ds_read_b64_tr_b16 v[36:37], v5 offset:9472
    ds_read_b64_tr_b16 v[38:39], v5 offset:14080
    v_mfma_f32_16x16x32_bf16 v[172:175], v[16:19], a[108:111], v[172:175]
    s_add_u32 m0, s62, 40960
    s_nop 0
    buffer_load_dwordx4 v44, s[52:55], s63 offen offset:0 lds
    v_mfma_f32_16x16x32_bf16 v[140:143], v[20:23], a[104:107], v[140:143]
    ds_read_b64_tr_b16 v[16:17], v5 offset:18432
    v_mfma_f32_16x16x32_bf16 v[176:179], v[20:23], a[108:111], v[176:179]
    ds_read_b64_tr_b16 v[18:19], v5 offset:23040
    s_waitcnt lgkmcnt(6)
    v_mfma_f32_16x16x32_bf16 v[144:147], v[24:27], a[104:107], v[144:147]
    ds_read_b64_tr_b16 v[20:21], v5 offset:18464
    ds_read_b64_tr_b16 v[22:23], v5 offset:23072
    v_mfma_f32_16x16x32_bf16 v[180:183], v[24:27], a[108:111], v[180:183]
    buffer_load_dwordx4 a[184:187], v1, s[24:27], s18 offen offset:3072
    v_mfma_f32_16x16x32_bf16 v[148:151], v[28:31], a[104:107], v[148:151]
    ds_read_b64_tr_b16 v[24:25], v5 offset:18496
    v_mfma_f32_16x16x32_bf16 v[184:187], v[28:31], a[108:111], v[184:187]
    ds_read_b64_tr_b16 v[26:27], v5 offset:23104
    s_waitcnt lgkmcnt(6)
    v_mfma_f32_16x16x32_bf16 v[152:155], v[32:35], a[104:107], v[152:155]
    ds_read_b64_tr_b16 v[28:29], v5 offset:18528
    v_mfma_f32_16x16x32_bf16 v[188:191], v[32:35], a[108:111], v[188:191]
    ds_read_b64_tr_b16 v[30:31], v5 offset:23136
    v_mfma_f32_16x16x32_bf16 v[156:159], v[36:39], a[104:107], v[156:159]
    ds_read_b64_tr_b16 v[32:33], v5 offset:18560
    v_mfma_f32_16x16x32_bf16 v[192:195], v[36:39], a[108:111], v[192:195]
    ds_read_b64_tr_b16 v[34:35], v5 offset:23168
    s_waitcnt vmcnt(31) lgkmcnt(6)
    v_mfma_f32_16x16x32_bf16 v[124:127], v[16:19], a[112:115], v[124:127]
    ds_read_b64_tr_b16 v[36:37], v5 offset:18592
    ds_read_b64_tr_b16 v[38:39], v5 offset:23200
    v_mfma_f32_16x16x32_bf16 v[160:163], v[16:19], a[116:119], v[160:163]
    buffer_load_dwordx4 v45, s[52:55], s63 offen offset:1024 lds
    v_mfma_f32_16x16x32_bf16 v[128:131], v[20:23], a[112:115], v[128:131]
    ds_read_b64_tr_b16 v[16:17], v5 offset:18624
    v_mfma_f32_16x16x32_bf16 v[164:167], v[20:23], a[116:119], v[164:167]
    ds_read_b64_tr_b16 v[18:19], v5 offset:23232
    s_waitcnt lgkmcnt(6)
    v_mfma_f32_16x16x32_bf16 v[132:135], v[24:27], a[112:115], v[132:135]
    ds_read_b64_tr_b16 v[20:21], v5 offset:18656
    ds_read_b64_tr_b16 v[22:23], v5 offset:23264
    v_mfma_f32_16x16x32_bf16 v[168:171], v[24:27], a[116:119], v[168:171]
    buffer_load_dwordx4 v46, s[52:55], s63 offen offset:2048 lds
    v_mfma_f32_16x16x32_bf16 v[136:139], v[28:31], a[112:115], v[136:139]
    ds_read_b64_tr_b16 v[24:25], v5 offset:18688
    v_mfma_f32_16x16x32_bf16 v[172:175], v[28:31], a[116:119], v[172:175]
    ds_read_b64_tr_b16 v[26:27], v5 offset:23296
    s_waitcnt lgkmcnt(6)
    v_mfma_f32_16x16x32_bf16 v[140:143], v[32:35], a[112:115], v[140:143]
    ds_read_b64_tr_b16 v[28:29], v5 offset:27648
    ds_read_b64_tr_b16 v[30:31], v5 offset:32256
    v_mfma_f32_16x16x32_bf16 v[176:179], v[32:35], a[116:119], v[176:179]
    buffer_load_dwordx4 a[188:191], v2, s[24:27], s18 offen offset:3072
    v_mfma_f32_16x16x32_bf16 v[144:147], v[36:39], a[112:115], v[144:147]
    ds_read_b64_tr_b16 v[32:33], v5 offset:27680
    v_mfma_f32_16x16x32_bf16 v[180:183], v[36:39], a[116:119], v[180:183]
    ds_read_b64_tr_b16 v[34:35], v5 offset:32288
    s_waitcnt lgkmcnt(6)
    v_mfma_f32_16x16x32_bf16 v[148:151], v[16:19], a[112:115], v[148:151]
    ds_read_b64_tr_b16 v[36:37], v5 offset:27712
    v_mfma_f32_16x16x32_bf16 v[184:187], v[16:19], a[116:119], v[184:187]
    ds_read_b64_tr_b16 v[38:39], v5 offset:32320
    v_mfma_f32_16x16x32_bf16 v[152:155], v[20:23], a[112:115], v[152:155]
    ds_read_b64_tr_b16 v[16:17], v5 offset:27744
    v_mfma_f32_16x16x32_bf16 v[188:191], v[20:23], a[116:119], v[188:191]
    ds_read_b64_tr_b16 v[18:19], v5 offset:32352
    s_waitcnt vmcnt(32) lgkmcnt(6)
    v_mfma_f32_16x16x32_bf16 v[156:159], v[24:27], a[112:115], v[156:159]
    ds_read_b64_tr_b16 v[20:21], v5 offset:27776
    ds_read_b64_tr_b16 v[22:23], v5 offset:32384
    v_mfma_f32_16x16x32_bf16 v[192:195], v[24:27], a[116:119], v[192:195]
    buffer_load_dwordx4 v47, s[52:55], s63 offen offset:3072 lds
    v_mfma_f32_16x16x32_bf16 v[124:127], v[28:31], a[120:123], v[124:127]
    ds_read_b64_tr_b16 v[24:25], v5 offset:27808
    v_mfma_f32_16x16x32_bf16 v[160:163], v[28:31], a[124:127], v[160:163]
    ds_read_b64_tr_b16 v[26:27], v5 offset:32416
    s_waitcnt lgkmcnt(6)
    v_mfma_f32_16x16x32_bf16 v[128:131], v[32:35], a[120:123], v[128:131]
    ds_read_b64_tr_b16 v[28:29], v5 offset:27840
    ds_read_b64_tr_b16 v[30:31], v5 offset:32448
    v_mfma_f32_16x16x32_bf16 v[164:167], v[32:35], a[124:127], v[164:167]
    s_add_u32 m0, s62, 45056
    s_nop 0
    buffer_load_dwordx4 v48, s[52:55], s63 offen offset:0 lds
    v_mfma_f32_16x16x32_bf16 v[132:135], v[36:39], a[120:123], v[132:135]
    ds_read_b64_tr_b16 v[32:33], v5 offset:27872
    v_mfma_f32_16x16x32_bf16 v[168:171], v[36:39], a[124:127], v[168:171]
    ds_read_b64_tr_b16 v[34:35], v5 offset:32480
    s_waitcnt lgkmcnt(6)
    v_mfma_f32_16x16x32_bf16 v[136:139], v[16:19], a[120:123], v[136:139]
    ds_read_b64_tr_b16 v[36:37], v5 offset:27904
    v_mfma_f32_16x16x32_bf16 v[172:175], v[16:19], a[124:127], v[172:175]
    ds_read_b64_tr_b16 v[38:39], v5 offset:32512
    v_mfma_f32_16x16x32_bf16 v[140:143], v[20:23], a[120:123], v[140:143]
    s_waitcnt vmcnt(13)
    s_barrier
    ds_read_b64_tr_b16 v[16:17], v3 offset:0
    v_mfma_f32_16x16x32_bf16 v[176:179], v[20:23], a[124:127], v[176:179]
    ds_read_b64_tr_b16 v[18:19], v3 offset:4608
    s_waitcnt lgkmcnt(6)
    v_mfma_f32_16x16x32_bf16 v[144:147], v[24:27], a[120:123], v[144:147]
    ds_read_b64_tr_b16 v[20:21], v3 offset:32
    ds_read_b64_tr_b16 v[22:23], v3 offset:4640
    v_mfma_f32_16x16x32_bf16 v[180:183], v[24:27], a[124:127], v[180:183]
    s_add_u32 s18, s14, 24576
    buffer_load_dwordx4 a[192:195], v1, s[24:27], s18 offen offset:0
    v_mfma_f32_16x16x32_bf16 v[148:151], v[28:31], a[120:123], v[148:151]
    ds_read_b64_tr_b16 v[24:25], v3 offset:64
    v_mfma_f32_16x16x32_bf16 v[184:187], v[28:31], a[124:127], v[184:187]
    ds_read_b64_tr_b16 v[26:27], v3 offset:4672
    s_waitcnt lgkmcnt(6)
    v_mfma_f32_16x16x32_bf16 v[152:155], v[32:35], a[120:123], v[152:155]
    ds_read_b64_tr_b16 v[28:29], v3 offset:96
    ds_read_b64_tr_b16 v[30:31], v3 offset:4704
    v_mfma_f32_16x16x32_bf16 v[188:191], v[32:35], a[124:127], v[188:191]
    s_add_u32 m0, s62, 73728
    s_add_u32 s63, s60, 884736
    buffer_load_dwordx4 v40, s[52:55], s63 offen offset:0 lds
    v_mfma_f32_16x16x32_bf16 v[156:159], v[36:39], a[120:123], v[156:159]
    ds_read_b64_tr_b16 v[32:33], v3 offset:128
    v_mfma_f32_16x16x32_bf16 v[192:195], v[36:39], a[124:127], v[192:195]
    ds_read_b64_tr_b16 v[34:35], v3 offset:4736
    s_waitcnt lgkmcnt(6)
    v_mfma_f32_16x16x32_bf16 v[124:127], v[16:19], a[128:131], v[124:127]
    ds_read_b64_tr_b16 v[36:37], v3 offset:160
    ds_read_b64_tr_b16 v[38:39], v3 offset:4768
    v_mfma_f32_16x16x32_bf16 v[160:163], v[16:19], a[132:135], v[160:163]
    buffer_load_dwordx4 v41, s[52:55], s63 offen offset:1024 lds
    v_mfma_f32_16x16x32_bf16 v[128:131], v[20:23], a[128:131], v[128:131]
    ds_read_b64_tr_b16 v[16:17], v3 offset:192
    v_mfma_f32_16x16x32_bf16 v[164:167], v[20:23], a[132:135], v[164:167]
    ds_read_b64_tr_b16 v[18:19], v3 offset:4800
    s_waitcnt lgkmcnt(6)
    v_mfma_f32_16x16x32_bf16 v[132:135], v[24:27], a[128:131], v[132:135]
    ds_read_b64_tr_b16 v[20:21], v3 offset:224
    v_mfma_f32_16x16x32_bf16 v[168:171], v[24:27], a[132:135], v[168:171]
    ds_read_b64_tr_b16 v[22:23], v3 offset:4832
    v_mfma_f32_16x16x32_bf16 v[136:139], v[28:31], a[128:131], v[136:139]
    ds_read_b64_tr_b16 v[24:25], v3 offset:256
    v_mfma_f32_16x16x32_bf16 v[172:175], v[28:31], a[132:135], v[172:175]
    ds_read_b64_tr_b16 v[26:27], v3 offset:4864
    s_waitcnt lgkmcnt(6)
    v_mfma_f32_16x16x32_bf16 v[140:143], v[32:35], a[128:131], v[140:143]
    ds_read_b64_tr_b16 v[28:29], v3 offset:9216
    ds_read_b64_tr_b16 v[30:31], v3 offset:13824
    v_mfma_f32_16x16x32_bf16 v[176:179], v[32:35], a[132:135], v[176:179]
    buffer_load_dwordx4 a[196:199], v2, s[24:27], s18 offen offset:0
    v_mfma_f32_16x16x32_bf16 v[144:147], v[36:39], a[128:131], v[144:147]
    ds_read_b64_tr_b16 v[32:33], v3 offset:9248
    v_mfma_f32_16x16x32_bf16 v[180:183], v[36:39], a[132:135], v[180:183]
    ds_read_b64_tr_b16 v[34:35], v3 offset:13856
    s_waitcnt lgkmcnt(6)
    v_mfma_f32_16x16x32_bf16 v[148:151], v[16:19], a[128:131], v[148:151]
    ds_read_b64_tr_b16 v[36:37], v3 offset:9280
    ds_read_b64_tr_b16 v[38:39], v3 offset:13888
    v_mfma_f32_16x16x32_bf16 v[184:187], v[16:19], a[132:135], v[184:187]
    buffer_load_dwordx4 v42, s[52:55], s63 offen offset:2048 lds
    v_mfma_f32_16x16x32_bf16 v[152:155], v[20:23], a[128:131], v[152:155]
    ds_read_b64_tr_b16 v[16:17], v3 offset:9312
    v_mfma_f32_16x16x32_bf16 v[188:191], v[20:23], a[132:135], v[188:191]
    ds_read_b64_tr_b16 v[18:19], v3 offset:13920
    s_waitcnt lgkmcnt(6)
    v_mfma_f32_16x16x32_bf16 v[156:159], v[24:27], a[128:131], v[156:159]
    ds_read_b64_tr_b16 v[20:21], v3 offset:9344
    ds_read_b64_tr_b16 v[22:23], v3 offset:13952
    v_mfma_f32_16x16x32_bf16 v[192:195], v[24:27], a[132:135], v[192:195]
    buffer_load_dwordx4 v43, s[52:55], s63 offen offset:3072 lds
    v_mfma_f32_16x16x32_bf16 v[124:127], v[28:31], a[136:139], v[124:127]
    ds_read_b64_tr_b16 v[24:25], v3 offset:9376
    v_mfma_f32_16x16x32_bf16 v[160:163], v[28:31], a[140:143], v[160:163]
    ds_read_b64_tr_b16 v[26:27], v3 offset:13984
    s_waitcnt lgkmcnt(6)
    v_mfma_f32_16x16x32_bf16 v[128:131], v[32:35], a[136:139], v[128:131]
    ds_read_b64_tr_b16 v[28:29], v3 offset:9408
    v_mfma_f32_16x16x32_bf16 v[164:167], v[32:35], a[140:143], v[164:167]
    ds_read_b64_tr_b16 v[30:31], v3 offset:14016
    v_mfma_f32_16x16x32_bf16 v[132:135], v[36:39], a[136:139], v[132:135]
    ds_read_b64_tr_b16 v[32:33], v3 offset:9440
    v_mfma_f32_16x16x32_bf16 v[168:171], v[36:39], a[140:143], v[168:171]
    ds_read_b64_tr_b16 v[34:35], v3 offset:14048
    s_waitcnt lgkmcnt(6)
    v_mfma_f32_16x16x32_bf16 v[136:139], v[16:19], a[136:139], v[136:139]
    ds_read_b64_tr_b16 v[36:37], v3 offset:9472
    ds_read_b64_tr_b16 v[38:39], v3 offset:14080
    v_mfma_f32_16x16x32_bf16 v[172:175], v[16:19], a[140:143], v[172:175]
    buffer_load_dwordx4 a[200:203], v1, s[24:27], s18 offen offset:1024
    v_mfma_f32_16x16x32_bf16 v[140:143], v[20:23], a[136:139], v[140:143]
    ds_read_b64_tr_b16 v[16:17], v3 offset:18432
    v_mfma_f32_16x16x32_bf16 v[176:179], v[20:23], a[140:143], v[176:179]
    ds_read_b64_tr_b16 v[18:19], v3 offset:23040
    s_waitcnt lgkmcnt(6)
    v_mfma_f32_16x16x32_bf16 v[144:147], v[24:27], a[136:139], v[144:147]
    ds_read_b64_tr_b16 v[20:21], v3 offset:18464
    ds_read_b64_tr_b16 v[22:23], v3 offset:23072
    v_mfma_f32_16x16x32_bf16 v[180:183], v[24:27], a[140:143], v[180:183]
    s_add_u32 m0, s62, 77824
    s_nop 0
    buffer_load_dwordx4 v44, s[52:55], s63 offen offset:0 lds
    v_mfma_f32_16x16x32_bf16 v[148:151], v[28:31], a[136:139], v[148:151]
    ds_read_b64_tr_b16 v[24:25], v3 offset:18496
    v_mfma_f32_16x16x32_bf16 v[184:187], v[28:31], a[140:143], v[184:187]
    ds_read_b64_tr_b16 v[26:27], v3 offset:23104
    s_waitcnt lgkmcnt(6)
    v_mfma_f32_16x16x32_bf16 v[152:155], v[32:35], a[136:139], v[152:155]
    ds_read_b64_tr_b16 v[28:29], v3 offset:18528
    ds_read_b64_tr_b16 v[30:31], v3 offset:23136
    v_mfma_f32_16x16x32_bf16 v[188:191], v[32:35], a[140:143], v[188:191]
    buffer_load_dwordx4 v45, s[52:55], s63 offen offset:1024 lds
    v_mfma_f32_16x16x32_bf16 v[156:159], v[36:39], a[136:139], v[156:159]
    ds_read_b64_tr_b16 v[32:33], v3 offset:18560
    v_mfma_f32_16x16x32_bf16 v[192:195], v[36:39], a[140:143], v[192:195]
    ds_read_b64_tr_b16 v[34:35], v3 offset:23168
    s_waitcnt lgkmcnt(6)
    v_mfma_f32_16x16x32_bf16 v[124:127], v[16:19], a[144:147], v[124:127]
    ds_read_b64_tr_b16 v[36:37], v3 offset:18592
    v_mfma_f32_16x16x32_bf16 v[160:163], v[16:19], a[148:151], v[160:163]
    ds_read_b64_tr_b16 v[38:39], v3 offset:23200
    v_mfma_f32_16x16x32_bf16 v[128:131], v[20:23], a[144:147], v[128:131]
    ds_read_b64_tr_b16 v[16:17], v3 offset:18624
    v_mfma_f32_16x16x32_bf16 v[164:167], v[20:23], a[148:151], v[164:167]
    ds_read_b64_tr_b16 v[18:19], v3 offset:23232
    s_waitcnt lgkmcnt(6)
    v_mfma_f32_16x16x32_bf16 v[132:135], v[24:27], a[144:147], v[132:135]
    ds_read_b64_tr_b16 v[20:21], v3 offset:18656
    ds_read_b64_tr_b16 v[22:23], v3 offset:23264
    v_mfma_f32_16x16x32_bf16 v[168:171], v[24:27], a[148:151], v[168:171]
    buffer_load_dwordx4 a[204:207], v2, s[24:27], s18 offen offset:1024
    v_mfma_f32_16x16x32_bf16 v[136:139], v[28:31], a[144:147], v[136:139]
    ds_read_b64_tr_b16 v[24:25], v3 offset:18688
    v_mfma_f32_16x16x32_bf16 v[172:175], v[28:31], a[148:151], v[172:175]
    ds_read_b64_tr_b16 v[26:27], v3 offset:23296
    s_waitcnt lgkmcnt(6)
    v_mfma_f32_16x16x32_bf16 v[140:143], v[32:35], a[144:147], v[140:143]
    ds_read_b64_tr_b16 v[28:29], v3 offset:27648
    ds_read_b64_tr_b16 v[30:31], v3 offset:32256
    v_mfma_f32_16x16x32_bf16 v[176:179], v[32:35], a[148:151], v[176:179]
    buffer_load_dwordx4 v46, s[52:55], s63 offen offset:2048 lds
    v_mfma_f32_16x16x32_bf16 v[144:147], v[36:39], a[144:147], v[144:147]
    ds_read_b64_tr_b16 v[32:33], v3 offset:27680
    v_mfma_f32_16x16x32_bf16 v[180:183], v[36:39], a[148:151], v[180:183]
    ds_read_b64_tr_b16 v[34:35], v3 offset:32288
    s_waitcnt lgkmcnt(6)
    v_mfma_f32_16x16x32_bf16 v[148:151], v[16:19], a[144:147], v[148:151]
    ds_read_b64_tr_b16 v[36:37], v3 offset:27712
    v_mfma_f32_16x16x32_bf16 v[184:187], v[16:19], a[148:151], v[184:187]
    ds_read_b64_tr_b16 v[38:39], v3 offset:32320
    v_mfma_f32_16x16x32_bf16 v[152:155], v[20:23], a[144:147], v[152:155]
    ds_read_b64_tr_b16 v[16:17], v3 offset:27744
    v_mfma_f32_16x16x32_bf16 v[188:191], v[20:23], a[148:151], v[188:191]
    ds_read_b64_tr_b16 v[18:19], v3 offset:32352
    s_waitcnt lgkmcnt(6)
    v_mfma_f32_16x16x32_bf16 v[156:159], v[24:27], a[144:147], v[156:159]
    ds_read_b64_tr_b16 v[20:21], v3 offset:27776
    ds_read_b64_tr_b16 v[22:23], v3 offset:32384
    v_mfma_f32_16x16x32_bf16 v[192:195], v[24:27], a[148:151], v[192:195]
    buffer_load_dwordx4 v47, s[52:55], s63 offen offset:3072 lds
    v_mfma_f32_16x16x32_bf16 v[124:127], v[28:31], a[152:155], v[124:127]
    ds_read_b64_tr_b16 v[24:25], v3 offset:27808
    v_mfma_f32_16x16x32_bf16 v[160:163], v[28:31], a[156:159], v[160:163]
    ds_read_b64_tr_b16 v[26:27], v3 offset:32416
    s_waitcnt lgkmcnt(6)
    v_mfma_f32_16x16x32_bf16 v[128:131], v[32:35], a[152:155], v[128:131]
    ds_read_b64_tr_b16 v[28:29], v3 offset:27840
    ds_read_b64_tr_b16 v[30:31], v3 offset:32448
    v_mfma_f32_16x16x32_bf16 v[164:167], v[32:35], a[156:159], v[164:167]
    buffer_load_dwordx4 a[208:211], v1, s[24:27], s18 offen offset:2048
    v_mfma_f32_16x16x32_bf16 v[132:135], v[36:39], a[152:155], v[132:135]
    ds_read_b64_tr_b16 v[32:33], v3 offset:27872
    v_mfma_f32_16x16x32_bf16 v[168:171], v[36:39], a[156:159], v[168:171]
    ds_read_b64_tr_b16 v[34:35], v3 offset:32480
    s_waitcnt lgkmcnt(6)
    v_mfma_f32_16x16x32_bf16 v[136:139], v[16:19], a[152:155], v[136:139]
    ds_read_b64_tr_b16 v[36:37], v3 offset:27904
    ds_read_b64_tr_b16 v[38:39], v3 offset:32512
    v_mfma_f32_16x16x32_bf16 v[172:175], v[16:19], a[156:159], v[172:175]
    s_add_u32 m0, s62, 81920
    s_nop 0
    buffer_load_dwordx4 v48, s[52:55], s63 offen offset:0 lds
    v_mfma_f32_16x16x32_bf16 v[140:143], v[20:23], a[152:155], v[140:143]
    s_waitcnt vmcnt(14)
    s_barrier
    ds_read_b64_tr_b16 v[16:17], v3 offset:36864
    v_mfma_f32_16x16x32_bf16 v[176:179], v[20:23], a[156:159], v[176:179]
    ds_read_b64_tr_b16 v[18:19], v3 offset:41472
    s_waitcnt lgkmcnt(6)
    v_mfma_f32_16x16x32_bf16 v[144:147], v[24:27], a[152:155], v[144:147]
    ds_read_b64_tr_b16 v[20:21], v3 offset:36896
    v_mfma_f32_16x16x32_bf16 v[180:183], v[24:27], a[156:159], v[180:183]
    ds_read_b64_tr_b16 v[22:23], v3 offset:41504
    v_mfma_f32_16x16x32_bf16 v[148:151], v[28:31], a[152:155], v[148:151]
    ds_read_b64_tr_b16 v[24:25], v3 offset:36928
    v_mfma_f32_16x16x32_bf16 v[184:187], v[28:31], a[156:159], v[184:187]
    ds_read_b64_tr_b16 v[26:27], v3 offset:41536
    s_waitcnt lgkmcnt(6)
    v_mfma_f32_16x16x32_bf16 v[152:155], v[32:35], a[152:155], v[152:155]
    ds_read_b64_tr_b16 v[28:29], v3 offset:36960
    ds_read_b64_tr_b16 v[30:31], v3 offset:41568
    v_mfma_f32_16x16x32_bf16 v[188:191], v[32:35], a[156:159], v[188:191]
    s_add_u32 m0, s62, 110592
    s_add_u32 s63, s60, 1032192
    buffer_load_dwordx4 v40, s[52:55], s63 offen offset:0 lds
    v_mfma_f32_16x16x32_bf16 v[156:159], v[36:39], a[152:155], v[156:159]
    ds_read_b64_tr_b16 v[32:33], v3 offset:36992
    v_mfma_f32_16x16x32_bf16 v[192:195], v[36:39], a[156:159], v[192:195]
    ds_read_b64_tr_b16 v[34:35], v3 offset:41600
    s_waitcnt lgkmcnt(6)
    v_mfma_f32_16x16x32_bf16 v[124:127], v[16:19], a[160:163], v[124:127]
    ds_read_b64_tr_b16 v[36:37], v3 offset:37024
    ds_read_b64_tr_b16 v[38:39], v3 offset:41632
    v_mfma_f32_16x16x32_bf16 v[160:163], v[16:19], a[164:167], v[160:163]
    buffer_load_dwordx4 a[212:215], v2, s[24:27], s18 offen offset:2048
    v_mfma_f32_16x16x32_bf16 v[128:131], v[20:23], a[160:163], v[128:131]
    ds_read_b64_tr_b16 v[16:17], v3 offset:37056
    v_mfma_f32_16x16x32_bf16 v[164:167], v[20:23], a[164:167], v[164:167]
    ds_read_b64_tr_b16 v[18:19], v3 offset:41664
    s_waitcnt lgkmcnt(6)
    v_mfma_f32_16x16x32_bf16 v[132:135], v[24:27], a[160:163], v[132:135]
    ds_read_b64_tr_b16 v[20:21], v3 offset:37088
    ds_read_b64_tr_b16 v[22:23], v3 offset:41696
    v_mfma_f32_16x16x32_bf16 v[168:171], v[24:27], a[164:167], v[168:171]
    buffer_load_dwordx4 v41, s[52:55], s63 offen offset:1024 lds
    v_mfma_f32_16x16x32_bf16 v[136:139], v[28:31], a[160:163], v[136:139]
    ds_read_b64_tr_b16 v[24:25], v3 offset:37120
    v_mfma_f32_16x16x32_bf16 v[172:175], v[28:31], a[164:167], v[172:175]
    ds_read_b64_tr_b16 v[26:27], v3 offset:41728
    s_waitcnt lgkmcnt(6)
    v_mfma_f32_16x16x32_bf16 v[140:143], v[32:35], a[160:163], v[140:143]
    ds_read_b64_tr_b16 v[28:29], v3 offset:46080
    v_mfma_f32_16x16x32_bf16 v[176:179], v[32:35], a[164:167], v[176:179]
    ds_read_b64_tr_b16 v[30:31], v3 offset:50688
    v_mfma_f32_16x16x32_bf16 v[144:147], v[36:39], a[160:163], v[144:147]
    ds_read_b64_tr_b16 v[32:33], v3 offset:46112
    v_mfma_f32_16x16x32_bf16 v[180:183], v[36:39], a[164:167], v[180:183]
    ds_read_b64_tr_b16 v[34:35], v3 offset:50720
    s_waitcnt lgkmcnt(6)
    v_mfma_f32_16x16x32_bf16 v[148:151], v[16:19], a[160:163], v[148:151]
    ds_read_b64_tr_b16 v[36:37], v3 offset:46144
    ds_read_b64_tr_b16 v[38:39], v3 offset:50752
    v_mfma_f32_16x16x32_bf16 v[184:187], v[16:19], a[164:167], v[184:187]
    buffer_load_dwordx4 v42, s[52:55], s63 offen offset:2048 lds
    v_mfma_f32_16x16x32_bf16 v[152:155], v[20:23], a[160:163], v[152:155]
    ds_read_b64_tr_b16 v[16:17], v3 offset:46176
    v_mfma_f32_16x16x32_bf16 v[188:191], v[20:23], a[164:167], v[188:191]
    ds_read_b64_tr_b16 v[18:19], v3 offset:50784
    s_waitcnt lgkmcnt(6)
    v_mfma_f32_16x16x32_bf16 v[156:159], v[24:27], a[160:163], v[156:159]
    ds_read_b64_tr_b16 v[20:21], v3 offset:46208
    ds_read_b64_tr_b16 v[22:23], v3 offset:50816
    v_mfma_f32_16x16x32_bf16 v[192:195], v[24:27], a[164:167], v[192:195]
    buffer_load_dwordx4 a[216:219], v1, s[24:27], s18 offen offset:3072
    v_mfma_f32_16x16x32_bf16 v[124:127], v[28:31], a[168:171], v[124:127]
    ds_read_b64_tr_b16 v[24:25], v3 offset:46240
    v_mfma_f32_16x16x32_bf16 v[160:163], v[28:31], a[172:175], v[160:163]
    ds_read_b64_tr_b16 v[26:27], v3 offset:50848
    s_waitcnt lgkmcnt(6)
    v_mfma_f32_16x16x32_bf16 v[128:131], v[32:35], a[168:171], v[128:131]
    ds_read_b64_tr_b16 v[28:29], v3 offset:46272
    ds_read_b64_tr_b16 v[30:31], v3 offset:50880
    v_mfma_f32_16x16x32_bf16 v[164:167], v[32:35], a[172:175], v[164:167]
    buffer_load_dwordx4 v43, s[52:55], s63 offen offset:3072 lds
    v_mfma_f32_16x16x32_bf16 v[132:135], v[36:39], a[168:171], v[132:135]
    ds_read_b64_tr_b16 v[32:33], v3 offset:46304
    v_mfma_f32_16x16x32_bf16 v[168:171], v[36:39], a[172:175], v[168:171]
    ds_read_b64_tr_b16 v[34:35], v3 offset:50912
    s_waitcnt lgkmcnt(6)
    v_mfma_f32_16x16x32_bf16 v[136:139], v[16:19], a[168:171], v[136:139]
    ds_read_b64_tr_b16 v[36:37], v3 offset:46336
    v_mfma_f32_16x16x32_bf16 v[172:175], v[16:19], a[172:175], v[172:175]
    ds_read_b64_tr_b16 v[38:39], v3 offset:50944
    v_mfma_f32_16x16x32_bf16 v[140:143], v[20:23], a[168:171], v[140:143]
    ds_read_b64_tr_b16 v[16:17], v4 offset:0
    v_mfma_f32_16x16x32_bf16 v[176:179], v[20:23], a[172:175], v[176:179]
    ds_read_b64_tr_b16 v[18:19], v4 offset:4608
    s_waitcnt lgkmcnt(6)
    v_mfma_f32_16x16x32_bf16 v[144:147], v[24:27], a[168:171], v[144:147]
    ds_read_b64_tr_b16 v[20:21], v4 offset:32
    ds_read_b64_tr_b16 v[22:23], v4 offset:4640
    v_mfma_f32_16x16x32_bf16 v[180:183], v[24:27], a[172:175], v[180:183]
    s_add_u32 m0, s62, 114688
    s_nop 0
    buffer_load_dwordx4 v44, s[52:55], s63 offen offset:0 lds
    v_mfma_f32_16x16x32_bf16 v[148:151], v[28:31], a[168:171], v[148:151]
    ds_read_b64_tr_b16 v[24:25], v4 offset:64
    v_mfma_f32_16x16x32_bf16 v[184:187], v[28:31], a[172:175], v[184:187]
    ds_read_b64_tr_b16 v[26:27], v4 offset:4672
    s_waitcnt lgkmcnt(6)
    v_mfma_f32_16x16x32_bf16 v[152:155], v[32:35], a[168:171], v[152:155]
    ds_read_b64_tr_b16 v[28:29], v4 offset:96
    ds_read_b64_tr_b16 v[30:31], v4 offset:4704
    v_mfma_f32_16x16x32_bf16 v[188:191], v[32:35], a[172:175], v[188:191]
    buffer_load_dwordx4 a[220:223], v2, s[24:27], s18 offen offset:3072
    v_mfma_f32_16x16x32_bf16 v[156:159], v[36:39], a[168:171], v[156:159]
    ds_read_b64_tr_b16 v[32:33], v4 offset:128
    v_mfma_f32_16x16x32_bf16 v[192:195], v[36:39], a[172:175], v[192:195]
    ds_read_b64_tr_b16 v[34:35], v4 offset:4736
    s_waitcnt lgkmcnt(6)
    v_mfma_f32_16x16x32_bf16 v[124:127], v[16:19], a[176:179], v[124:127]
    ds_read_b64_tr_b16 v[36:37], v4 offset:160
    v_mfma_f32_16x16x32_bf16 v[160:163], v[16:19], a[180:183], v[160:163]
    ds_read_b64_tr_b16 v[38:39], v4 offset:4768
    v_mfma_f32_16x16x32_bf16 v[128:131], v[20:23], a[176:179], v[128:131]
    ds_read_b64_tr_b16 v[16:17], v4 offset:192
    v_mfma_f32_16x16x32_bf16 v[164:167], v[20:23], a[180:183], v[164:167]
    ds_read_b64_tr_b16 v[18:19], v4 offset:4800
    s_waitcnt lgkmcnt(6)
    v_mfma_f32_16x16x32_bf16 v[132:135], v[24:27], a[176:179], v[132:135]
    ds_read_b64_tr_b16 v[20:21], v4 offset:224
    ds_read_b64_tr_b16 v[22:23], v4 offset:4832
    v_mfma_f32_16x16x32_bf16 v[168:171], v[24:27], a[180:183], v[168:171]
    buffer_load_dwordx4 v45, s[52:55], s63 offen offset:1024 lds
    v_mfma_f32_16x16x32_bf16 v[136:139], v[28:31], a[176:179], v[136:139]
    ds_read_b64_tr_b16 v[24:25], v4 offset:256
    v_mfma_f32_16x16x32_bf16 v[172:175], v[28:31], a[180:183], v[172:175]
    ds_read_b64_tr_b16 v[26:27], v4 offset:4864
    s_waitcnt lgkmcnt(6)
    v_mfma_f32_16x16x32_bf16 v[140:143], v[32:35], a[176:179], v[140:143]
    ds_read_b64_tr_b16 v[28:29], v4 offset:9216
    ds_read_b64_tr_b16 v[30:31], v4 offset:13824
    v_mfma_f32_16x16x32_bf16 v[176:179], v[32:35], a[180:183], v[176:179]
    buffer_load_dwordx4 v46, s[52:55], s63 offen offset:2048 lds
    v_mfma_f32_16x16x32_bf16 v[144:147], v[36:39], a[176:179], v[144:147]
    ds_read_b64_tr_b16 v[32:33], v4 offset:9248
    v_mfma_f32_16x16x32_bf16 v[180:183], v[36:39], a[180:183], v[180:183]
    ds_read_b64_tr_b16 v[34:35], v4 offset:13856
    s_waitcnt lgkmcnt(6)
    v_mfma_f32_16x16x32_bf16 v[148:151], v[16:19], a[176:179], v[148:151]
    ds_read_b64_tr_b16 v[36:37], v4 offset:9280
    ds_read_b64_tr_b16 v[38:39], v4 offset:13888
    v_mfma_f32_16x16x32_bf16 v[184:187], v[16:19], a[180:183], v[184:187]
    s_add_u32 s18, s14, 28672
    buffer_load_dwordx4 a[224:227], v1, s[24:27], s18 offen offset:0
    v_mfma_f32_16x16x32_bf16 v[152:155], v[20:23], a[176:179], v[152:155]
    ds_read_b64_tr_b16 v[16:17], v4 offset:9312
    v_mfma_f32_16x16x32_bf16 v[188:191], v[20:23], a[180:183], v[188:191]
    ds_read_b64_tr_b16 v[18:19], v4 offset:13920
    s_waitcnt lgkmcnt(6)
    v_mfma_f32_16x16x32_bf16 v[156:159], v[24:27], a[176:179], v[156:159]
    ds_read_b64_tr_b16 v[20:21], v4 offset:9344
    v_mfma_f32_16x16x32_bf16 v[192:195], v[24:27], a[180:183], v[192:195]
    ds_read_b64_tr_b16 v[22:23], v4 offset:13952
    v_mfma_f32_16x16x32_bf16 v[124:127], v[28:31], a[184:187], v[124:127]
    ds_read_b64_tr_b16 v[24:25], v4 offset:9376
    v_mfma_f32_16x16x32_bf16 v[160:163], v[28:31], a[188:191], v[160:163]
    ds_read_b64_tr_b16 v[26:27], v4 offset:13984
    s_waitcnt lgkmcnt(6)
    v_mfma_f32_16x16x32_bf16 v[128:131], v[32:35], a[184:187], v[128:131]
    ds_read_b64_tr_b16 v[28:29], v4 offset:9408
    ds_read_b64_tr_b16 v[30:31], v4 offset:14016
    v_mfma_f32_16x16x32_bf16 v[164:167], v[32:35], a[188:191], v[164:167]
    buffer_load_dwordx4 v47, s[52:55], s63 offen offset:3072 lds
    v_mfma_f32_16x16x32_bf16 v[132:135], v[36:39], a[184:187], v[132:135]
    ds_read_b64_tr_b16 v[32:33], v4 offset:9440
    v_mfma_f32_16x16x32_bf16 v[168:171], v[36:39], a[188:191], v[168:171]
    ds_read_b64_tr_b16 v[34:35], v4 offset:14048
    s_waitcnt lgkmcnt(6)
    v_mfma_f32_16x16x32_bf16 v[136:139], v[16:19], a[184:187], v[136:139]
    ds_read_b64_tr_b16 v[36:37], v4 offset:9472
    ds_read_b64_tr_b16 v[38:39], v4 offset:14080
    v_mfma_f32_16x16x32_bf16 v[172:175], v[16:19], a[188:191], v[172:175]
    s_add_u32 m0, s62, 118784
    s_nop 0
    buffer_load_dwordx4 v48, s[52:55], s63 offen offset:0 lds
    v_mfma_f32_16x16x32_bf16 v[140:143], v[20:23], a[184:187], v[140:143]
    s_waitcnt vmcnt(13)
    s_barrier
    ds_read_b64_tr_b16 v[16:17], v4 offset:18432
    v_mfma_f32_16x16x32_bf16 v[176:179], v[20:23], a[188:191], v[176:179]
    ds_read_b64_tr_b16 v[18:19], v4 offset:23040
    s_waitcnt lgkmcnt(6)
    v_mfma_f32_16x16x32_bf16 v[144:147], v[24:27], a[184:187], v[144:147]
    ds_read_b64_tr_b16 v[20:21], v4 offset:18464
    ds_read_b64_tr_b16 v[22:23], v4 offset:23072
    v_mfma_f32_16x16x32_bf16 v[180:183], v[24:27], a[188:191], v[180:183]
    buffer_load_dwordx4 a[228:231], v2, s[24:27], s18 offen offset:0
    v_mfma_f32_16x16x32_bf16 v[148:151], v[28:31], a[184:187], v[148:151]
    ds_read_b64_tr_b16 v[24:25], v4 offset:18496
    v_mfma_f32_16x16x32_bf16 v[184:187], v[28:31], a[188:191], v[184:187]
    ds_read_b64_tr_b16 v[26:27], v4 offset:23104
    s_waitcnt lgkmcnt(6)
    v_mfma_f32_16x16x32_bf16 v[152:155], v[32:35], a[184:187], v[152:155]
    ds_read_b64_tr_b16 v[28:29], v4 offset:18528
    v_mfma_f32_16x16x32_bf16 v[188:191], v[32:35], a[188:191], v[188:191]
    ds_read_b64_tr_b16 v[30:31], v4 offset:23136
    v_mfma_f32_16x16x32_bf16 v[156:159], v[36:39], a[184:187], v[156:159]
    ds_read_b64_tr_b16 v[32:33], v4 offset:18560
    v_mfma_f32_16x16x32_bf16 v[192:195], v[36:39], a[188:191], v[192:195]
    ds_read_b64_tr_b16 v[34:35], v4 offset:23168
    s_waitcnt lgkmcnt(6)
    v_mfma_f32_16x16x32_bf16 v[124:127], v[16:19], a[192:195], v[124:127]
    ds_read_b64_tr_b16 v[36:37], v4 offset:18592
    ds_read_b64_tr_b16 v[38:39], v4 offset:23200
    v_mfma_f32_16x16x32_bf16 v[160:163], v[16:19], a[196:199], v[160:163]
    s_add_u32 m0, s62, 0
    s_add_u32 s63, s60, 1179648
    buffer_load_dwordx4 v40, s[52:55], s63 offen offset:0 lds
    v_mfma_f32_16x16x32_bf16 v[128:131], v[20:23], a[192:195], v[128:131]
    ds_read_b64_tr_b16 v[16:17], v4 offset:18624
    v_mfma_f32_16x16x32_bf16 v[164:167], v[20:23], a[196:199], v[164:167]
    ds_read_b64_tr_b16 v[18:19], v4 offset:23232
    s_waitcnt lgkmcnt(6)
    v_mfma_f32_16x16x32_bf16 v[132:135], v[24:27], a[192:195], v[132:135]
    ds_read_b64_tr_b16 v[20:21], v4 offset:18656
    ds_read_b64_tr_b16 v[22:23], v4 offset:23264
    v_mfma_f32_16x16x32_bf16 v[168:171], v[24:27], a[196:199], v[168:171]
    buffer_load_dwordx4 v41, s[52:55], s63 offen offset:1024 lds
    v_mfma_f32_16x16x32_bf16 v[136:139], v[28:31], a[192:195], v[136:139]
    ds_read_b64_tr_b16 v[24:25], v4 offset:18688
    v_mfma_f32_16x16x32_bf16 v[172:175], v[28:31], a[196:199], v[172:175]
    ds_read_b64_tr_b16 v[26:27], v4 offset:23296
    s_waitcnt lgkmcnt(6)
    v_mfma_f32_16x16x32_bf16 v[140:143], v[32:35], a[192:195], v[140:143]
    ds_read_b64_tr_b16 v[28:29], v4 offset:27648
    ds_read_b64_tr_b16 v[30:31], v4 offset:32256
    v_mfma_f32_16x16x32_bf16 v[176:179], v[32:35], a[196:199], v[176:179]
    buffer_load_dwordx4 a[232:235], v1, s[24:27], s18 offen offset:1024
    v_mfma_f32_16x16x32_bf16 v[144:147], v[36:39], a[192:195], v[144:147]
    ds_read_b64_tr_b16 v[32:33], v4 offset:27680
    v_mfma_f32_16x16x32_bf16 v[180:183], v[36:39], a[196:199], v[180:183]
    ds_read_b64_tr_b16 v[34:35], v4 offset:32288
    s_waitcnt lgkmcnt(6)
    v_mfma_f32_16x16x32_bf16 v[148:151], v[16:19], a[192:195], v[148:151]
    ds_read_b64_tr_b16 v[36:37], v4 offset:27712
    v_mfma_f32_16x16x32_bf16 v[184:187], v[16:19], a[196:199], v[184:187]
    ds_read_b64_tr_b16 v[38:39], v4 offset:32320
    v_mfma_f32_16x16x32_bf16 v[152:155], v[20:23], a[192:195], v[152:155]
    ds_read_b64_tr_b16 v[16:17], v4 offset:27744
    v_mfma_f32_16x16x32_bf16 v[188:191], v[20:23], a[196:199], v[188:191]
    ds_read_b64_tr_b16 v[18:19], v4 offset:32352
    s_waitcnt lgkmcnt(6)
    v_mfma_f32_16x16x32_bf16 v[156:159], v[24:27], a[192:195], v[156:159]
    ds_read_b64_tr_b16 v[20:21], v4 offset:27776
    ds_read_b64_tr_b16 v[22:23], v4 offset:32384
    v_mfma_f32_16x16x32_bf16 v[192:195], v[24:27], a[196:199], v[192:195]
    buffer_load_dwordx4 v42, s[52:55], s63 offen offset:2048 lds
    v_mfma_f32_16x16x32_bf16 v[124:127], v[28:31], a[200:203], v[124:127]
    ds_read_b64_tr_b16 v[24:25], v4 offset:27808
    v_mfma_f32_16x16x32_bf16 v[160:163], v[28:31], a[204:207], v[160:163]
    ds_read_b64_tr_b16 v[26:27], v4 offset:32416
    s_waitcnt lgkmcnt(6)
    v_mfma_f32_16x16x32_bf16 v[128:131], v[32:35], a[200:203], v[128:131]
    ds_read_b64_tr_b16 v[28:29], v4 offset:27840
    ds_read_b64_tr_b16 v[30:31], v4 offset:32448
    v_mfma_f32_16x16x32_bf16 v[164:167], v[32:35], a[204:207], v[164:167]
    buffer_load_dwordx4 v43, s[52:55], s63 offen offset:3072 lds
    v_mfma_f32_16x16x32_bf16 v[132:135], v[36:39], a[200:203], v[132:135]
    ds_read_b64_tr_b16 v[32:33], v4 offset:27872
    v_mfma_f32_16x16x32_bf16 v[168:171], v[36:39], a[204:207], v[168:171]
    ds_read_b64_tr_b16 v[34:35], v4 offset:32480
    s_waitcnt lgkmcnt(6)
    v_mfma_f32_16x16x32_bf16 v[136:139], v[16:19], a[200:203], v[136:139]
    ds_read_b64_tr_b16 v[36:37], v4 offset:27904
    v_mfma_f32_16x16x32_bf16 v[172:175], v[16:19], a[204:207], v[172:175]
    ds_read_b64_tr_b16 v[38:39], v4 offset:32512
    v_mfma_f32_16x16x32_bf16 v[140:143], v[20:23], a[200:203], v[140:143]
    ds_read_b64_tr_b16 v[16:17], v4 offset:36864
    v_mfma_f32_16x16x32_bf16 v[176:179], v[20:23], a[204:207], v[176:179]
    ds_read_b64_tr_b16 v[18:19], v4 offset:41472
    s_waitcnt lgkmcnt(6)
    v_mfma_f32_16x16x32_bf16 v[144:147], v[24:27], a[200:203], v[144:147]
    ds_read_b64_tr_b16 v[20:21], v4 offset:36896
    ds_read_b64_tr_b16 v[22:23], v4 offset:41504
    v_mfma_f32_16x16x32_bf16 v[180:183], v[24:27], a[204:207], v[180:183]
    buffer_load_dwordx4 a[236:239], v2, s[24:27], s18 offen offset:1024
    v_mfma_f32_16x16x32_bf16 v[148:151], v[28:31], a[200:203], v[148:151]
    ds_read_b64_tr_b16 v[24:25], v4 offset:36928
    v_mfma_f32_16x16x32_bf16 v[184:187], v[28:31], a[204:207], v[184:187]
    ds_read_b64_tr_b16 v[26:27], v4 offset:41536
    s_waitcnt lgkmcnt(6)
    v_mfma_f32_16x16x32_bf16 v[152:155], v[32:35], a[200:203], v[152:155]
    ds_read_b64_tr_b16 v[28:29], v4 offset:36960
    ds_read_b64_tr_b16 v[30:31], v4 offset:41568
    v_mfma_f32_16x16x32_bf16 v[188:191], v[32:35], a[204:207], v[188:191]
    s_add_u32 m0, s62, 4096
    s_nop 0
    buffer_load_dwordx4 v44, s[52:55], s63 offen offset:0 lds
    v_mfma_f32_16x16x32_bf16 v[156:159], v[36:39], a[200:203], v[156:159]
    ds_read_b64_tr_b16 v[32:33], v4 offset:36992
    v_mfma_f32_16x16x32_bf16 v[192:195], v[36:39], a[204:207], v[192:195]
    ds_read_b64_tr_b16 v[34:35], v4 offset:41600
    s_waitcnt vmcnt(19) lgkmcnt(6)
    v_mfma_f32_16x16x32_bf16 v[124:127], v[16:19], a[208:211], v[124:127]
    ds_read_b64_tr_b16 v[36:37], v4 offset:37024
    ds_read_b64_tr_b16 v[38:39], v4 offset:41632
    v_mfma_f32_16x16x32_bf16 v[160:163], v[16:19], a[212:215], v[160:163]
    buffer_load_dwordx4 v45, s[52:55], s63 offen offset:1024 lds
    v_mfma_f32_16x16x32_bf16 v[128:131], v[20:23], a[208:211], v[128:131]
    ds_read_b64_tr_b16 v[16:17], v4 offset:37056
    v_mfma_f32_16x16x32_bf16 v[164:167], v[20:23], a[212:215], v[164:167]
    ds_read_b64_tr_b16 v[18:19], v4 offset:41664
    s_waitcnt lgkmcnt(6)
    v_mfma_f32_16x16x32_bf16 v[132:135], v[24:27], a[208:211], v[132:135]
    ds_read_b64_tr_b16 v[20:21], v4 offset:37088
    v_mfma_f32_16x16x32_bf16 v[168:171], v[24:27], a[212:215], v[168:171]
    ds_read_b64_tr_b16 v[22:23], v4 offset:41696
    v_mfma_f32_16x16x32_bf16 v[136:139], v[28:31], a[208:211], v[136:139]
    ds_read_b64_tr_b16 v[24:25], v4 offset:37120
    v_mfma_f32_16x16x32_bf16 v[172:175], v[28:31], a[212:215], v[172:175]
    ds_read_b64_tr_b16 v[26:27], v4 offset:41728
    s_waitcnt lgkmcnt(6)
    v_mfma_f32_16x16x32_bf16 v[140:143], v[32:35], a[208:211], v[140:143]
    ds_read_b64_tr_b16 v[28:29], v4 offset:46080
    ds_read_b64_tr_b16 v[30:31], v4 offset:50688
    v_mfma_f32_16x16x32_bf16 v[176:179], v[32:35], a[212:215], v[176:179]
    buffer_load_dwordx4 a[240:243], v1, s[24:27], s18 offen offset:2048
    v_mfma_f32_16x16x32_bf16 v[144:147], v[36:39], a[208:211], v[144:147]
    ds_read_b64_tr_b16 v[32:33], v4 offset:46112
    v_mfma_f32_16x16x32_bf16 v[180:183], v[36:39], a[212:215], v[180:183]
    ds_read_b64_tr_b16 v[34:35], v4 offset:50720
    s_waitcnt lgkmcnt(6)
    v_mfma_f32_16x16x32_bf16 v[148:151], v[16:19], a[208:211], v[148:151]
    ds_read_b64_tr_b16 v[36:37], v4 offset:46144
    ds_read_b64_tr_b16 v[38:39], v4 offset:50752
    v_mfma_f32_16x16x32_bf16 v[184:187], v[16:19], a[212:215], v[184:187]
    buffer_load_dwordx4 v46, s[52:55], s63 offen offset:2048 lds
    v_mfma_f32_16x16x32_bf16 v[152:155], v[20:23], a[208:211], v[152:155]
    ds_read_b64_tr_b16 v[16:17], v4 offset:46176
    v_mfma_f32_16x16x32_bf16 v[188:191], v[20:23], a[212:215], v[188:191]
    ds_read_b64_tr_b16 v[18:19], v4 offset:50784
    s_waitcnt vmcnt(16) lgkmcnt(6)
    v_mfma_f32_16x16x32_bf16 v[156:159], v[24:27], a[208:211], v[156:159]
    ds_read_b64_tr_b16 v[20:21], v4 offset:46208
    ds_read_b64_tr_b16 v[22:23], v4 offset:50816
    v_mfma_f32_16x16x32_bf16 v[192:195], v[24:27], a[212:215], v[192:195]
    buffer_load_dwordx4 v47, s[52:55], s63 offen offset:3072 lds
    v_mfma_f32_16x16x32_bf16 v[124:127], v[28:31], a[216:219], v[124:127]
    ds_read_b64_tr_b16 v[24:25], v4 offset:46240
    v_mfma_f32_16x16x32_bf16 v[160:163], v[28:31], a[220:223], v[160:163]
    ds_read_b64_tr_b16 v[26:27], v4 offset:50848
    s_waitcnt lgkmcnt(6)
    v_mfma_f32_16x16x32_bf16 v[128:131], v[32:35], a[216:219], v[128:131]
    ds_read_b64_tr_b16 v[28:29], v4 offset:46272
    v_mfma_f32_16x16x32_bf16 v[164:167], v[32:35], a[220:223], v[164:167]
    ds_read_b64_tr_b16 v[30:31], v4 offset:50880
    v_mfma_f32_16x16x32_bf16 v[132:135], v[36:39], a[216:219], v[132:135]
    ds_read_b64_tr_b16 v[32:33], v4 offset:46304
    v_mfma_f32_16x16x32_bf16 v[168:171], v[36:39], a[220:223], v[168:171]
    ds_read_b64_tr_b16 v[34:35], v4 offset:50912
    s_waitcnt lgkmcnt(6)
    v_mfma_f32_16x16x32_bf16 v[136:139], v[16:19], a[216:219], v[136:139]
    ds_read_b64_tr_b16 v[36:37], v4 offset:46336
    ds_read_b64_tr_b16 v[38:39], v4 offset:50944
    v_mfma_f32_16x16x32_bf16 v[172:175], v[16:19], a[220:223], v[172:175]
    buffer_load_dwordx4 a[244:247], v2, s[24:27], s18 offen offset:2048
    v_mfma_f32_16x16x32_bf16 v[140:143], v[20:23], a[216:219], v[140:143]
    s_waitcnt vmcnt(13)
    s_barrier
    ds_read_b64_tr_b16 v[16:17], v5 offset:0
    v_mfma_f32_16x16x32_bf16 v[176:179], v[20:23], a[220:223], v[176:179]
    ds_read_b64_tr_b16 v[18:19], v5 offset:4608
    s_waitcnt lgkmcnt(6)
    v_mfma_f32_16x16x32_bf16 v[144:147], v[24:27], a[216:219], v[144:147]
    ds_read_b64_tr_b16 v[20:21], v5 offset:32
    ds_read_b64_tr_b16 v[22:23], v5 offset:4640
    v_mfma_f32_16x16x32_bf16 v[180:183], v[24:27], a[220:223], v[180:183]
    s_add_u32 m0, s62, 8192
    s_nop 0
    buffer_load_dwordx4 v48, s[52:55], s63 offen offset:0 lds
    v_mfma_f32_16x16x32_bf16 v[148:151], v[28:31], a[216:219], v[148:151]
    ds_read_b64_tr_b16 v[24:25], v5 offset:64
    v_mfma_f32_16x16x32_bf16 v[184:187], v[28:31], a[220:223], v[184:187]
    ds_read_b64_tr_b16 v[26:27], v5 offset:4672
    s_waitcnt lgkmcnt(6)
    v_mfma_f32_16x16x32_bf16 v[152:155], v[32:35], a[216:219], v[152:155]
    ds_read_b64_tr_b16 v[28:29], v5 offset:96
    ds_read_b64_tr_b16 v[30:31], v5 offset:4704
    v_mfma_f32_16x16x32_bf16 v[188:191], v[32:35], a[220:223], v[188:191]
    buffer_load_dwordx4 a[248:251], v1, s[24:27], s18 offen offset:3072
    v_mfma_f32_16x16x32_bf16 v[156:159], v[36:39], a[216:219], v[156:159]
    ds_read_b64_tr_b16 v[32:33], v5 offset:128
    v_mfma_f32_16x16x32_bf16 v[192:195], v[36:39], a[220:223], v[192:195]
    ds_read_b64_tr_b16 v[34:35], v5 offset:4736
    s_waitcnt vmcnt(14) lgkmcnt(6)
    v_mfma_f32_16x16x32_bf16 v[124:127], v[16:19], a[224:227], v[124:127]
    ds_read_b64_tr_b16 v[36:37], v5 offset:160
    v_mfma_f32_16x16x32_bf16 v[160:163], v[16:19], a[228:231], v[160:163]
    ds_read_b64_tr_b16 v[38:39], v5 offset:4768
    v_mfma_f32_16x16x32_bf16 v[128:131], v[20:23], a[224:227], v[128:131]
    ds_read_b64_tr_b16 v[16:17], v5 offset:192
    v_mfma_f32_16x16x32_bf16 v[164:167], v[20:23], a[228:231], v[164:167]
    ds_read_b64_tr_b16 v[18:19], v5 offset:4800
    s_waitcnt lgkmcnt(6)
    v_mfma_f32_16x16x32_bf16 v[132:135], v[24:27], a[224:227], v[132:135]
    ds_read_b64_tr_b16 v[20:21], v5 offset:224
    ds_read_b64_tr_b16 v[22:23], v5 offset:4832
    v_mfma_f32_16x16x32_bf16 v[168:171], v[24:27], a[228:231], v[168:171]
    buffer_load_dwordx4 a[252:255], v2, s[24:27], s18 offen offset:3072
    v_mfma_f32_16x16x32_bf16 v[136:139], v[28:31], a[224:227], v[136:139]
    ds_read_b64_tr_b16 v[24:25], v5 offset:256
    v_mfma_f32_16x16x32_bf16 v[172:175], v[28:31], a[228:231], v[172:175]
    ds_read_b64_tr_b16 v[26:27], v5 offset:4864
    s_waitcnt lgkmcnt(6)
    v_mfma_f32_16x16x32_bf16 v[140:143], v[32:35], a[224:227], v[140:143]
    ds_read_b64_tr_b16 v[28:29], v5 offset:9216
    ds_read_b64_tr_b16 v[30:31], v5 offset:13824
    v_mfma_f32_16x16x32_bf16 v[176:179], v[32:35], a[228:231], v[176:179]
    s_add_u32 s18, s14, 32768
    buffer_load_dwordx4 v[224:227], v1, s[24:27], s18 offen offset:0
    v_mfma_f32_16x16x32_bf16 v[144:147], v[36:39], a[224:227], v[144:147]
    ds_read_b64_tr_b16 v[32:33], v5 offset:9248
    v_mfma_f32_16x16x32_bf16 v[180:183], v[36:39], a[228:231], v[180:183]
    ds_read_b64_tr_b16 v[34:35], v5 offset:13856
    s_waitcnt lgkmcnt(6)
    v_mfma_f32_16x16x32_bf16 v[148:151], v[16:19], a[224:227], v[148:151]
    ds_read_b64_tr_b16 v[36:37], v5 offset:9280
    v_mfma_f32_16x16x32_bf16 v[184:187], v[16:19], a[228:231], v[184:187]
    ds_read_b64_tr_b16 v[38:39], v5 offset:13888
    v_mfma_f32_16x16x32_bf16 v[152:155], v[20:23], a[224:227], v[152:155]
    ds_read_b64_tr_b16 v[16:17], v5 offset:9312
    v_mfma_f32_16x16x32_bf16 v[188:191], v[20:23], a[228:231], v[188:191]
    ds_read_b64_tr_b16 v[18:19], v5 offset:13920
    s_waitcnt vmcnt(10) lgkmcnt(6)
    v_mfma_f32_16x16x32_bf16 v[156:159], v[24:27], a[224:227], v[156:159]
    ds_read_b64_tr_b16 v[20:21], v5 offset:9344
    ds_read_b64_tr_b16 v[22:23], v5 offset:13952
    v_mfma_f32_16x16x32_bf16 v[192:195], v[24:27], a[228:231], v[192:195]
    buffer_load_dwordx4 v[228:231], v2, s[24:27], s18 offen offset:0
    v_mfma_f32_16x16x32_bf16 v[124:127], v[28:31], a[232:235], v[124:127]
    ds_read_b64_tr_b16 v[24:25], v5 offset:9376
    v_mfma_f32_16x16x32_bf16 v[160:163], v[28:31], a[236:239], v[160:163]
    ds_read_b64_tr_b16 v[26:27], v5 offset:13984
    s_waitcnt lgkmcnt(6)
    v_mfma_f32_16x16x32_bf16 v[128:131], v[32:35], a[232:235], v[128:131]
    ds_read_b64_tr_b16 v[28:29], v5 offset:9408
    ds_read_b64_tr_b16 v[30:31], v5 offset:14016
    v_mfma_f32_16x16x32_bf16 v[164:167], v[32:35], a[236:239], v[164:167]
    buffer_load_dwordx4 v[232:235], v1, s[24:27], s18 offen offset:1024
    v_mfma_f32_16x16x32_bf16 v[132:135], v[36:39], a[232:235], v[132:135]
    ds_read_b64_tr_b16 v[32:33], v5 offset:9440
    v_mfma_f32_16x16x32_bf16 v[168:171], v[36:39], a[236:239], v[168:171]
    ds_read_b64_tr_b16 v[34:35], v5 offset:14048
    s_waitcnt lgkmcnt(6)
    v_mfma_f32_16x16x32_bf16 v[136:139], v[16:19], a[232:235], v[136:139]
    ds_read_b64_tr_b16 v[36:37], v5 offset:9472
    ds_read_b64_tr_b16 v[38:39], v5 offset:14080
    v_mfma_f32_16x16x32_bf16 v[172:175], v[16:19], a[236:239], v[172:175]
    buffer_load_dwordx4 v[236:239], v2, s[24:27], s18 offen offset:1024
    v_mfma_f32_16x16x32_bf16 v[140:143], v[20:23], a[232:235], v[140:143]
    ds_read_b64_tr_b16 v[16:17], v5 offset:18432
    v_mfma_f32_16x16x32_bf16 v[176:179], v[20:23], a[236:239], v[176:179]
    ds_read_b64_tr_b16 v[18:19], v5 offset:23040
    s_waitcnt lgkmcnt(6)
    v_mfma_f32_16x16x32_bf16 v[144:147], v[24:27], a[232:235], v[144:147]
    ds_read_b64_tr_b16 v[20:21], v5 offset:18464
    v_mfma_f32_16x16x32_bf16 v[180:183], v[24:27], a[236:239], v[180:183]
    ds_read_b64_tr_b16 v[22:23], v5 offset:23072
    v_mfma_f32_16x16x32_bf16 v[148:151], v[28:31], a[232:235], v[148:151]
    ds_read_b64_tr_b16 v[24:25], v5 offset:18496
    v_mfma_f32_16x16x32_bf16 v[184:187], v[28:31], a[236:239], v[184:187]
    ds_read_b64_tr_b16 v[26:27], v5 offset:23104
    s_waitcnt lgkmcnt(6)
    v_mfma_f32_16x16x32_bf16 v[152:155], v[32:35], a[232:235], v[152:155]
    ds_read_b64_tr_b16 v[28:29], v5 offset:18528
    ds_read_b64_tr_b16 v[30:31], v5 offset:23136
    v_mfma_f32_16x16x32_bf16 v[188:191], v[32:35], a[236:239], v[188:191]
    buffer_load_dwordx4 v[240:243], v1, s[24:27], s18 offen offset:2048
    v_mfma_f32_16x16x32_bf16 v[156:159], v[36:39], a[232:235], v[156:159]
    ds_read_b64_tr_b16 v[32:33], v5 offset:18560
    v_mfma_f32_16x16x32_bf16 v[192:195], v[36:39], a[236:239], v[192:195]
    ds_read_b64_tr_b16 v[34:35], v5 offset:23168
    s_waitcnt vmcnt(8) lgkmcnt(6)
    v_mfma_f32_16x16x32_bf16 v[124:127], v[16:19], a[240:243], v[124:127]
    ds_read_b64_tr_b16 v[36:37], v5 offset:18592
    ds_read_b64_tr_b16 v[38:39], v5 offset:23200
    v_mfma_f32_16x16x32_bf16 v[160:163], v[16:19], a[244:247], v[160:163]
    buffer_load_dwordx4 v[244:247], v2, s[24:27], s18 offen offset:2048
    v_mfma_f32_16x16x32_bf16 v[128:131], v[20:23], a[240:243], v[128:131]
    ds_read_b64_tr_b16 v[16:17], v5 offset:18624
    v_mfma_f32_16x16x32_bf16 v[164:167], v[20:23], a[244:247], v[164:167]
    ds_read_b64_tr_b16 v[18:19], v5 offset:23232
    s_waitcnt lgkmcnt(6)
    v_mfma_f32_16x16x32_bf16 v[132:135], v[24:27], a[240:243], v[132:135]
    ds_read_b64_tr_b16 v[20:21], v5 offset:18656
    ds_read_b64_tr_b16 v[22:23], v5 offset:23264
    v_mfma_f32_16x16x32_bf16 v[168:171], v[24:27], a[244:247], v[168:171]
    buffer_load_dwordx4 v[248:251], v1, s[24:27], s18 offen offset:3072
    v_mfma_f32_16x16x32_bf16 v[136:139], v[28:31], a[240:243], v[136:139]
    ds_read_b64_tr_b16 v[24:25], v5 offset:18688
    v_mfma_f32_16x16x32_bf16 v[172:175], v[28:31], a[244:247], v[172:175]
    ds_read_b64_tr_b16 v[26:27], v5 offset:23296
    s_waitcnt lgkmcnt(6)
    v_mfma_f32_16x16x32_bf16 v[140:143], v[32:35], a[240:243], v[140:143]
    ds_read_b64_tr_b16 v[28:29], v5 offset:27648
    v_mfma_f32_16x16x32_bf16 v[176:179], v[32:35], a[244:247], v[176:179]
    ds_read_b64_tr_b16 v[30:31], v5 offset:32256
    v_mfma_f32_16x16x32_bf16 v[144:147], v[36:39], a[240:243], v[144:147]
    ds_read_b64_tr_b16 v[32:33], v5 offset:27680
    v_mfma_f32_16x16x32_bf16 v[180:183], v[36:39], a[244:247], v[180:183]
    ds_read_b64_tr_b16 v[34:35], v5 offset:32288
    s_waitcnt lgkmcnt(6)
    v_mfma_f32_16x16x32_bf16 v[148:151], v[16:19], a[240:243], v[148:151]
    ds_read_b64_tr_b16 v[36:37], v5 offset:27712
    ds_read_b64_tr_b16 v[38:39], v5 offset:32320
    v_mfma_f32_16x16x32_bf16 v[184:187], v[16:19], a[244:247], v[184:187]
    buffer_load_dwordx4 v[252:255], v2, s[24:27], s18 offen offset:3072
    v_mfma_f32_16x16x32_bf16 v[152:155], v[20:23], a[240:243], v[152:155]
    ds_read_b64_tr_b16 v[16:17], v5 offset:27744
    v_mfma_f32_16x16x32_bf16 v[188:191], v[20:23], a[244:247], v[188:191]
    ds_read_b64_tr_b16 v[18:19], v5 offset:32352
    s_waitcnt vmcnt(8) lgkmcnt(6)
    v_mfma_f32_16x16x32_bf16 v[156:159], v[24:27], a[240:243], v[156:159]
    ds_read_b64_tr_b16 v[20:21], v5 offset:27776
    ds_read_b64_tr_b16 v[22:23], v5 offset:32384
    v_mfma_f32_16x16x32_bf16 v[192:195], v[24:27], a[244:247], v[192:195]
    buffer_load_dwordx4 v[196:199], v9, s[20:23], s36 offen sc1
    v_mfma_f32_16x16x32_bf16 v[124:127], v[28:31], a[248:251], v[124:127]
    ds_read_b64_tr_b16 v[24:25], v5 offset:27808
    v_mfma_f32_16x16x32_bf16 v[160:163], v[28:31], a[252:255], v[160:163]
    ds_read_b64_tr_b16 v[26:27], v5 offset:32416
    s_waitcnt lgkmcnt(6)
    v_mfma_f32_16x16x32_bf16 v[128:131], v[32:35], a[248:251], v[128:131]
    ds_read_b64_tr_b16 v[28:29], v5 offset:27840
    ds_read_b64_tr_b16 v[30:31], v5 offset:32448
    v_mfma_f32_16x16x32_bf16 v[164:167], v[32:35], a[252:255], v[164:167]
    buffer_load_dwordx4 v[200:203], v9, s[20:23], s37 offen sc1
    v_mfma_f32_16x16x32_bf16 v[132:135], v[36:39], a[248:251], v[132:135]
    ds_read_b64_tr_b16 v[32:33], v5 offset:27872
    v_mfma_f32_16x16x32_bf16 v[168:171], v[36:39], a[252:255], v[168:171]
    ds_read_b64_tr_b16 v[34:35], v5 offset:32480
    s_waitcnt lgkmcnt(6)
    v_mfma_f32_16x16x32_bf16 v[136:139], v[16:19], a[248:251], v[136:139]
    ds_read_b64_tr_b16 v[36:37], v5 offset:27904
    v_mfma_f32_16x16x32_bf16 v[172:175], v[16:19], a[252:255], v[172:175]
    ds_read_b64_tr_b16 v[38:39], v5 offset:32512
    v_mfma_f32_16x16x32_bf16 v[140:143], v[20:23], a[248:251], v[140:143]
    s_barrier
    ds_read_b64_tr_b16 v[16:17], v3 offset:0
    v_mfma_f32_16x16x32_bf16 v[176:179], v[20:23], a[252:255], v[176:179]
    ds_read_b64_tr_b16 v[18:19], v3 offset:4608
    s_waitcnt lgkmcnt(6)
    v_mfma_f32_16x16x32_bf16 v[144:147], v[24:27], a[248:251], v[144:147]
    ds_read_b64_tr_b16 v[20:21], v3 offset:9216
    ds_read_b64_tr_b16 v[22:23], v3 offset:13824
    v_mfma_f32_16x16x32_bf16 v[180:183], v[24:27], a[252:255], v[180:183]
    buffer_load_dwordx4 v[204:207], v10, s[20:23], s38 offen sc1
    v_mfma_f32_16x16x32_bf16 v[148:151], v[28:31], a[248:251], v[148:151]
    ds_read_b64_tr_b16 v[24:25], v3 offset:18432
    v_mfma_f32_16x16x32_bf16 v[184:187], v[28:31], a[252:255], v[184:187]
    ds_read_b64_tr_b16 v[26:27], v3 offset:23040
    s_waitcnt lgkmcnt(6)
    v_mfma_f32_16x16x32_bf16 v[152:155], v[32:35], a[248:251], v[152:155]
    ds_read_b64_tr_b16 v[28:29], v3 offset:27648
    ds_read_b64_tr_b16 v[30:31], v3 offset:32256
    v_mfma_f32_16x16x32_bf16 v[188:191], v[32:35], a[252:255], v[188:191]
    buffer_load_dwordx4 v[208:211], v12, s[32:35], s39 offen
    v_mfma_f32_16x16x32_bf16 v[156:159], v[36:39], a[248:251], v[156:159]
    ds_read_b64_tr_b16 v[32:33], v3 offset:32
    v_mfma_f32_16x16x32_bf16 v[192:195], v[36:39], a[252:255], v[192:195]
    ds_read_b64_tr_b16 v[34:35], v3 offset:4640
    s_waitcnt vmcnt(8) lgkmcnt(6)
    v_mfma_f32_16x16x32_bf16 v[124:127], v[16:19], v[224:227], v[124:127]
    ds_read_b64_tr_b16 v[36:37], v3 offset:9248
    v_mfma_f32_16x16x32_bf16 v[160:163], v[16:19], v[228:231], v[160:163]
    ds_read_b64_tr_b16 v[38:39], v3 offset:13856
    v_mfma_f32_16x16x32_bf16 v[124:127], v[20:23], v[232:235], v[124:127]
    ds_read_b64_tr_b16 v[16:17], v3 offset:18464
    v_mfma_f32_16x16x32_bf16 v[160:163], v[20:23], v[236:239], v[160:163]
    ds_read_b64_tr_b16 v[18:19], v3 offset:23072
    s_waitcnt vmcnt(4) lgkmcnt(6)
    v_mfma_f32_16x16x32_bf16 v[124:127], v[24:27], v[240:243], v[124:127]
    ds_read_b64_tr_b16 v[20:21], v3 offset:27680
    ds_read_b64_tr_b16 v[22:23], v3 offset:32288
    v_mfma_f32_16x16x32_bf16 v[160:163], v[24:27], v[244:247], v[160:163]
    buffer_load_dwordx4 v[212:215], v13, s[32:35], s40 offen
    v_mfma_f32_16x16x32_bf16 v[124:127], v[28:31], v[248:251], v[124:127]
    ds_read_b64_tr_b16 v[24:25], v3 offset:64
    v_mfma_f32_16x16x32_bf16 v[160:163], v[28:31], v[252:255], v[160:163]
    ds_read_b64_tr_b16 v[26:27], v3 offset:4672
    s_waitcnt lgkmcnt(6)
    v_mfma_f32_16x16x32_bf16 v[128:131], v[32:35], v[224:227], v[128:131]
    ds_read_b64_tr_b16 v[28:29], v3 offset:9280
    v_mfma_f32_16x16x32_bf16 v[164:167], v[32:35], v[228:231], v[164:167]
    ds_read_b64_tr_b16 v[30:31], v3 offset:13888
    v_mfma_f32_16x16x32_bf16 v[128:131], v[36:39], v[232:235], v[128:131]
    ds_read_b64_tr_b16 v[32:33], v3 offset:18496
    v_mfma_f32_16x16x32_bf16 v[164:167], v[36:39], v[236:239], v[164:167]
    ds_read_b64_tr_b16 v[34:35], v3 offset:23104
    s_waitcnt lgkmcnt(6)
    v_mfma_f32_16x16x32_bf16 v[128:131], v[16:19], v[240:243], v[128:131]
    ds_read_b64_tr_b16 v[36:37], v3 offset:27712
    v_mfma_f32_16x16x32_bf16 v[164:167], v[16:19], v[244:247], v[164:167]
    ds_read_b64_tr_b16 v[38:39], v3 offset:32320
    v_mfma_f32_16x16x32_bf16 v[128:131], v[20:23], v[248:251], v[128:131]
    ds_read_b64_tr_b16 v[16:17], v3 offset:96
    v_mfma_f32_16x16x32_bf16 v[164:167], v[20:23], v[252:255], v[164:167]
    ds_read_b64_tr_b16 v[18:19], v3 offset:4704
    s_waitcnt lgkmcnt(6)
    v_mfma_f32_16x16x32_bf16 v[132:135], v[24:27], v[224:227], v[132:135]
    ds_read_b64_tr_b16 v[20:21], v3 offset:9312
    v_mfma_f32_16x16x32_bf16 v[168:171], v[24:27], v[228:231], v[168:171]
    ds_read_b64_tr_b16 v[22:23], v3 offset:13920
    v_mfma_f32_16x16x32_bf16 v[132:135], v[28:31], v[232:235], v[132:135]
    ds_read_b64_tr_b16 v[24:25], v3 offset:18528
    v_mfma_f32_16x16x32_bf16 v[168:171], v[28:31], v[236:239], v[168:171]
    ds_read_b64_tr_b16 v[26:27], v3 offset:23136
    s_waitcnt lgkmcnt(6)
    v_mfma_f32_16x16x32_bf16 v[132:135], v[32:35], v[240:243], v[132:135]
    ds_read_b64_tr_b16 v[28:29], v3 offset:27744
    v_cvt_pk_bf16_f32 v52, v124, v125
    v_mfma_f32_16x16x32_bf16 v[168:171], v[32:35], v[244:247], v[168:171]
    ds_read_b64_tr_b16 v[30:31], v3 offset:32352
    v_cvt_pk_bf16_f32 v68, v160, v161
    v_mfma_f32_16x16x32_bf16 v[132:135], v[36:39], v[248:251], v[132:135]
    ds_read_b64_tr_b16 v[32:33], v3 offset:128
    v_cvt_pk_bf16_f32 v53, v126, v127
    v_mfma_f32_16x16x32_bf16 v[168:171], v[36:39], v[252:255], v[168:171]
    ds_read_b64_tr_b16 v[34:35], v3 offset:4736
    v_cvt_pk_bf16_f32 v69, v162, v163
    s_waitcnt lgkmcnt(6)
    v_mfma_f32_16x16x32_bf16 v[136:139], v[16:19], v[224:227], v[136:139]
    ds_read_b64_tr_b16 v[36:37], v3 offset:9344
    v_cvt_pk_bf16_f32 v54, v128, v129
    v_mfma_f32_16x16x32_bf16 v[172:175], v[16:19], v[228:231], v[172:175]
    ds_read_b64_tr_b16 v[38:39], v3 offset:13952
    v_cvt_pk_bf16_f32 v70, v164, v165
    v_mfma_f32_16x16x32_bf16 v[136:139], v[20:23], v[232:235], v[136:139]
    ds_read_b64_tr_b16 v[16:17], v3 offset:18560
    v_cvt_pk_bf16_f32 v55, v130, v131
    v_mfma_f32_16x16x32_bf16 v[172:175], v[20:23], v[236:239], v[172:175]
    ds_read_b64_tr_b16 v[18:19], v3 offset:23168
    v_cvt_pk_bf16_f32 v71, v166, v167
    s_waitcnt lgkmcnt(6)
    v_mfma_f32_16x16x32_bf16 v[136:139], v[24:27], v[240:243], v[136:139]
    ds_read_b64_tr_b16 v[20:21], v3 offset:27776
    v_permlane16_swap_b32 v52, v54
    v_mfma_f32_16x16x32_bf16 v[172:175], v[24:27], v[244:247], v[172:175]
    ds_read_b64_tr_b16 v[22:23], v3 offset:32384
    v_permlane16_swap_b32 v68, v70
    v_mfma_f32_16x16x32_bf16 v[136:139], v[28:31], v[248:251], v[136:139]
    ds_read_b64_tr_b16 v[24:25], v3 offset:160
    v_permlane16_swap_b32 v53, v55
    v_mfma_f32_16x16x32_bf16 v[172:175], v[28:31], v[252:255], v[172:175]
    ds_read_b64_tr_b16 v[26:27], v3 offset:4768
    v_permlane16_swap_b32 v69, v71
    s_waitcnt lgkmcnt(6)
    v_mfma_f32_16x16x32_bf16 v[140:143], v[32:35], v[224:227], v[140:143]
    ds_read_b64_tr_b16 v[28:29], v3 offset:9376
    buffer_store_dwordx4 v[52:55], v1, s[28:31], s46 offen offset:0 sc1
    v_mfma_f32_16x16x32_bf16 v[176:179], v[32:35], v[228:231], v[176:179]
    ds_read_b64_tr_b16 v[30:31], v3 offset:13984
    buffer_store_dwordx4 v[68:71], v1, s[28:31], s47 offen offset:0 sc1
    v_mfma_f32_16x16x32_bf16 v[140:143], v[36:39], v[232:235], v[140:143]
    ds_read_b64_tr_b16 v[32:33], v3 offset:18592
    ds_write_b128 v15, v[52:55] offset:0
    v_mfma_f32_16x16x32_bf16 v[176:179], v[36:39], v[236:239], v[176:179]
    ds_read_b64_tr_b16 v[34:35], v3 offset:23200
    ds_write_b128 v15, v[68:71] offset:4096
    s_waitcnt lgkmcnt(8)
    v_mfma_f32_16x16x32_bf16 v[140:143], v[16:19], v[240:243], v[140:143]
    ds_read_b64_tr_b16 v[36:37], v3 offset:27808
    v_cvt_pk_bf16_f32 v56, v132, v133
    v_mfma_f32_16x16x32_bf16 v[176:179], v[16:19], v[244:247], v[176:179]
    ds_read_b64_tr_b16 v[38:39], v3 offset:32416
    v_cvt_pk_bf16_f32 v72, v168, v169
    v_mfma_f32_16x16x32_bf16 v[140:143], v[20:23], v[248:251], v[140:143]
    ds_read_b64_tr_b16 v[16:17], v3 offset:192
    v_cvt_pk_bf16_f32 v57, v134, v135
    v_mfma_f32_16x16x32_bf16 v[176:179], v[20:23], v[252:255], v[176:179]
    ds_read_b64_tr_b16 v[18:19], v3 offset:4800
    v_cvt_pk_bf16_f32 v73, v170, v171
    s_waitcnt lgkmcnt(8)
    v_mfma_f32_16x16x32_bf16 v[144:147], v[24:27], v[224:227], v[144:147]
    ds_read_b64_tr_b16 v[20:21], v3 offset:9408
    v_cvt_pk_bf16_f32 v58, v136, v137
    v_mfma_f32_16x16x32_bf16 v[180:183], v[24:27], v[228:231], v[180:183]
    ds_read_b64_tr_b16 v[22:23], v3 offset:14016
    v_cvt_pk_bf16_f32 v74, v172, v173
    v_mfma_f32_16x16x32_bf16 v[144:147], v[28:31], v[232:235], v[144:147]
    ds_read_b64_tr_b16 v[24:25], v3 offset:18624
    v_cvt_pk_bf16_f32 v59, v138, v139
    v_mfma_f32_16x16x32_bf16 v[180:183], v[28:31], v[236:239], v[180:183]
    ds_read_b64_tr_b16 v[26:27], v3 offset:23232
    v_cvt_pk_bf16_f32 v75, v174, v175
    s_waitcnt lgkmcnt(6)
    v_mfma_f32_16x16x32_bf16 v[144:147], v[32:35], v[240:243], v[144:147]
    ds_read_b64_tr_b16 v[28:29], v3 offset:27840
    v_permlane16_swap_b32 v56, v58
    v_mfma_f32_16x16x32_bf16 v[180:183], v[32:35], v[244:247], v[180:183]
    ds_read_b64_tr_b16 v[30:31], v3 offset:32448
    v_permlane16_swap_b32 v72, v74
    v_mfma_f32_16x16x32_bf16 v[144:147], v[36:39], v[248:251], v[144:147]
    ds_read_b64_tr_b16 v[32:33], v3 offset:224
    v_permlane16_swap_b32 v57, v59
    v_mfma_f32_16x16x32_bf16 v[180:183], v[36:39], v[252:255], v[180:183]
    ds_read_b64_tr_b16 v[34:35], v3 offset:4832
    v_permlane16_swap_b32 v73, v75
    s_waitcnt lgkmcnt(6)
    v_mfma_f32_16x16x32_bf16 v[148:151], v[16:19], v[224:227], v[148:151]
    ds_read_b64_tr_b16 v[36:37], v3 offset:9440
    buffer_store_dwordx4 v[56:59], v1, s[28:31], s46 offen offset:1024 sc1
    v_mfma_f32_16x16x32_bf16 v[184:187], v[16:19], v[228:231], v[184:187]
    ds_read_b64_tr_b16 v[38:39], v3 offset:14048
    buffer_store_dwordx4 v[72:75], v1, s[28:31], s47 offen offset:1024 sc1
    v_mfma_f32_16x16x32_bf16 v[148:151], v[20:23], v[232:235], v[148:151]
    ds_read_b64_tr_b16 v[16:17], v3 offset:18656
    ds_write_b128 v15, v[56:59] offset:1024
    v_mfma_f32_16x16x32_bf16 v[184:187], v[20:23], v[236:239], v[184:187]
    ds_read_b64_tr_b16 v[18:19], v3 offset:23264
    ds_write_b128 v15, v[72:75] offset:5120
    s_waitcnt lgkmcnt(8)
    v_mfma_f32_16x16x32_bf16 v[148:151], v[24:27], v[240:243], v[148:151]
    ds_read_b64_tr_b16 v[20:21], v3 offset:27872
    v_cvt_pk_bf16_f32 v60, v140, v141
    v_mfma_f32_16x16x32_bf16 v[184:187], v[24:27], v[244:247], v[184:187]
    ds_read_b64_tr_b16 v[22:23], v3 offset:32480
    v_cvt_pk_bf16_f32 v76, v176, v177
    v_mfma_f32_16x16x32_bf16 v[148:151], v[28:31], v[248:251], v[148:151]
    ds_read_b64_tr_b16 v[24:25], v3 offset:256
    v_cvt_pk_bf16_f32 v61, v142, v143
    v_mfma_f32_16x16x32_bf16 v[184:187], v[28:31], v[252:255], v[184:187]
    ds_read_b64_tr_b16 v[26:27], v3 offset:4864
    v_cvt_pk_bf16_f32 v77, v178, v179
    s_waitcnt lgkmcnt(8)
    v_mfma_f32_16x16x32_bf16 v[152:155], v[32:35], v[224:227], v[152:155]
    ds_read_b64_tr_b16 v[28:29], v3 offset:9472
    v_cvt_pk_bf16_f32 v62, v144, v145
    v_mfma_f32_16x16x32_bf16 v[188:191], v[32:35], v[228:231], v[188:191]
    ds_read_b64_tr_b16 v[30:31], v3 offset:14080
    v_cvt_pk_bf16_f32 v78, v180, v181
    v_mfma_f32_16x16x32_bf16 v[152:155], v[36:39], v[232:235], v[152:155]
    ds_read_b64_tr_b16 v[32:33], v3 offset:18688
    v_cvt_pk_bf16_f32 v63, v146, v147
    v_mfma_f32_16x16x32_bf16 v[188:191], v[36:39], v[236:239], v[188:191]
    ds_read_b64_tr_b16 v[34:35], v3 offset:23296
    v_cvt_pk_bf16_f32 v79, v182, v183
    s_waitcnt lgkmcnt(6)
    v_mfma_f32_16x16x32_bf16 v[152:155], v[16:19], v[240:243], v[152:155]
    ds_read_b64_tr_b16 v[36:37], v3 offset:27904
    v_permlane16_swap_b32 v60, v62
    v_mfma_f32_16x16x32_bf16 v[188:191], v[16:19], v[244:247], v[188:191]
    ds_read_b64_tr_b16 v[38:39], v3 offset:32512
    v_permlane16_swap_b32 v76, v78
    v_mfma_f32_16x16x32_bf16 v[152:155], v[20:23], v[248:251], v[152:155]
    v_permlane16_swap_b32 v61, v63
    v_mfma_f32_16x16x32_bf16 v[188:191], v[20:23], v[252:255], v[188:191]
    v_permlane16_swap_b32 v77, v79
    s_waitcnt lgkmcnt(4)
    v_mfma_f32_16x16x32_bf16 v[156:159], v[24:27], v[224:227], v[156:159]
    buffer_store_dwordx4 v[60:63], v1, s[28:31], s46 offen offset:2048 sc1
    v_mfma_f32_16x16x32_bf16 v[192:195], v[24:27], v[228:231], v[192:195]
    buffer_store_dwordx4 v[76:79], v1, s[28:31], s47 offen offset:2048 sc1
    v_mfma_f32_16x16x32_bf16 v[156:159], v[28:31], v[232:235], v[156:159]
    ds_write_b128 v15, v[60:63] offset:2048
    v_mfma_f32_16x16x32_bf16 v[192:195], v[28:31], v[236:239], v[192:195]
    ds_write_b128 v15, v[76:79] offset:6144
    s_waitcnt lgkmcnt(2)
    v_mfma_f32_16x16x32_bf16 v[156:159], v[32:35], v[240:243], v[156:159]
    v_cvt_pk_bf16_f32 v64, v148, v149
    v_mfma_f32_16x16x32_bf16 v[192:195], v[32:35], v[244:247], v[192:195]
    v_cvt_pk_bf16_f32 v80, v184, v185
    v_mfma_f32_16x16x32_bf16 v[156:159], v[36:39], v[248:251], v[156:159]
    v_cvt_pk_bf16_f32 v65, v150, v151
    v_mfma_f32_16x16x32_bf16 v[192:195], v[36:39], v[252:255], v[192:195]
    v_cvt_pk_bf16_f32 v81, v186, v187
    v_cvt_pk_bf16_f32 v66, v152, v153
    v_cvt_pk_bf16_f32 v82, v188, v189
    v_cvt_pk_bf16_f32 v67, v154, v155
    v_cvt_pk_bf16_f32 v83, v190, v191
    v_permlane16_swap_b32 v64, v66
    v_permlane16_swap_b32 v80, v82
    v_permlane16_swap_b32 v65, v67
    v_permlane16_swap_b32 v81, v83
    buffer_store_dwordx4 v[64:67], v1, s[28:31], s46 offen offset:3072 sc1
    buffer_store_dwordx4 v[80:83], v1, s[28:31], s47 offen offset:3072 sc1
    ds_write_b128 v15, v[64:67] offset:3072
    ds_write_b128 v15, v[80:83] offset:7168
    v_cvt_pk_bf16_f32 v84, v156, v157
    v_cvt_pk_bf16_f32 v85, v158, v159
    v_cvt_pk_bf16_f32 v86, v192, v193
    v_cvt_pk_bf16_f32 v87, v194, v195
    s_nop 0
    v_permlane16_swap_b32 v84, v86
    v_permlane16_swap_b32 v85, v87
    buffer_store_dwordx4 v[84:87], v1, s[28:31], s48 offen offset:0 sc1
    ds_write_b128 v15, v[84:87] offset:8192
    s_and_b32 s9, s4, 63
    s_lshl_b32 s9, s9, 2
    s_add_u32 s9, s9, s3
    s_lshl_b32 s9, s9, 9
    s_add_u32 s9, s9, 589824
    s_cmp_eq_u32 s3, s5
    s_cbranch_scc1 KB_OWN
    s_lshl_b32 s19, s5, 7
    s_add_u32 s9, s9, s19
    s_waitcnt vmcnt(0)
    buffer_store_dwordx4 v[216:219], v220, s[56:59], s9 offen sc1
    s_branch KB_GO
KB_OWN:
    v_add_u32 v3, s5, v8
    v_add_u32 v3, 1, v3
    v_and_b32 v3, 3, v3
    v_cmp_gt_u32 vcc, 3, v8
    v_lshlrev_b32 v3, 7, v3
    s_nop 0
    v_cndmask_b32 v3, 2.0, v3, vcc
    s_mov_b32 s19, 0
KB_P3:
    buffer_load_dword v16, v3, s[56:59], s9 offen sc1
    s_add_u32 s19, s19, 1
    s_waitcnt vmcnt(0)
    v_cmp_eq_u32 vcc, s51, v16
    s_cmp_gt_u32 s19, 0x40000
    s_cbranch_scc1 KB_P3_X
    s_bcnt1_i32_b64 s61, vcc
    s_cmp_lt_u32 s61, 3
    s_cbranch_scc1 KB_P3
KB_P3_X:
    s_waitcnt lgkmcnt(0)
KB_GO:
    s_barrier
    s_and_b32 s9, s4, 63
    s_lshl_b32 s9, s9, 2
    s_add_u32 s9, s9, s5
    s_mul_i32 s9, s9, 9216
    s_lshl_b32 s19, s3, 10
    v_add_u32 v3, s19, v1
    v_add_u32 v4, 0x1000, v3
    v_add_u32 v5, 0x2000, v1
    s_add_u32 s19, s5, 1
    s_and_b32 s19, s19, 3
    s_mul_i32 s19, s19, 2359296
    s_add_u32 s19, s19, s9
    buffer_load_dwordx4 v[88:91], v3, s[28:31], s19 offen sc1
    buffer_load_dwordx4 v[100:103], v4, s[28:31], s19 offen sc1
    buffer_load_dwordx4 v[112:115], v5, s[28:31], s19 offen sc1
    s_add_u32 s19, s5, 2
    s_and_b32 s19, s19, 3
    s_mul_i32 s19, s19, 2359296
    s_add_u32 s19, s19, s9
    buffer_load_dwordx4 v[92:95], v3, s[28:31], s19 offen sc1
    buffer_load_dwordx4 v[104:107], v4, s[28:31], s19 offen sc1
    buffer_load_dwordx4 v[116:119], v5, s[28:31], s19 offen sc1
    s_add_u32 s19, s5, 3
    s_and_b32 s19, s19, 3
    s_mul_i32 s19, s19, 2359296
    s_add_u32 s19, s19, s9
    buffer_load_dwordx4 v[96:99], v3, s[28:31], s19 offen sc1
    buffer_load_dwordx4 v[108:111], v4, s[28:31], s19 offen sc1
    buffer_load_dwordx4 v[120:123], v5, s[28:31], s19 offen sc1
    v_add_u32 v16, 147456, v3
    ds_read_b128 v[52:55], v16
    v_add_u32 v17, 147456, v4
    ds_read_b128 v[56:59], v17
    v_add_u32 v18, 147456, v5
    ds_read_b128 v[60:63], v18
    s_mov_b32 s20, s44
    s_mov_b32 s21, s45
    s_mov_b32 s22, 2359296
    s_mov_b32 s23, 0x00020000
    v_lshlrev_b32 v172, 16, v208
    v_and_b32 v173, 0xffff0000, v208
    v_lshlrev_b32 v174, 16, v209
    v_and_b32 v175, 0xffff0000, v209
    v_lshlrev_b32 v176, 16, v210
    v_and_b32 v177, 0xffff0000, v210
    v_lshlrev_b32 v178, 16, v211
    v_and_b32 v179, 0xffff0000, v211
    v_lshlrev_b32 v180, 16, v212
    v_and_b32 v181, 0xffff0000, v212
    v_lshlrev_b32 v182, 16, v213
    v_and_b32 v183, 0xffff0000, v213
    v_lshlrev_b32 v184, 16, v214
    v_and_b32 v185, 0xffff0000, v214
    v_lshlrev_b32 v186, 16, v215
    v_and_b32 v187, 0xffff0000, v215
    s_waitcnt lgkmcnt(0)
    v_lshlrev_b32 v124, 16, v52
    v_and_b32 v125, 0xffff0000, v52
    v_lshlrev_b32 v126, 16, v53
    v_and_b32 v127, 0xffff0000, v53
    v_lshlrev_b32 v128, 16, v54
    v_and_b32 v129, 0xffff0000, v54
    v_lshlrev_b32 v130, 16, v55
    v_and_b32 v131, 0xffff0000, v55
    v_lshlrev_b32 v132, 16, v56
    v_and_b32 v133, 0xffff0000, v56
    v_lshlrev_b32 v134, 16, v57
    v_and_b32 v135, 0xffff0000, v57
    v_lshlrev_b32 v136, 16, v58
    v_and_b32 v137, 0xffff0000, v58
    v_lshlrev_b32 v138, 16, v59
    v_and_b32 v139, 0xffff0000, v59
    v_lshlrev_b32 v140, 16, v60
    v_and_b32 v141, 0xffff0000, v60
    v_lshlrev_b32 v142, 16, v61
    v_and_b32 v143, 0xffff0000, v61
    v_lshlrev_b32 v144, 16, v62
    v_and_b32 v145, 0xffff0000, v62
    v_lshlrev_b32 v146, 16, v63
    v_and_b32 v147, 0xffff0000, v63
    s_waitcnt vmcnt(0) lgkmcnt(0)
    v_lshlrev_b32 v148, 16, v88
    v_and_b32 v149, 0xffff0000, v88
    v_lshlrev_b32 v150, 16, v89
    v_and_b32 v151, 0xffff0000, v89
    v_lshlrev_b32 v152, 16, v90
    v_and_b32 v153, 0xffff0000, v90
    v_lshlrev_b32 v154, 16, v91
    v_and_b32 v155, 0xffff0000, v91
    v_lshlrev_b32 v156, 16, v92
    v_and_b32 v157, 0xffff0000, v92
    v_lshlrev_b32 v158, 16, v93
    v_and_b32 v159, 0xffff0000, v93
    v_lshlrev_b32 v160, 16, v94
    v_and_b32 v161, 0xffff0000, v94
    v_lshlrev_b32 v162, 16, v95
    v_and_b32 v163, 0xffff0000, v95
    v_lshlrev_b32 v164, 16, v96
    v_and_b32 v165, 0xffff0000, v96
    v_lshlrev_b32 v166, 16, v97
    v_and_b32 v167, 0xffff0000, v97
    v_lshlrev_b32 v168, 16, v98
    v_and_b32 v169, 0xffff0000, v98
    v_lshlrev_b32 v170, 16, v99
    v_and_b32 v171, 0xffff0000, v99
    v_pk_add_f32 v[148:149], v[148:149], v[156:157]
    v_pk_add_f32 v[124:125], v[124:125], v[164:165]
    v_pk_add_f32 v[150:151], v[150:151], v[158:159]
    v_pk_add_f32 v[126:127], v[126:127], v[166:167]
    v_pk_add_f32 v[152:153], v[152:153], v[160:161]
    v_pk_add_f32 v[128:129], v[128:129], v[168:169]
    v_pk_add_f32 v[154:155], v[154:155], v[162:163]
    v_pk_add_f32 v[130:131], v[130:131], v[170:171]
    v_lshlrev_b32 v156, 16, v196
    v_and_b32 v157, 0xffff0000, v196
    v_pk_add_f32 v[124:125], v[124:125], v[148:149]
    v_lshlrev_b32 v158, 16, v197
    v_and_b32 v159, 0xffff0000, v197
    v_pk_add_f32 v[126:127], v[126:127], v[150:151]
    v_lshlrev_b32 v160, 16, v198
    v_and_b32 v161, 0xffff0000, v198
    v_pk_add_f32 v[128:129], v[128:129], v[152:153]
    v_lshlrev_b32 v162, 16, v199
    v_and_b32 v163, 0xffff0000, v199
    v_pk_add_f32 v[130:131], v[130:131], v[154:155]
    v_pk_fma_f32 v[124:125], v[124:125], v[172:173], v[156:157]
    v_pk_fma_f32 v[126:127], v[126:127], v[174:175], v[158:159]
    v_pk_fma_f32 v[128:129], v[128:129], v[176:177], v[160:161]
    v_pk_fma_f32 v[130:131], v[130:131], v[178:179], v[162:163]
    v_cvt_pk_bf16_f32 v196, v124, v125
    v_cvt_pk_bf16_f32 v197, v126, v127
    v_cvt_pk_bf16_f32 v198, v128, v129
    v_cvt_pk_bf16_f32 v199, v130, v131
    buffer_store_dwordx4 v[196:199], v9, s[20:23], s36 offen
    v_lshlrev_b32 v148, 16, v100
    v_and_b32 v149, 0xffff0000, v100
    v_lshlrev_b32 v150, 16, v101
    v_and_b32 v151, 0xffff0000, v101
    v_lshlrev_b32 v152, 16, v102
    v_and_b32 v153, 0xffff0000, v102
    v_lshlrev_b32 v154, 16, v103
    v_and_b32 v155, 0xffff0000, v103
    v_lshlrev_b32 v156, 16, v104
    v_and_b32 v157, 0xffff0000, v104
    v_lshlrev_b32 v158, 16, v105
    v_and_b32 v159, 0xffff0000, v105
    v_lshlrev_b32 v160, 16, v106
    v_and_b32 v161, 0xffff0000, v106
    v_lshlrev_b32 v162, 16, v107
    v_and_b32 v163, 0xffff0000, v107
    v_lshlrev_b32 v164, 16, v108
    v_and_b32 v165, 0xffff0000, v108
    v_lshlrev_b32 v166, 16, v109
    v_and_b32 v167, 0xffff0000, v109
    v_lshlrev_b32 v168, 16, v110
    v_and_b32 v169, 0xffff0000, v110
    v_lshlrev_b32 v170, 16, v111
    v_and_b32 v171, 0xffff0000, v111
    v_pk_add_f32 v[148:149], v[148:149], v[156:157]
    v_pk_add_f32 v[132:133], v[132:133], v[164:165]
    v_pk_add_f32 v[150:151], v[150:151], v[158:159]
    v_pk_add_f32 v[134:135], v[134:135], v[166:167]
    v_pk_add_f32 v[152:153], v[152:153], v[160:161]
    v_pk_add_f32 v[136:137], v[136:137], v[168:169]
    v_pk_add_f32 v[154:155], v[154:155], v[162:163]
    v_pk_add_f32 v[138:139], v[138:139], v[170:171]
    v_lshlrev_b32 v156, 16, v200
    v_and_b32 v157, 0xffff0000, v200
    v_pk_add_f32 v[132:133], v[132:133], v[148:149]
    v_lshlrev_b32 v158, 16, v201
    v_and_b32 v159, 0xffff0000, v201
    v_pk_add_f32 v[134:135], v[134:135], v[150:151]
    v_lshlrev_b32 v160, 16, v202
    v_and_b32 v161, 0xffff0000, v202
    v_pk_add_f32 v[136:137], v[136:137], v[152:153]
    v_lshlrev_b32 v162, 16, v203
    v_and_b32 v163, 0xffff0000, v203
    v_pk_add_f32 v[138:139], v[138:139], v[154:155]
    v_pk_fma_f32 v[132:133], v[132:133], v[172:173], v[156:157]
    v_pk_fma_f32 v[134:135], v[134:135], v[174:175], v[158:159]
    v_pk_fma_f32 v[136:137], v[136:137], v[176:177], v[160:161]
    v_pk_fma_f32 v[138:139], v[138:139], v[178:179], v[162:163]
    v_cvt_pk_bf16_f32 v200, v132, v133
    v_cvt_pk_bf16_f32 v201, v134, v135
    v_cvt_pk_bf16_f32 v202, v136, v137
    v_cvt_pk_bf16_f32 v203, v138, v139
    buffer_store_dwordx4 v[200:203], v9, s[20:23], s37 offen
    s_cmp_lg_u32 s3, 0
    s_cbranch_scc1 KB_FIN
    v_lshlrev_b32 v148, 16, v112
    v_and_b32 v149, 0xffff0000, v112
    v_lshlrev_b32 v150, 16, v113
    v_and_b32 v151, 0xffff0000, v113
    v_lshlrev_b32 v152, 16, v114
    v_and_b32 v153, 0xffff0000, v114
    v_lshlrev_b32 v154, 16, v115
    v_and_b32 v155, 0xffff0000, v115
    v_lshlrev_b32 v156, 16, v116
    v_and_b32 v157, 0xffff0000, v116
    v_lshlrev_b32 v158, 16, v117
    v_and_b32 v159, 0xffff0000, v117
    v_lshlrev_b32 v160, 16, v118
    v_and_b32 v161, 0xffff0000, v118
    v_lshlrev_b32 v162, 16, v119
    v_and_b32 v163, 0xffff0000, v119
    v_lshlrev_b32 v164, 16, v120
    v_and_b32 v165, 0xffff0000, v120
    v_lshlrev_b32 v166, 16, v121
    v_and_b32 v167, 0xffff0000, v121
    v_lshlrev_b32 v168, 16, v122
    v_and_b32 v169, 0xffff0000, v122
    v_lshlrev_b32 v170, 16, v123
    v_and_b32 v171, 0xffff0000, v123
    v_pk_add_f32 v[148:149], v[148:149], v[156:157]
    v_pk_add_f32 v[140:141], v[140:141], v[164:165]
    v_pk_add_f32 v[150:151], v[150:151], v[158:159]
    v_pk_add_f32 v[142:143], v[142:143], v[166:167]
    v_pk_add_f32 v[152:153], v[152:153], v[160:161]
    v_pk_add_f32 v[144:145], v[144:145], v[168:169]
    v_pk_add_f32 v[154:155], v[154:155], v[162:163]
    v_pk_add_f32 v[146:147], v[146:147], v[170:171]
    v_lshlrev_b32 v156, 16, v204
    v_and_b32 v157, 0xffff0000, v204
    v_pk_add_f32 v[140:141], v[140:141], v[148:149]
    v_lshlrev_b32 v158, 16, v205
    v_and_b32 v159, 0xffff0000, v205
    v_pk_add_f32 v[142:143], v[142:143], v[150:151]
    v_lshlrev_b32 v160, 16, v206
    v_and_b32 v161, 0xffff0000, v206
    v_pk_add_f32 v[144:145], v[144:145], v[152:153]
    v_lshlrev_b32 v162, 16, v207
    v_and_b32 v163, 0xffff0000, v207
    v_pk_add_f32 v[146:147], v[146:147], v[154:155]
    v_pk_fma_f32 v[140:141], v[140:141], v[180:181], v[156:157]
    v_pk_fma_f32 v[142:143], v[142:143], v[182:183], v[158:159]
    v_pk_fma_f32 v[144:145], v[144:145], v[184:185], v[160:161]
    v_pk_fma_f32 v[146:147], v[146:147], v[186:187], v[162:163]
    v_cvt_pk_bf16_f32 v204, v140, v141
    v_cvt_pk_bf16_f32 v205, v142, v143
    v_cvt_pk_bf16_f32 v206, v144, v145
    v_cvt_pk_bf16_f32 v207, v146, v147
    buffer_store_dwordx4 v[204:207], v10, s[20:23], s38 offen
KB_FIN:
KB_END:
    s_endpgm

TEXT_END:
    s_endpgm
.section .rodata,"a"
.p2align 6
.amdhsa_kernel adaLN_cond__ssm_conv_h3__glu_gated_glu__prompt_kernel
  .amdhsa_next_free_vgpr 512
  .amdhsa_next_free_sgpr 102
  .amdhsa_accum_offset 256
  .amdhsa_group_segment_fixed_size 0
  .amdhsa_kernarg_size 120
  .amdhsa_user_sgpr_count 2
  .amdhsa_user_sgpr_kernarg_segment_ptr 1
  .amdhsa_system_sgpr_workgroup_id_x 1
  .amdhsa_float_denorm_mode_32 3
.end_amdhsa_kernel
```
